```python
import torch

def _softmax(x, axis=-1):
    return torch.softmax(x, dim=axis)
def _gelu(x):
    return torch.nn.functional.gelu(x, approximate="tanh")
def _silu(x):
    return torch.nn.functional.silu(x)
def _sigmoid(x):
    return torch.sigmoid(x)
def _layernorm(x, axis=-1, eps=1e-5):
    m = x.mean(dim=axis, keepdim=True)
    v = x.var(dim=axis, keepdim=True, unbiased=False)
    return (x - m) / torch.sqrt(v + eps)
def _scatter_add(tgt, idx, src, axis=0):
    return tgt.clone().index_add_(axis, idx, src)
def _segment_sum(src, seg, n):
    out = torch.zeros((n,) + src.shape[1:], dtype=src.dtype)
    return out.index_add_(0, seg, src)
def _pad(x, pw):
    flat = tuple(v for pair in reversed(pw) for v in pair)
    return torch.nn.functional.pad(x, flat)

kernel_name = 'concat_heads__mha_block_cached__mha_block_cached__near_ridge'

def setup_inputs():

    _w = (lambda a: (lambda t: t.to(torch.bfloat16) if t.is_floating_point() else t)(torch.as_tensor(a)))
    def _A_setup():
        B, Sq, D = 8, 144, 1024
        H, Sk, Dh = 32, 512, 128
        return {
            "x": _w((lambda *s: torch.randn(*s, dtype=torch.bfloat16) * 0.8)(B, Sq, D)),
            "k_cache": _w((lambda *s: torch.randn(*s, dtype=torch.bfloat16) * 0.8)(B, H, Sk, Dh)),
            "v_cache": _w((lambda *s: torch.randn(*s, dtype=torch.bfloat16) * 0.05)(B, H, Sk, Dh)),
            "wq": _w((lambda *s: torch.randn(*s, dtype=torch.bfloat16) * 0.8)(D, H * Dh) * (D ** -0.5)),
            "wo": _w((lambda *s: torch.randn(*s, dtype=torch.bfloat16) * 0.05)(H * Dh, D) * ((H * Dh) ** -0.5)),
        }
    _A_in = _A_setup()

    def _B_setup():
        B, Sq, D = 8, 144, 1024
        H, Sk, Dh = 32, 512, 128
        return {
            "x": _w((lambda *s: torch.randn(*s, dtype=torch.bfloat16) * 0.8)(B, Sq, D)),
            "k_cache": _w((lambda *s: torch.randn(*s, dtype=torch.bfloat16) * 0.8)(B, H, Sk, Dh)),
            "v_cache": _w((lambda *s: torch.randn(*s, dtype=torch.bfloat16) * 0.05)(B, H, Sk, Dh)),
            "wq": _w((lambda *s: torch.randn(*s, dtype=torch.bfloat16) * 0.8)(D, H * Dh) * (D ** -0.5)),
            "wo": _w((lambda *s: torch.randn(*s, dtype=torch.bfloat16) * 0.05)(H * Dh, D) * ((H * Dh) ** -0.5)),
        }
    _B_in = _B_setup()

    return {
        "A_x": _A_in["x"],
        "A_k_cache": _A_in["k_cache"],
        "A_v_cache": _A_in["v_cache"],
        "A_wq": _A_in["wq"],
        "A_wo": _A_in["wo"],
        "B_x": _B_in["x"],
        "B_k_cache": _B_in["k_cache"],
        "B_v_cache": _B_in["v_cache"],
        "B_wq": _B_in["wq"],
        "B_wo": _B_in["wo"],
    }

def reference(A_x, A_k_cache, A_v_cache, A_wq, A_wo, B_x, B_k_cache, B_v_cache, B_wq, B_wo):
    def _A_ref(x, k_cache, v_cache, wq, wo):
        B, Sq, D = x.shape
        H, Dh = 32, 128
        q = (lambda x, *d: x.permute(*d))((x @ wq).reshape(B, Sq, H, Dh), 0, 2, 1, 3)
        scores = torch.einsum("bhqd,bhkd->bhqk", q, k_cache) * (Dh ** -0.5)
        p = _softmax(scores, axis=-1)
        o = torch.einsum("bhqk,bhkd->bhqd", p, v_cache)
        return (lambda x, *d: x.permute(*d))(o, 0, 2, 1, 3).reshape(B, Sq, H * Dh) @ wo

    def _B_ref(x, k_cache, v_cache, wq, wo):
        B, Sq, D = x.shape
        H, Dh = 32, 128
        q = (lambda x, *d: x.permute(*d))((x @ wq).reshape(B, Sq, H, Dh), 0, 2, 1, 3)
        scores = torch.einsum("bhqd,bhkd->bhqk", q, k_cache) * (Dh ** -0.5)
        p = _softmax(scores, axis=-1)
        o = torch.einsum("bhqk,bhkd->bhqd", p, v_cache)
        return (lambda x, *d: x.permute(*d))(o, 0, 2, 1, 3).reshape(B, Sq, H * Dh) @ wo

    a = _A_ref(A_x, A_k_cache, A_v_cache, A_wq, A_wo)
    b = _B_ref(B_x, B_k_cache, B_v_cache, B_wq, B_wo)
    return torch.concatenate([a, b], axis=-1)
```

```asm
; @launch grid=(256,1,1) block=(256,1,1) lds=163840
.amdgcn_target "amdgcn-amd-amdhsa--gfx950"
.text
.globl concat_heads__mha_block_cached__mha_block_cached__near_ridge_kernel
.p2align 8
.type concat_heads__mha_block_cached__mha_block_cached__near_ridge_kernel,@function
concat_heads__mha_block_cached__mha_block_cached__near_ridge_kernel:
    s_cmp_ge_u32 s2, 256
    s_cbranch_scc1 L_end
    s_load_dwordx8 s[36:43], s[0:1], 0
    s_load_dwordx8 s[52:59], s[0:1], 40
    s_load_dwordx2 s[46:47], s[0:1], 32
    s_load_dwordx8 s[8:15], s[0:1], 72
    s_getpc_b64 s[44:45]
L_pc:
    s_lshr_b32 s34, s2, 3
    s_lshl_b32 s34, s34, 11
    v_lshrrev_b32 v29, 4, v0
    v_and_b32 v28, 3, v0
    v_and_b32 v29, 12, v29
    v_or_b32 v29, v29, v28
    v_lshlrev_b32 v29, 7, v29
    v_add_u32 v29, s34, v29
    v_min_u32 v29, L_code_end-L_pc-4, v29
    s_mov_b64 exec, 15
    global_load_dword v1, v29, s[44:45]
    s_mov_b64 exec, -1
    v_lshrrev_b32 v27, 6, v0
    v_and_b32 v0, 63, v0
    v_readfirstlane_b32 s3, v27
    s_bfe_u32 s60, s2, 0x10002
    s_bfe_u32 s63, s2, 0x20003
    s_lshr_b32 s62, s2, 5
    s_and_b32 s61, s2, 3
    s_lshl_b32 s61, s61, 2
    s_add_u32 s61, s61, s63
    v_and_b32 v24, 3, v0
    v_bfe_u32 v25, v0, 2, 2
    v_lshrrev_b32 v26, 4, v0
    s_and_b32 s4, s3, 1
    s_lshr_b32 s5, s3, 1
    s_lshl_b32 s6, s3, 12
    s_lshl_b32 s7, s3, 9
    v_lshrrev_b32 v28, 5, v0
    v_lshl_add_u32 v28, v28, 2, v25
    v_lshlrev_b32 v28, 11, v28
    v_and_b32 v29, 1, v26
    v_lshl_add_u32 v28, v29, 6, v28
    v_lshl_add_u32 v28, v24, 4, v28
    s_lshl_b32 s34, s3, 16
    v_add_u32 v80, s34, v28
    v_xor_b32 v81, 32, v80
    s_lshl_b32 s34, s5, 5
    v_xor_b32 v28, s34, v28
    s_lshl_b32 s34, s3, 13
    s_add_u32 s34, s34, 0x40000
    v_add_u32 v82, s34, v28
    v_lshlrev_b32 v27, 4, v24
    v_lshl_add_u32 v27, v26, 6, v27
    v_lshl_add_u32 v28, v25, 13, v27
    s_lshl_b32 s34, s3, 17
    v_add_u32 v83, s34, v28
    v_xor_b32 v84, 32, v83
    s_add_u32 s34, s62, s63
    s_and_b32 s34, s34, 3
    s_mov_b32 s100, 0x65832140
    s_mov_b32 s101, 0xfedba9c7
    s_cmp_eq_u32 s34, 1
    s_cselect_b32 s100, 0x69432501, s100
    s_cselect_b32 s101, 0xfecbad87, s101
    s_cmp_eq_u32 s34, 2
    s_cselect_b32 s100, 0xa5436102, s100
    s_cselect_b32 s101, 0xfdcbe987, s101
    s_cmp_eq_u32 s34, 3
    s_cselect_b32 s100, 0x65472103, s100
    s_cselect_b32 s101, 0xedcfa98b, s101
    s_bfe_u32 s28, s100, 0x40000
    s_lshl_b32 s30, s28, 19
    s_lshl_b32 s28, s28, 7
    s_mul_i32 s34, s62, 294912
    s_lshl_b32 s35, s61, 9
    s_waitcnt lgkmcnt(0)
    s_cmp_eq_u32 s60, 0
    s_cselect_b64 s[36:37], s[36:37], s[52:53]
    s_cselect_b64 s[42:43], s[42:43], s[58:59]
    s_cselect_b64 s[38:39], s[38:39], s[54:55]
    s_cselect_b64 s[40:41], s[40:41], s[56:57]
    s_cselect_b64 s[46:47], s[46:47], s[8:9]
    s_mov_b64 s[50:51], s[10:11]
    s_mov_b64 s[56:57], s[12:13]
    s_mov_b64 s[48:49], s[14:15]
    s_add_u32 s8, s36, s34
    s_addc_u32 s9, s37, 0
    s_mov_b32 s10, 294912
    s_mov_b32 s11, 0x20000
    s_add_u32 s12, s42, s35
    s_addc_u32 s13, s43, 0
    s_sub_u32 s14, 0x800000, s35
    s_mov_b32 s15, 0x20000
    s_add_u32 m0, s6, 0
    s_nop 0
    buffer_load_dwordx4 v80, s[8:11], s28 offen offset:0 lds
    s_add_u32 s90, s28, 15360
    buffer_load_dwordx4 v81, s[8:11], s90 offen offset:1024 lds
    s_add_u32 s91, s28, 30720
    buffer_load_dwordx4 v80, s[8:11], s91 offen offset:2048 lds
    s_add_u32 s92, s28, 46080
    buffer_load_dwordx4 v81, s[8:11], s92 offen offset:3072 lds
    s_add_u32 m0, s7, 16384
    s_nop 0
    s_mov_b32 exec_hi, 0
    buffer_load_dwordx4 v82, s[8:11], s28 offen lds
    s_mov_b32 exec_hi, -1
    s_add_u32 m0, s6, 20480
    s_nop 0
    buffer_load_dwordx4 v83, s[12:15], s30 offen offset:0 lds
    s_add_u32 s93, s30, 31744
    buffer_load_dwordx4 v83, s[12:15], s93 offen offset:1024 lds
    s_add_u32 s94, s30, 63488
    buffer_load_dwordx4 v84, s[12:15], s94 offen offset:2048 lds
    s_add_u32 s95, s30, 95232
    buffer_load_dwordx4 v84, s[12:15], s95 offen offset:3072 lds
    s_add_u32 m0, s6, 36864
    s_add_u32 s96, s30, 256
    buffer_load_dwordx4 v83, s[12:15], s96 offen offset:0 lds
    s_add_u32 s97, s30, 32000
    buffer_load_dwordx4 v83, s[12:15], s97 offen offset:1024 lds
    s_add_u32 s90, s30, 63744
    buffer_load_dwordx4 v84, s[12:15], s90 offen offset:2048 lds
    s_add_u32 s91, s30, 95488
    buffer_load_dwordx4 v84, s[12:15], s91 offen offset:3072 lds
    v_lshlrev_b32 v7, 4, v0
    s_lshl_b32 s55, s62, 4
    s_add_u32 s55, s55, s61
    s_lshl_b32 s54, s55, 18
    s_add_u32 s16, s38, s54
    s_addc_u32 s17, s39, 0
    s_mov_b32 s18, 262144
    s_mov_b32 s19, 0x20000
    s_add_u32 s20, s40, s54
    s_addc_u32 s21, s41, 0
    s_mov_b32 s22, 262144
    s_mov_b32 s23, 0x20000
    s_lshl_b32 s54, s60, 7
    s_add_u32 s55, s55, s54
    s_mul_i32 s55, s55, 73728
    s_add_u32 s24, s48, s55
    s_addc_u32 s25, s49, 0
    s_mov_b32 s26, 73728
    s_mov_b32 s27, 0x20000
    s_mov_b32 s58, 256
    s_mov_b32 s59, 0x20000
    s_add_u32 s52, s48, 67108864
    s_addc_u32 s53, s49, 0
    s_mov_b32 s54, 65536
    s_mov_b32 s55, 0x20000
    s_lshl_b32 s34, s2, 8
    v_mov_b32 v28, 0
    v_lshlrev_b32 v29, 2, v0
    buffer_store_dword v28, v29, s[52:55], s34 offen sc0 sc1
    s_lshl_b32 s34, s60, 3
    s_add_u32 s34, s34, s62
    s_lshl_b32 s34, s34, 4
    v_mov_b32 v13, s34
    s_cmp_eq_u32 s3, 0
    s_cselect_b32 s34, s34, 2146435072
    v_mov_b32 v30, s34
    v_mov_b32 v31, 2146435072
    v_cmp_eq_u32 vcc, 0, v0
    v_mov_b32 v12, 1
    s_mov_b32 s45, 65536
    v_cndmask_b32 v11, v31, v30, vcc
    v_lshl_add_u32 v28, v25, 8, v27
    v_add_u32 v2, s6, v28
    v_xor_b32 v3, 16, v2
    v_mov_b32 v4, v2
    v_xor_b32 v5, 32, v2
    s_lshl_b32 s55, s5, 17
    s_lshl_b32 s54, s4, 13
    s_add_u32 s55, s55, s54
    v_lshlrev_b32 v28, 7, v0
    v_add_u32 v6, s55, v28
    v_add_u32 v104, s6, v7
    v_add_u32 v105, 0x10000, v104
    v_add_u32 v106, 0x20000, v104
    v_lshl_add_u32 v28, v25, 11, v27
    s_lshl_b32 s55, s3, 15
    v_add_u32 v9, s55, v28
    v_xor_b32 v10, 32, v9
    s_bfe_u32 s55, s2, 0x10001
    s_lshl_b32 s33, s5, 1
    s_add_u32 s33, s33, s55
    v_lshrrev_b32 v27, 1, v25
    v_lshlrev_b32 v28, 1, v27
    v_xor_b32 v28, v28, v26
    v_lshlrev_b32 v28, 4, v28
    v_lshl_add_u32 v28, v24, 6, v28
    v_lshl_add_u32 v28, v25, 9, v28
    s_xor_b32 s55, s33, 0
    s_lshl_b32 s55, s55, 11
    s_add_u32 s55, s55, s54
    v_add_u32 v85, s55, v28
    s_xor_b32 s55, s33, 1
    s_lshl_b32 s55, s55, 11
    s_add_u32 s55, s55, s54
    v_add_u32 v86, s55, v28
    s_xor_b32 s55, s33, 2
    s_lshl_b32 s55, s55, 11
    s_add_u32 s55, s55, s54
    v_add_u32 v87, s55, v28
    s_xor_b32 s55, s33, 3
    s_lshl_b32 s55, s55, 11
    s_add_u32 s55, s55, s54
    v_add_u32 v88, s55, v28
    v_add_u32 v89, 16384, v28
    v_and_b32 v28, 1, v26
    v_lshlrev_b32 v28, 1, v28
    v_lshrrev_b32 v29, 1, v26
    v_or_b32 v28, v28, v29
    v_xor_b32 v28, v28, v27
    v_lshlrev_b32 v28, 4, v28
    v_lshl_add_u32 v28, v24, 6, v28
    v_lshl_add_u32 v28, v25, 10, v28
    s_lshl_b32 s54, s5, 14
    s_mul_i32 s55, s4, 8704
    s_add_u32 s55, s55, s54
    s_add_u32 s55, s55, 65536
    v_add_u32 v14, s55, v28
    v_xor_b32 v15, 512, v14
    v_xor_b32 v16, 8192, v14
    v_xor_b32 v17, 8704, v14
    v_lshlrev_b32 v28, 3, v24
    v_lshl_add_u32 v28, v25, 6, v28
    v_and_b32 v29, 1, v26
    v_lshl_add_u32 v30, v29, 5, v28
    s_lshl_b32 s55, s4, 13
    s_add_u32 s55, s55, s54
    s_add_u32 s55, s55, 131072
    v_lshl_add_u32 v27, v26, 10, v30
    v_add_u32 v18, s55, v27
    v_xor_b32 v19, 32, v18
    v_xor_b32 v20, 8192, v18
    v_xor_b32 v21, 8224, v18
    s_lshl_b32 s55, s4, 9
    s_add_u32 s55, s55, s54
    s_add_u32 s55, s55, 20480
    v_lshl_add_u32 v27, v26, 11, v30
    v_add_u32 v90, s55, v27
    v_xor_b32 v91, 512, v90
    v_xor_b32 v92, 32, v90
    v_xor_b32 v93, 544, v90
    s_mov_b32 s62, 0x3e0293ee
    s_mov_b32 s63, 0x3e0293ee
    s_bfe_u32 s29, s100, 0x40004
    s_lshl_b32 s31, s29, 19
    s_lshl_b32 s29, s29, 7
    s_add_u32 m0, s6, 53248
    s_nop 0
    buffer_load_dwordx4 v80, s[8:11], s29 offen offset:0 lds
    s_add_u32 s92, s29, 15360
    buffer_load_dwordx4 v81, s[8:11], s92 offen offset:1024 lds
    s_add_u32 s93, s29, 30720
    buffer_load_dwordx4 v80, s[8:11], s93 offen offset:2048 lds
    s_add_u32 s94, s29, 46080
    buffer_load_dwordx4 v81, s[8:11], s94 offen offset:3072 lds
    s_add_u32 m0, s7, 69632
    s_nop 0
    s_mov_b32 exec_hi, 0
    buffer_load_dwordx4 v82, s[8:11], s29 offen lds
    s_mov_b32 exec_hi, -1
    s_add_u32 m0, s6, 73728
    s_nop 0
    buffer_load_dwordx4 v83, s[12:15], s31 offen offset:0 lds
    s_add_u32 s95, s31, 31744
    buffer_load_dwordx4 v83, s[12:15], s95 offen offset:1024 lds
    s_add_u32 s96, s31, 63488
    buffer_load_dwordx4 v84, s[12:15], s96 offen offset:2048 lds
    s_add_u32 s97, s31, 95232
    buffer_load_dwordx4 v84, s[12:15], s97 offen offset:3072 lds
    s_add_u32 m0, s6, 90112
    s_add_u32 s90, s31, 256
    buffer_load_dwordx4 v83, s[12:15], s90 offen offset:0 lds
    s_add_u32 s91, s31, 32000
    buffer_load_dwordx4 v83, s[12:15], s91 offen offset:1024 lds
    s_add_u32 s92, s31, 63744
    buffer_load_dwordx4 v84, s[12:15], s92 offen offset:2048 lds
    s_add_u32 s93, s31, 95488
    buffer_load_dwordx4 v84, s[12:15], s93 offen offset:3072 lds
    s_bfe_u32 s28, s100, 0x40008
    s_lshl_b32 s30, s28, 19
    s_lshl_b32 s28, s28, 7
    s_waitcnt vmcnt(14)
    s_barrier
    ds_read_b128 v[32:35], v85 offset:0
    ds_read_b128 v[36:39], v85 offset:256
    ds_read_b128 v[40:43], v86 offset:0
    ds_read_b128 v[44:47], v86 offset:256
    ds_read_b128 v[48:51], v87 offset:0
    ds_read_b128 v[52:55], v87 offset:256
    ds_read_b128 v[56:59], v88 offset:0
    ds_read_b128 v[60:63], v88 offset:256
    ds_read_b128 v[64:67], v89 offset:0
    ds_read_b128 v[68:71], v89 offset:256
    ds_read_b64_tr_b16 a[176:177], v90 offset:0
    ds_read_b64_tr_b16 a[178:179], v90 offset:1024
    ds_read_b64_tr_b16 a[180:181], v90 offset:8192
    ds_read_b64_tr_b16 a[182:183], v90 offset:9216
    ds_read_b64_tr_b16 a[184:185], v92 offset:0
    ds_read_b64_tr_b16 a[186:187], v92 offset:1024
    ds_read_b64_tr_b16 a[188:189], v92 offset:8192
    ds_read_b64_tr_b16 a[190:191], v92 offset:9216
    ds_read_b64_tr_b16 a[192:193], v90 offset:256
    ds_read_b64_tr_b16 a[194:195], v90 offset:1280
    ds_read_b64_tr_b16 a[196:197], v90 offset:8448
    ds_read_b64_tr_b16 a[198:199], v90 offset:9472
    ds_read_b64_tr_b16 a[200:201], v92 offset:256
    ds_read_b64_tr_b16 a[202:203], v92 offset:1280
    ds_read_b64_tr_b16 a[204:205], v92 offset:8448
    ds_read_b64_tr_b16 a[206:207], v92 offset:9472
    ds_read_b64_tr_b16 a[208:209], v91 offset:0
    ds_read_b64_tr_b16 a[210:211], v91 offset:1024
    ds_read_b64_tr_b16 a[212:213], v91 offset:8192
    ds_read_b64_tr_b16 a[214:215], v91 offset:9216
    ds_read_b64_tr_b16 a[216:217], v93 offset:0
    ds_read_b64_tr_b16 a[218:219], v93 offset:1024
    ds_read_b64_tr_b16 a[220:221], v93 offset:8192
    ds_read_b64_tr_b16 a[222:223], v93 offset:9216
    ds_read_b64_tr_b16 a[224:225], v91 offset:256
    ds_read_b64_tr_b16 a[226:227], v91 offset:1280
    ds_read_b64_tr_b16 a[228:229], v91 offset:8448
    ds_read_b64_tr_b16 a[230:231], v91 offset:9472
    ds_read_b64_tr_b16 a[232:233], v93 offset:256
    ds_read_b64_tr_b16 a[234:235], v93 offset:1280
    ds_read_b64_tr_b16 a[236:237], v93 offset:8448
    ds_read_b64_tr_b16 a[238:239], v93 offset:9472
    v_add_u32 v85, 53248, v85
    v_add_u32 v86, 53248, v86
    v_add_u32 v87, 53248, v87
    v_add_u32 v88, 53248, v88
    v_add_u32 v89, 53248, v89
    v_add_u32 v90, 53248, v90
    v_add_u32 v91, 53248, v91
    v_add_u32 v92, 53248, v92
    v_add_u32 v93, 53248, v93
    s_add_u32 m0, s6, 106496
    s_nop 0
    buffer_load_dwordx4 v80, s[8:11], s28 offen offset:0 lds
    s_add_u32 s94, s28, 15360
    buffer_load_dwordx4 v81, s[8:11], s94 offen offset:1024 lds
    s_add_u32 s95, s28, 30720
    buffer_load_dwordx4 v80, s[8:11], s95 offen offset:2048 lds
    s_add_u32 s96, s28, 46080
    buffer_load_dwordx4 v81, s[8:11], s96 offen offset:3072 lds
    s_add_u32 m0, s7, 122880
    s_nop 0
    s_mov_b32 exec_hi, 0
    buffer_load_dwordx4 v82, s[8:11], s28 offen lds
    s_mov_b32 exec_hi, -1
    s_add_u32 m0, s6, 126976
    s_nop 0
    buffer_load_dwordx4 v83, s[12:15], s30 offen offset:0 lds
    s_add_u32 s97, s30, 31744
    buffer_load_dwordx4 v83, s[12:15], s97 offen offset:1024 lds
    s_add_u32 s90, s30, 63488
    buffer_load_dwordx4 v84, s[12:15], s90 offen offset:2048 lds
    s_add_u32 s91, s30, 95232
    buffer_load_dwordx4 v84, s[12:15], s91 offen offset:3072 lds
    s_add_u32 m0, s6, 143360
    s_add_u32 s92, s30, 256
    buffer_load_dwordx4 v83, s[12:15], s92 offen offset:0 lds
    s_add_u32 s93, s30, 32000
    buffer_load_dwordx4 v83, s[12:15], s93 offen offset:1024 lds
    s_add_u32 s94, s30, 63744
    buffer_load_dwordx4 v84, s[12:15], s94 offen offset:2048 lds
    s_add_u32 s95, s30, 95488
    buffer_load_dwordx4 v84, s[12:15], s95 offen offset:3072 lds
    s_bfe_u32 s29, s100, 0x4000c
    s_lshl_b32 s31, s29, 19
    s_lshl_b32 s29, s29, 7
    s_waitcnt vmcnt(13) lgkmcnt(0)
    s_barrier
    v_mfma_f32_16x16x32_bf16 v[112:115], a[176:179], v[32:35], 0
    s_bfe_u32 s28, s100, 0x40010
    ds_read_b64_tr_b16 a[240:241], v90 offset:0
    v_mfma_f32_16x16x32_bf16 v[112:115], a[180:183], v[36:39], v[112:115]
    s_lshl_b32 s30, s28, 19
    ds_read_b64_tr_b16 a[242:243], v90 offset:1024
    v_mfma_f32_16x16x32_bf16 v[116:119], a[180:183], v[44:47], 0
    buffer_atomic_add v12, v11, s[56:59], 0 offen sc1
    v_mfma_f32_16x16x32_bf16 v[116:119], a[176:179], v[40:43], v[116:119]
    s_lshl_b32 s28, s28, 7
    ds_read_b64_tr_b16 a[244:245], v90 offset:8192
    v_mfma_f32_16x16x32_bf16 v[120:123], a[176:179], v[48:51], 0
    ds_read_b64_tr_b16 a[246:247], v90 offset:9216
    v_mfma_f32_16x16x32_bf16 v[120:123], a[180:183], v[52:55], v[120:123]
    ds_read_b64_tr_b16 a[248:249], v92 offset:0
    v_mfma_f32_16x16x32_bf16 v[124:127], a[180:183], v[60:63], 0
    buffer_load_dwordx4 a[0:3], v2, s[16:19], 0 offen offset:0 nt
    v_mfma_f32_16x16x32_bf16 v[124:127], a[176:179], v[56:59], v[124:127]
    ds_read_b64_tr_b16 a[250:251], v92 offset:1024
    v_mfma_f32_16x16x32_bf16 v[240:243], a[176:179], v[64:67], 0
    ds_read_b64_tr_b16 a[252:253], v92 offset:8192
    v_mfma_f32_16x16x32_bf16 v[240:243], a[180:183], v[68:71], v[240:243]
    ds_read_b64_tr_b16 a[254:255], v92 offset:9216
    v_mfma_f32_16x16x32_bf16 v[244:247], a[188:191], v[68:71], 0
    buffer_load_dwordx4 a[4:7], v2, s[16:19], 0 offen offset:1024 nt
    v_mfma_f32_16x16x32_bf16 v[244:247], a[184:187], v[64:67], v[244:247]
    ds_read_b64_tr_b16 a[176:177], v90 offset:256
    v_mfma_f32_16x16x32_bf16 v[140:143], a[184:187], v[56:59], 0
    ds_read_b64_tr_b16 a[178:179], v90 offset:1280
    v_mfma_f32_16x16x32_bf16 v[140:143], a[188:191], v[60:63], v[140:143]
    ds_read_b64_tr_b16 a[180:181], v90 offset:8448
    v_mfma_f32_16x16x32_bf16 v[136:139], a[188:191], v[52:55], 0
    buffer_load_dwordx4 a[8:11], v3, s[16:19], 0 offen offset:2048 nt
    v_mfma_f32_16x16x32_bf16 v[136:139], a[184:187], v[48:51], v[136:139]
    ds_read_b64_tr_b16 a[182:183], v90 offset:9472
    v_add_u32 v90, 53248, v90
    v_mfma_f32_16x16x32_bf16 v[132:135], a[184:187], v[40:43], 0
    ds_read_b128 a[128:131], v85 offset:0
    v_mfma_f32_16x16x32_bf16 v[132:135], a[188:191], v[44:47], v[132:135]
    s_add_u32 m0, s6, 0
    ds_read_b128 a[132:135], v85 offset:256
    v_add_u32 v85, 53248, v85
    v_mfma_f32_16x16x32_bf16 v[128:131], a[188:191], v[36:39], 0
    buffer_load_dwordx4 v80, s[8:11], s29 offen offset:0 lds
    v_mfma_f32_16x16x32_bf16 v[128:131], a[184:187], v[32:35], v[128:131]
    ds_read_b64_tr_b16 a[184:185], v92 offset:256
    v_mfma_f32_16x16x32_bf16 v[144:147], a[192:195], v[32:35], 0
    ds_read_b64_tr_b16 a[186:187], v92 offset:1280
    v_mfma_f32_16x16x32_bf16 v[144:147], a[196:199], v[36:39], v[144:147]
    s_add_u32 s96, s29, 15360
    ds_read_b64_tr_b16 a[188:189], v92 offset:8448
    v_mfma_f32_16x16x32_bf16 v[148:151], a[196:199], v[44:47], 0
    buffer_load_dwordx4 v81, s[8:11], s96 offen offset:1024 lds
    v_mfma_f32_16x16x32_bf16 v[148:151], a[192:195], v[40:43], v[148:151]
    ds_read_b64_tr_b16 a[190:191], v92 offset:9472
    v_add_u32 v92, 53248, v92
    v_mfma_f32_16x16x32_bf16 v[152:155], a[192:195], v[48:51], 0
    ds_read_b128 a[136:139], v86 offset:0
    v_mfma_f32_16x16x32_bf16 v[152:155], a[196:199], v[52:55], v[152:155]
    s_add_u32 s97, s29, 30720
    ds_read_b128 a[140:143], v86 offset:256
    v_add_u32 v86, 53248, v86
    v_mfma_f32_16x16x32_bf16 v[156:159], a[196:199], v[60:63], 0
    buffer_load_dwordx4 v80, s[8:11], s97 offen offset:2048 lds
    v_mfma_f32_16x16x32_bf16 v[156:159], a[192:195], v[56:59], v[156:159]
    ds_read_b128 a[144:147], v87 offset:0
    v_mfma_f32_16x16x32_bf16 v[248:251], a[192:195], v[64:67], 0
    ds_read_b128 a[148:151], v87 offset:256
    v_add_u32 v87, 53248, v87
    v_mfma_f32_16x16x32_bf16 v[248:251], a[196:199], v[68:71], v[248:251]
    s_add_u32 s90, s29, 46080
    ds_read_b64_tr_b16 a[192:193], v91 offset:0
    v_mfma_f32_16x16x32_bf16 v[252:255], a[204:207], v[68:71], 0
    buffer_load_dwordx4 v81, s[8:11], s90 offen offset:3072 lds
    v_mfma_f32_16x16x32_bf16 v[252:255], a[200:203], v[64:67], v[252:255]
    ds_read_b64_tr_b16 a[194:195], v91 offset:1024
    v_mfma_f32_16x16x32_bf16 v[172:175], a[200:203], v[56:59], 0
    ds_read_b64_tr_b16 a[196:197], v91 offset:8192
    v_mfma_f32_16x16x32_bf16 v[172:175], a[204:207], v[60:63], v[172:175]
    s_add_u32 m0, s7, 16384
    ds_read_b64_tr_b16 a[198:199], v91 offset:9216
    v_mfma_f32_16x16x32_bf16 v[168:171], a[204:207], v[52:55], 0
    s_mov_b32 exec_hi, 0
    buffer_load_dwordx4 v82, s[8:11], s29 offen lds
    s_mov_b32 exec_hi, -1
    v_mfma_f32_16x16x32_bf16 v[168:171], a[200:203], v[48:51], v[168:171]
    ds_read_b128 a[152:155], v88 offset:0
    v_mfma_f32_16x16x32_bf16 v[164:167], a[200:203], v[40:43], 0
    ds_read_b128 a[156:159], v88 offset:256
    v_add_u32 v88, 53248, v88
    v_mfma_f32_16x16x32_bf16 v[164:167], a[204:207], v[44:47], v[164:167]
    s_add_u32 m0, s6, 20480
    ds_read_b128 a[160:163], v89 offset:0
    v_mfma_f32_16x16x32_bf16 v[160:163], a[204:207], v[36:39], 0
    buffer_load_dwordx4 v83, s[12:15], s31 offen offset:0 lds
    v_mfma_f32_16x16x32_bf16 v[160:163], a[200:203], v[32:35], v[160:163]
    ds_read_b64_tr_b16 a[200:201], v93 offset:0
    v_mfma_f32_16x16x32_bf16 v[176:179], a[208:211], v[32:35], 0
    ds_read_b64_tr_b16 a[202:203], v93 offset:1024
    v_mfma_f32_16x16x32_bf16 v[176:179], a[212:215], v[36:39], v[176:179]
    s_add_u32 s91, s31, 31744
    ds_read_b64_tr_b16 a[204:205], v93 offset:8192
    v_mfma_f32_16x16x32_bf16 v[180:183], a[212:215], v[44:47], 0
    buffer_load_dwordx4 v83, s[12:15], s91 offen offset:1024 lds
    v_mfma_f32_16x16x32_bf16 v[180:183], a[208:211], v[40:43], v[180:183]
    ds_read_b64_tr_b16 a[206:207], v93 offset:9216
    v_mfma_f32_16x16x32_bf16 v[184:187], a[208:211], v[48:51], 0
    ds_read_b128 a[164:167], v89 offset:256
    v_add_u32 v89, 53248, v89
    v_mfma_f32_16x16x32_bf16 v[184:187], a[212:215], v[52:55], v[184:187]
    s_add_u32 s92, s31, 63488
    v_mfma_f32_16x16x32_bf16 v[188:191], a[212:215], v[60:63], 0
    buffer_load_dwordx4 v84, s[12:15], s92 offen offset:2048 lds
    v_mfma_f32_16x16x32_bf16 v[188:191], a[208:211], v[56:59], v[188:191]
    ds_read_b64_tr_b16 a[208:209], v91 offset:256
    v_mfma_f32_16x16x32_bf16 v[204:207], a[216:219], v[56:59], 0
    ds_read_b64_tr_b16 a[210:211], v91 offset:1280
    v_mfma_f32_16x16x32_bf16 v[204:207], a[220:223], v[60:63], v[204:207]
    s_add_u32 s93, s31, 95232
    ds_read_b64_tr_b16 a[212:213], v91 offset:8448
    v_mfma_f32_16x16x32_bf16 v[200:203], a[220:223], v[52:55], 0
    buffer_load_dwordx4 v84, s[12:15], s93 offen offset:3072 lds
    v_mfma_f32_16x16x32_bf16 v[200:203], a[216:219], v[48:51], v[200:203]
    ds_read_b64_tr_b16 a[214:215], v91 offset:9472
    v_add_u32 v91, 53248, v91
    v_mfma_f32_16x16x32_bf16 v[196:199], a[216:219], v[40:43], 0
    s_add_u32 s94, s31, 256
    v_mfma_f32_16x16x32_bf16 v[196:199], a[220:223], v[44:47], v[196:199]
    s_add_u32 m0, s6, 36864
    v_mfma_f32_16x16x32_bf16 v[192:195], a[220:223], v[36:39], 0
    buffer_load_dwordx4 v83, s[12:15], s94 offen offset:0 lds
    v_mfma_f32_16x16x32_bf16 v[192:195], a[216:219], v[32:35], v[192:195]
    ds_read_b64_tr_b16 a[216:217], v93 offset:256
    v_mfma_f32_16x16x32_bf16 v[208:211], a[224:227], v[32:35], 0
    ds_read_b64_tr_b16 a[218:219], v93 offset:1280
    v_mfma_f32_16x16x32_bf16 v[208:211], a[228:231], v[36:39], v[208:211]
    s_add_u32 s95, s31, 32000
    ds_read_b64_tr_b16 a[220:221], v93 offset:8448
    v_mfma_f32_16x16x32_bf16 v[212:215], a[228:231], v[44:47], 0
    buffer_load_dwordx4 v83, s[12:15], s95 offen offset:1024 lds
    v_mfma_f32_16x16x32_bf16 v[212:215], a[224:227], v[40:43], v[212:215]
    ds_read_b64_tr_b16 a[222:223], v93 offset:9472
    v_add_u32 v93, 53248, v93
    v_mfma_f32_16x16x32_bf16 v[216:219], a[224:227], v[48:51], 0
    v_mfma_f32_16x16x32_bf16 v[216:219], a[228:231], v[52:55], v[216:219]
    s_add_u32 s96, s31, 63744
    v_mfma_f32_16x16x32_bf16 v[220:223], a[228:231], v[60:63], 0
    buffer_load_dwordx4 v84, s[12:15], s96 offen offset:2048 lds
    v_mfma_f32_16x16x32_bf16 v[220:223], a[224:227], v[56:59], v[220:223]
    v_mfma_f32_16x16x32_bf16 v[236:239], a[232:235], v[56:59], 0
    v_mfma_f32_16x16x32_bf16 v[236:239], a[236:239], v[60:63], v[236:239]
    s_add_u32 s97, s31, 95488
    v_mfma_f32_16x16x32_bf16 v[232:235], a[236:239], v[52:55], 0
    buffer_load_dwordx4 v84, s[12:15], s97 offen offset:3072 lds
    v_mfma_f32_16x16x32_bf16 v[232:235], a[232:235], v[48:51], v[232:235]
    v_mfma_f32_16x16x32_bf16 v[228:231], a[232:235], v[40:43], 0
    v_mfma_f32_16x16x32_bf16 v[228:231], a[236:239], v[44:47], v[228:231]
    v_mfma_f32_16x16x32_bf16 v[224:227], a[236:239], v[36:39], 0
    v_mfma_f32_16x16x32_bf16 v[224:227], a[232:235], v[32:35], v[224:227]
    s_waitcnt vmcnt(17) lgkmcnt(0)
    s_barrier
    v_mfma_f32_16x16x32_bf16 v[112:115], a[240:243], a[128:131], v[112:115]
    s_bfe_u32 s29, s100, 0x40014
    ds_read_b64_tr_b16 a[224:225], v90 offset:0
    v_mfma_f32_16x16x32_bf16 v[112:115], a[244:247], a[132:135], v[112:115]
    s_lshl_b32 s31, s29, 19
    ds_read_b64_tr_b16 a[226:227], v90 offset:1024
    v_mfma_f32_16x16x32_bf16 v[116:119], a[244:247], a[140:143], v[116:119]
    buffer_load_dwordx4 a[12:15], v3, s[16:19], 0 offen offset:3072 nt
    v_mfma_f32_16x16x32_bf16 v[116:119], a[240:243], a[136:139], v[116:119]
    s_lshl_b32 s29, s29, 7
    ds_read_b64_tr_b16 a[228:229], v90 offset:8192
    v_mfma_f32_16x16x32_bf16 v[120:123], a[240:243], a[144:147], v[120:123]
    ds_read_b64_tr_b16 a[230:231], v90 offset:9216
    v_mfma_f32_16x16x32_bf16 v[120:123], a[244:247], a[148:151], v[120:123]
    s_mov_b32 s90, 131072
    ds_read_b64_tr_b16 a[232:233], v92 offset:0
    v_mfma_f32_16x16x32_bf16 v[124:127], a[244:247], a[156:159], v[124:127]
    buffer_load_dwordx4 a[16:19], v2, s[16:19], s90 offen offset:0 nt
    v_mfma_f32_16x16x32_bf16 v[124:127], a[240:243], a[152:155], v[124:127]
    ds_read_b64_tr_b16 a[234:235], v92 offset:1024
    v_mfma_f32_16x16x32_bf16 v[240:243], a[240:243], a[160:163], v[240:243]
    ds_read_b64_tr_b16 a[236:237], v92 offset:8192
    v_mfma_f32_16x16x32_bf16 v[240:243], a[244:247], a[164:167], v[240:243]
    ds_read_b64_tr_b16 a[238:239], v92 offset:9216
    v_mfma_f32_16x16x32_bf16 v[244:247], a[252:255], a[164:167], v[244:247]
    buffer_load_dwordx4 a[20:23], v2, s[16:19], s90 offen offset:1024 nt
    v_mfma_f32_16x16x32_bf16 v[244:247], a[248:251], a[160:163], v[244:247]
    ds_read_b64_tr_b16 a[240:241], v90 offset:256
    v_mfma_f32_16x16x32_bf16 v[140:143], a[248:251], a[152:155], v[140:143]
    ds_read_b64_tr_b16 a[242:243], v90 offset:1280
    v_mfma_f32_16x16x32_bf16 v[140:143], a[252:255], a[156:159], v[140:143]
    s_add_u32 m0, s6, 53248
    ds_read_b64_tr_b16 a[244:245], v90 offset:8448
    v_mfma_f32_16x16x32_bf16 v[136:139], a[252:255], a[148:151], v[136:139]
    buffer_load_dwordx4 v80, s[8:11], s28 offen offset:0 lds
    v_mfma_f32_16x16x32_bf16 v[136:139], a[248:251], a[144:147], v[136:139]
    ds_read_b64_tr_b16 a[246:247], v90 offset:9472
    v_add_u32 v90, 4294860800, v90
    v_mfma_f32_16x16x32_bf16 v[132:135], a[248:251], a[136:139], v[132:135]
    ds_read_b128 v[32:35], v85 offset:0
    v_mfma_f32_16x16x32_bf16 v[132:135], a[252:255], a[140:143], v[132:135]
    ds_read_b128 v[36:39], v85 offset:256
    v_add_u32 v85, 4294860800, v85
    v_mfma_f32_16x16x32_bf16 v[128:131], a[252:255], a[132:135], v[128:131]
    s_add_u32 s91, s28, 15360
    ds_read_b128 v[40:43], v86 offset:0
    v_mfma_f32_16x16x32_bf16 v[128:131], a[248:251], a[128:131], v[128:131]
    buffer_load_dwordx4 v81, s[8:11], s91 offen offset:1024 lds
    v_mfma_f32_16x16x32_bf16 v[144:147], a[176:179], a[128:131], v[144:147]
    ds_read_b64_tr_b16 a[248:249], v92 offset:256
    v_mfma_f32_16x16x32_bf16 v[144:147], a[180:183], a[132:135], v[144:147]
    ds_read_b64_tr_b16 a[250:251], v92 offset:1280
    v_mfma_f32_16x16x32_bf16 v[148:151], a[180:183], a[140:143], v[148:151]
    s_add_u32 s92, s28, 30720
    ds_read_b64_tr_b16 a[252:253], v92 offset:8448
    v_mfma_f32_16x16x32_bf16 v[148:151], a[176:179], a[136:139], v[148:151]
    buffer_load_dwordx4 v80, s[8:11], s92 offen offset:2048 lds
    v_mfma_f32_16x16x32_bf16 v[152:155], a[176:179], a[144:147], v[152:155]
    ds_read_b64_tr_b16 a[254:255], v92 offset:9472
    v_add_u32 v92, 4294860800, v92
    v_mfma_f32_16x16x32_bf16 v[152:155], a[180:183], a[148:151], v[152:155]
    ds_read_b128 v[44:47], v86 offset:256
    v_add_u32 v86, 4294860800, v86
    v_mfma_f32_16x16x32_bf16 v[156:159], a[180:183], a[156:159], v[156:159]
    s_add_u32 s93, s28, 46080
    ds_read_b128 v[48:51], v87 offset:0
    v_mfma_f32_16x16x32_bf16 v[156:159], a[176:179], a[152:155], v[156:159]
    buffer_load_dwordx4 v81, s[8:11], s93 offen offset:3072 lds
    v_mfma_f32_16x16x32_bf16 v[248:251], a[176:179], a[160:163], v[248:251]
    ds_read_b128 v[52:55], v87 offset:256
    v_add_u32 v87, 4294860800, v87
    v_mfma_f32_16x16x32_bf16 v[248:251], a[180:183], a[164:167], v[248:251]
    ds_read_b64_tr_b16 a[176:177], v91 offset:0
    v_mfma_f32_16x16x32_bf16 v[252:255], a[188:191], a[164:167], v[252:255]
    s_add_u32 m0, s7, 69632
    ds_read_b64_tr_b16 a[178:179], v91 offset:1024
    v_mfma_f32_16x16x32_bf16 v[252:255], a[184:187], a[160:163], v[252:255]
    s_mov_b32 exec_hi, 0
    buffer_load_dwordx4 v82, s[8:11], s28 offen lds
    s_mov_b32 exec_hi, -1
    v_mfma_f32_16x16x32_bf16 v[172:175], a[184:187], a[152:155], v[172:175]
    ds_read_b64_tr_b16 a[180:181], v91 offset:8192
    v_mfma_f32_16x16x32_bf16 v[172:175], a[188:191], a[156:159], v[172:175]
    ds_read_b64_tr_b16 a[182:183], v91 offset:9216
    v_mfma_f32_16x16x32_bf16 v[168:171], a[188:191], a[148:151], v[168:171]
    ds_read_b128 v[56:59], v88 offset:0
    v_mfma_f32_16x16x32_bf16 v[168:171], a[184:187], a[144:147], v[168:171]
    s_add_u32 m0, s6, 73728
    ds_read_b128 v[60:63], v88 offset:256
    v_add_u32 v88, 4294860800, v88
    v_mfma_f32_16x16x32_bf16 v[164:167], a[184:187], a[136:139], v[164:167]
    buffer_load_dwordx4 v83, s[12:15], s30 offen offset:0 lds
    v_mfma_f32_16x16x32_bf16 v[164:167], a[188:191], a[140:143], v[164:167]
    ds_read_b128 v[64:67], v89 offset:0
    v_mfma_f32_16x16x32_bf16 v[160:163], a[188:191], a[132:135], v[160:163]
    ds_read_b128 v[68:71], v89 offset:256
    v_add_u32 v89, 4294860800, v89
    v_mfma_f32_16x16x32_bf16 v[160:163], a[184:187], a[128:131], v[160:163]
    s_add_u32 s94, s30, 31744
    ds_read_b64_tr_b16 a[184:185], v93 offset:0
    v_mfma_f32_16x16x32_bf16 v[176:179], a[192:195], a[128:131], v[176:179]
    buffer_load_dwordx4 v83, s[12:15], s94 offen offset:1024 lds
    v_mfma_f32_16x16x32_bf16 v[176:179], a[196:199], a[132:135], v[176:179]
    ds_read_b64_tr_b16 a[186:187], v93 offset:1024
    v_mfma_f32_16x16x32_bf16 v[180:183], a[196:199], a[140:143], v[180:183]
    ds_read_b64_tr_b16 a[188:189], v93 offset:8192
    v_mfma_f32_16x16x32_bf16 v[180:183], a[192:195], a[136:139], v[180:183]
    s_add_u32 s95, s30, 63488
    ds_read_b64_tr_b16 a[190:191], v93 offset:9216
    v_mfma_f32_16x16x32_bf16 v[184:187], a[192:195], a[144:147], v[184:187]
    buffer_load_dwordx4 v84, s[12:15], s95 offen offset:2048 lds
    v_mfma_f32_16x16x32_bf16 v[184:187], a[196:199], a[148:151], v[184:187]
    v_mfma_f32_16x16x32_bf16 v[188:191], a[196:199], a[156:159], v[188:191]
    v_mfma_f32_16x16x32_bf16 v[188:191], a[192:195], a[152:155], v[188:191]
    s_add_u32 s96, s30, 95232
    ds_read_b64_tr_b16 a[192:193], v91 offset:256
    v_mfma_f32_16x16x32_bf16 v[204:207], a[200:203], a[152:155], v[204:207]
    buffer_load_dwordx4 v84, s[12:15], s96 offen offset:3072 lds
    v_mfma_f32_16x16x32_bf16 v[204:207], a[204:207], a[156:159], v[204:207]
    ds_read_b64_tr_b16 a[194:195], v91 offset:1280
    v_mfma_f32_16x16x32_bf16 v[200:203], a[204:207], a[148:151], v[200:203]
    ds_read_b64_tr_b16 a[196:197], v91 offset:8448
    v_mfma_f32_16x16x32_bf16 v[200:203], a[200:203], a[144:147], v[200:203]
    s_add_u32 s97, s30, 256
    ds_read_b64_tr_b16 a[198:199], v91 offset:9472
    v_add_u32 v91, 4294860800, v91
    v_mfma_f32_16x16x32_bf16 v[196:199], a[200:203], a[136:139], v[196:199]
    s_add_u32 m0, s6, 90112
    v_mfma_f32_16x16x32_bf16 v[196:199], a[204:207], a[140:143], v[196:199]
    buffer_load_dwordx4 v83, s[12:15], s97 offen offset:0 lds
    v_mfma_f32_16x16x32_bf16 v[192:195], a[204:207], a[132:135], v[192:195]
    v_mfma_f32_16x16x32_bf16 v[192:195], a[200:203], a[128:131], v[192:195]
    ds_read_b64_tr_b16 a[200:201], v93 offset:256
    v_mfma_f32_16x16x32_bf16 v[208:211], a[208:211], a[128:131], v[208:211]
    s_add_u32 s90, s30, 32000
    ds_read_b64_tr_b16 a[202:203], v93 offset:1280
    v_mfma_f32_16x16x32_bf16 v[208:211], a[212:215], a[132:135], v[208:211]
    buffer_load_dwordx4 v83, s[12:15], s90 offen offset:1024 lds
    v_mfma_f32_16x16x32_bf16 v[212:215], a[212:215], a[140:143], v[212:215]
    ds_read_b64_tr_b16 a[204:205], v93 offset:8448
    v_mfma_f32_16x16x32_bf16 v[212:215], a[208:211], a[136:139], v[212:215]
    ds_read_b64_tr_b16 a[206:207], v93 offset:9472
    v_add_u32 v93, 4294860800, v93
    v_mfma_f32_16x16x32_bf16 v[216:219], a[208:211], a[144:147], v[216:219]
    s_add_u32 s91, s30, 63744
    v_mfma_f32_16x16x32_bf16 v[216:219], a[212:215], a[148:151], v[216:219]
    buffer_load_dwordx4 v84, s[12:15], s91 offen offset:2048 lds
    v_mfma_f32_16x16x32_bf16 v[220:223], a[212:215], a[156:159], v[220:223]
    v_mfma_f32_16x16x32_bf16 v[220:223], a[208:211], a[152:155], v[220:223]
    v_mfma_f32_16x16x32_bf16 v[236:239], a[216:219], a[152:155], v[236:239]
    s_add_u32 s92, s30, 95488
    v_mfma_f32_16x16x32_bf16 v[236:239], a[220:223], a[156:159], v[236:239]
    buffer_load_dwordx4 v84, s[12:15], s92 offen offset:3072 lds
    v_mfma_f32_16x16x32_bf16 v[232:235], a[220:223], a[148:151], v[232:235]
    v_mfma_f32_16x16x32_bf16 v[232:235], a[216:219], a[144:147], v[232:235]
    v_mfma_f32_16x16x32_bf16 v[228:231], a[216:219], a[136:139], v[228:231]
    v_mfma_f32_16x16x32_bf16 v[228:231], a[220:223], a[140:143], v[228:231]
    v_mfma_f32_16x16x32_bf16 v[224:227], a[220:223], a[132:135], v[224:227]
    v_mfma_f32_16x16x32_bf16 v[224:227], a[216:219], a[128:131], v[224:227]
    s_waitcnt vmcnt(16) lgkmcnt(0)
    s_barrier
    v_mfma_f32_16x16x32_bf16 v[112:115], a[224:227], v[32:35], v[112:115]
    s_bfe_u32 s28, s100, 0x40018
    ds_read_b64_tr_b16 a[208:209], v90 offset:0
    v_mfma_f32_16x16x32_bf16 v[112:115], a[228:231], v[36:39], v[112:115]
    s_mov_b32 s93, 131072
    ds_read_b64_tr_b16 a[210:211], v90 offset:1024
    v_mfma_f32_16x16x32_bf16 v[116:119], a[228:231], v[44:47], v[116:119]
    buffer_load_dwordx4 a[24:27], v3, s[16:19], s93 offen offset:2048 nt
    v_mfma_f32_16x16x32_bf16 v[116:119], a[224:227], v[40:43], v[116:119]
    s_lshl_b32 s30, s28, 19
    ds_read_b64_tr_b16 a[212:213], v90 offset:8192
    v_mfma_f32_16x16x32_bf16 v[120:123], a[224:227], v[48:51], v[120:123]
    s_lshl_b32 s28, s28, 7
    ds_read_b64_tr_b16 a[214:215], v90 offset:9216
    v_mfma_f32_16x16x32_bf16 v[120:123], a[228:231], v[52:55], v[120:123]
    ds_read_b64_tr_b16 a[216:217], v92 offset:0
    v_mfma_f32_16x16x32_bf16 v[124:127], a[228:231], v[60:63], v[124:127]
    buffer_load_dwordx4 a[28:31], v3, s[16:19], s93 offen offset:3072 nt
    v_mfma_f32_16x16x32_bf16 v[124:127], a[224:227], v[56:59], v[124:127]
    ds_read_b64_tr_b16 a[218:219], v92 offset:1024
    v_mfma_f32_16x16x32_bf16 v[240:243], a[224:227], v[64:67], v[240:243]
    ds_read_b64_tr_b16 a[220:221], v92 offset:8192
    v_mfma_f32_16x16x32_bf16 v[240:243], a[228:231], v[68:71], v[240:243]
    s_mov_b32 s94, 16384
    ds_read_b64_tr_b16 a[222:223], v92 offset:9216
    v_mfma_f32_16x16x32_bf16 v[244:247], a[236:239], v[68:71], v[244:247]
    buffer_load_dwordx4 a[32:35], v2, s[16:19], s94 offen offset:0 nt
    v_mfma_f32_16x16x32_bf16 v[244:247], a[232:235], v[64:67], v[244:247]
    ds_read_b64_tr_b16 a[224:225], v90 offset:256
    v_mfma_f32_16x16x32_bf16 v[140:143], a[232:235], v[56:59], v[140:143]
    ds_read_b64_tr_b16 a[226:227], v90 offset:1280
    v_mfma_f32_16x16x32_bf16 v[140:143], a[236:239], v[60:63], v[140:143]
    s_add_u32 m0, s6, 106496
    ds_read_b64_tr_b16 a[228:229], v90 offset:8448
    v_mfma_f32_16x16x32_bf16 v[136:139], a[236:239], v[52:55], v[136:139]
    buffer_load_dwordx4 v80, s[8:11], s29 offen offset:0 lds
    v_mfma_f32_16x16x32_bf16 v[136:139], a[232:235], v[48:51], v[136:139]
    ds_read_b64_tr_b16 a[230:231], v90 offset:9472
    v_add_u32 v90, 53248, v90
    v_mfma_f32_16x16x32_bf16 v[132:135], a[232:235], v[40:43], v[132:135]
    ds_read_b128 a[128:131], v85 offset:0
    v_mfma_f32_16x16x32_bf16 v[132:135], a[236:239], v[44:47], v[132:135]
    ds_read_b128 a[132:135], v85 offset:256
    v_add_u32 v85, 53248, v85
    v_mfma_f32_16x16x32_bf16 v[128:131], a[236:239], v[36:39], v[128:131]
    s_add_u32 s95, s29, 15360
    ds_read_b128 a[136:139], v86 offset:0
    v_mfma_f32_16x16x32_bf16 v[128:131], a[232:235], v[32:35], v[128:131]
    buffer_load_dwordx4 v81, s[8:11], s95 offen offset:1024 lds
    v_mfma_f32_16x16x32_bf16 v[144:147], a[240:243], v[32:35], v[144:147]
    ds_read_b64_tr_b16 a[232:233], v92 offset:256
    v_mfma_f32_16x16x32_bf16 v[144:147], a[244:247], v[36:39], v[144:147]
    ds_read_b64_tr_b16 a[234:235], v92 offset:1280
    v_mfma_f32_16x16x32_bf16 v[148:151], a[244:247], v[44:47], v[148:151]
    s_add_u32 s96, s29, 30720
    ds_read_b64_tr_b16 a[236:237], v92 offset:8448
    v_mfma_f32_16x16x32_bf16 v[148:151], a[240:243], v[40:43], v[148:151]
    buffer_load_dwordx4 v80, s[8:11], s96 offen offset:2048 lds
    v_mfma_f32_16x16x32_bf16 v[152:155], a[240:243], v[48:51], v[152:155]
    ds_read_b64_tr_b16 a[238:239], v92 offset:9472
    v_add_u32 v92, 53248, v92
    v_mfma_f32_16x16x32_bf16 v[152:155], a[244:247], v[52:55], v[152:155]
    ds_read_b128 a[140:143], v86 offset:256
    v_add_u32 v86, 53248, v86
    v_mfma_f32_16x16x32_bf16 v[156:159], a[244:247], v[60:63], v[156:159]
    s_add_u32 s97, s29, 46080
    ds_read_b128 a[144:147], v87 offset:0
    v_mfma_f32_16x16x32_bf16 v[156:159], a[240:243], v[56:59], v[156:159]
    buffer_load_dwordx4 v81, s[8:11], s97 offen offset:3072 lds
    v_mfma_f32_16x16x32_bf16 v[248:251], a[240:243], v[64:67], v[248:251]
    ds_read_b128 a[148:151], v87 offset:256
    v_add_u32 v87, 53248, v87
    v_mfma_f32_16x16x32_bf16 v[248:251], a[244:247], v[68:71], v[248:251]
    ds_read_b64_tr_b16 a[240:241], v91 offset:0
    v_mfma_f32_16x16x32_bf16 v[252:255], a[252:255], v[68:71], v[252:255]
    s_add_u32 m0, s7, 122880
    ds_read_b64_tr_b16 a[242:243], v91 offset:1024
    v_mfma_f32_16x16x32_bf16 v[252:255], a[248:251], v[64:67], v[252:255]
    s_mov_b32 exec_hi, 0
    buffer_load_dwordx4 v82, s[8:11], s29 offen lds
    s_mov_b32 exec_hi, -1
    v_mfma_f32_16x16x32_bf16 v[172:175], a[248:251], v[56:59], v[172:175]
    ds_read_b64_tr_b16 a[244:245], v91 offset:8192
    v_mfma_f32_16x16x32_bf16 v[172:175], a[252:255], v[60:63], v[172:175]
    ds_read_b64_tr_b16 a[246:247], v91 offset:9216
    v_mfma_f32_16x16x32_bf16 v[168:171], a[252:255], v[52:55], v[168:171]
    ds_read_b128 a[152:155], v88 offset:0
    v_mfma_f32_16x16x32_bf16 v[168:171], a[248:251], v[48:51], v[168:171]
    s_add_u32 m0, s6, 126976
    ds_read_b128 a[156:159], v88 offset:256
    v_add_u32 v88, 53248, v88
    v_mfma_f32_16x16x32_bf16 v[164:167], a[248:251], v[40:43], v[164:167]
    buffer_load_dwordx4 v83, s[12:15], s31 offen offset:0 lds
    v_mfma_f32_16x16x32_bf16 v[164:167], a[252:255], v[44:47], v[164:167]
    ds_read_b128 a[160:163], v89 offset:0
    v_mfma_f32_16x16x32_bf16 v[160:163], a[252:255], v[36:39], v[160:163]
    ds_read_b128 a[164:167], v89 offset:256
    v_add_u32 v89, 53248, v89
    v_mfma_f32_16x16x32_bf16 v[160:163], a[248:251], v[32:35], v[160:163]
    s_add_u32 s90, s31, 31744
    ds_read_b64_tr_b16 a[248:249], v93 offset:0
    v_mfma_f32_16x16x32_bf16 v[176:179], a[176:179], v[32:35], v[176:179]
    buffer_load_dwordx4 v83, s[12:15], s90 offen offset:1024 lds
    v_mfma_f32_16x16x32_bf16 v[176:179], a[180:183], v[36:39], v[176:179]
    ds_read_b64_tr_b16 a[250:251], v93 offset:1024
    v_mfma_f32_16x16x32_bf16 v[180:183], a[180:183], v[44:47], v[180:183]
    ds_read_b64_tr_b16 a[252:253], v93 offset:8192
    v_mfma_f32_16x16x32_bf16 v[180:183], a[176:179], v[40:43], v[180:183]
    s_add_u32 s91, s31, 63488
    ds_read_b64_tr_b16 a[254:255], v93 offset:9216
    v_mfma_f32_16x16x32_bf16 v[184:187], a[176:179], v[48:51], v[184:187]
    buffer_load_dwordx4 v84, s[12:15], s91 offen offset:2048 lds
    v_mfma_f32_16x16x32_bf16 v[184:187], a[180:183], v[52:55], v[184:187]
    v_mfma_f32_16x16x32_bf16 v[188:191], a[180:183], v[60:63], v[188:191]
    v_mfma_f32_16x16x32_bf16 v[188:191], a[176:179], v[56:59], v[188:191]
    s_add_u32 s92, s31, 95232
    ds_read_b64_tr_b16 a[176:177], v91 offset:256
    v_mfma_f32_16x16x32_bf16 v[204:207], a[184:187], v[56:59], v[204:207]
    buffer_load_dwordx4 v84, s[12:15], s92 offen offset:3072 lds
    v_mfma_f32_16x16x32_bf16 v[204:207], a[188:191], v[60:63], v[204:207]
    ds_read_b64_tr_b16 a[178:179], v91 offset:1280
    v_mfma_f32_16x16x32_bf16 v[200:203], a[188:191], v[52:55], v[200:203]
    ds_read_b64_tr_b16 a[180:181], v91 offset:8448
    v_mfma_f32_16x16x32_bf16 v[200:203], a[184:187], v[48:51], v[200:203]
    s_add_u32 s93, s31, 256
    ds_read_b64_tr_b16 a[182:183], v91 offset:9472
    v_add_u32 v91, 53248, v91
    v_mfma_f32_16x16x32_bf16 v[196:199], a[184:187], v[40:43], v[196:199]
    s_add_u32 m0, s6, 143360
    v_mfma_f32_16x16x32_bf16 v[196:199], a[188:191], v[44:47], v[196:199]
    buffer_load_dwordx4 v83, s[12:15], s93 offen offset:0 lds
    v_mfma_f32_16x16x32_bf16 v[192:195], a[188:191], v[36:39], v[192:195]
    v_mfma_f32_16x16x32_bf16 v[192:195], a[184:187], v[32:35], v[192:195]
    ds_read_b64_tr_b16 a[184:185], v93 offset:256
    v_mfma_f32_16x16x32_bf16 v[208:211], a[192:195], v[32:35], v[208:211]
    s_add_u32 s94, s31, 32000
    ds_read_b64_tr_b16 a[186:187], v93 offset:1280
    v_mfma_f32_16x16x32_bf16 v[208:211], a[196:199], v[36:39], v[208:211]
    buffer_load_dwordx4 v83, s[12:15], s94 offen offset:1024 lds
    v_mfma_f32_16x16x32_bf16 v[212:215], a[196:199], v[44:47], v[212:215]
    ds_read_b64_tr_b16 a[188:189], v93 offset:8448
    v_mfma_f32_16x16x32_bf16 v[212:215], a[192:195], v[40:43], v[212:215]
    ds_read_b64_tr_b16 a[190:191], v93 offset:9472
    v_add_u32 v93, 53248, v93
    v_mfma_f32_16x16x32_bf16 v[216:219], a[192:195], v[48:51], v[216:219]
    s_add_u32 s95, s31, 63744
    v_mfma_f32_16x16x32_bf16 v[216:219], a[196:199], v[52:55], v[216:219]
    buffer_load_dwordx4 v84, s[12:15], s95 offen offset:2048 lds
    v_mfma_f32_16x16x32_bf16 v[220:223], a[196:199], v[60:63], v[220:223]
    v_mfma_f32_16x16x32_bf16 v[220:223], a[192:195], v[56:59], v[220:223]
    v_mfma_f32_16x16x32_bf16 v[236:239], a[200:203], v[56:59], v[236:239]
    s_add_u32 s96, s31, 95488
    v_mfma_f32_16x16x32_bf16 v[236:239], a[204:207], v[60:63], v[236:239]
    buffer_load_dwordx4 v84, s[12:15], s96 offen offset:3072 lds
    v_mfma_f32_16x16x32_bf16 v[232:235], a[204:207], v[52:55], v[232:235]
    v_mfma_f32_16x16x32_bf16 v[232:235], a[200:203], v[48:51], v[232:235]
    v_mfma_f32_16x16x32_bf16 v[228:231], a[200:203], v[40:43], v[228:231]
    v_mfma_f32_16x16x32_bf16 v[228:231], a[204:207], v[44:47], v[228:231]
    v_mfma_f32_16x16x32_bf16 v[224:227], a[204:207], v[36:39], v[224:227]
    v_mfma_f32_16x16x32_bf16 v[224:227], a[200:203], v[32:35], v[224:227]
    s_waitcnt vmcnt(16) lgkmcnt(0)
    s_barrier
    v_mfma_f32_16x16x32_bf16 v[112:115], a[208:211], a[128:131], v[112:115]
    s_bfe_u32 s29, s100, 0x4001c
    ds_read_b64_tr_b16 a[192:193], v90 offset:0
    v_mfma_f32_16x16x32_bf16 v[112:115], a[212:215], a[132:135], v[112:115]
    s_mov_b32 s97, 16384
    ds_read_b64_tr_b16 a[194:195], v90 offset:1024
    v_mfma_f32_16x16x32_bf16 v[116:119], a[212:215], a[140:143], v[116:119]
    buffer_load_dwordx4 a[36:39], v2, s[16:19], s97 offen offset:1024 nt
    v_mfma_f32_16x16x32_bf16 v[116:119], a[208:211], a[136:139], v[116:119]
    s_lshl_b32 s31, s29, 19
    ds_read_b64_tr_b16 a[196:197], v90 offset:8192
    v_mfma_f32_16x16x32_bf16 v[120:123], a[208:211], a[144:147], v[120:123]
    s_lshl_b32 s29, s29, 7
    ds_read_b64_tr_b16 a[198:199], v90 offset:9216
    v_mfma_f32_16x16x32_bf16 v[120:123], a[212:215], a[148:151], v[120:123]
    ds_read_b64_tr_b16 a[200:201], v92 offset:0
    v_mfma_f32_16x16x32_bf16 v[124:127], a[212:215], a[156:159], v[124:127]
    buffer_load_dwordx4 a[40:43], v3, s[16:19], s97 offen offset:2048 nt
    v_mfma_f32_16x16x32_bf16 v[124:127], a[208:211], a[152:155], v[124:127]
    ds_read_b64_tr_b16 a[202:203], v92 offset:1024
    v_mfma_f32_16x16x32_bf16 v[240:243], a[208:211], a[160:163], v[240:243]
    ds_read_b64_tr_b16 a[204:205], v92 offset:8192
    v_mfma_f32_16x16x32_bf16 v[240:243], a[212:215], a[164:167], v[240:243]
    ds_read_b64_tr_b16 a[206:207], v92 offset:9216
    v_mfma_f32_16x16x32_bf16 v[244:247], a[220:223], a[164:167], v[244:247]
    buffer_load_dwordx4 a[44:47], v3, s[16:19], s97 offen offset:3072 nt
    v_mfma_f32_16x16x32_bf16 v[244:247], a[216:219], a[160:163], v[244:247]
    ds_read_b64_tr_b16 a[208:209], v90 offset:256
    v_mfma_f32_16x16x32_bf16 v[140:143], a[216:219], a[152:155], v[140:143]
    ds_read_b64_tr_b16 a[210:211], v90 offset:1280
    v_mfma_f32_16x16x32_bf16 v[140:143], a[220:223], a[156:159], v[140:143]
    s_add_u32 m0, s6, 0
    ds_read_b64_tr_b16 a[212:213], v90 offset:8448
    v_mfma_f32_16x16x32_bf16 v[136:139], a[220:223], a[148:151], v[136:139]
    buffer_load_dwordx4 v80, s[8:11], s28 offen offset:0 lds
    v_mfma_f32_16x16x32_bf16 v[136:139], a[216:219], a[144:147], v[136:139]
    ds_read_b64_tr_b16 a[214:215], v90 offset:9472
    v_add_u32 v90, 53248, v90
    v_mfma_f32_16x16x32_bf16 v[132:135], a[216:219], a[136:139], v[132:135]
    ds_read_b128 v[32:35], v85 offset:0
    v_mfma_f32_16x16x32_bf16 v[132:135], a[220:223], a[140:143], v[132:135]
    ds_read_b128 v[36:39], v85 offset:256
    v_add_u32 v85, 53248, v85
    v_mfma_f32_16x16x32_bf16 v[128:131], a[220:223], a[132:135], v[128:131]
    s_add_u32 s90, s28, 15360
    ds_read_b128 v[40:43], v86 offset:0
    v_mfma_f32_16x16x32_bf16 v[128:131], a[216:219], a[128:131], v[128:131]
    buffer_load_dwordx4 v81, s[8:11], s90 offen offset:1024 lds
    v_mfma_f32_16x16x32_bf16 v[144:147], a[224:227], a[128:131], v[144:147]
    ds_read_b64_tr_b16 a[216:217], v92 offset:256
    v_mfma_f32_16x16x32_bf16 v[144:147], a[228:231], a[132:135], v[144:147]
    ds_read_b64_tr_b16 a[218:219], v92 offset:1280
    v_mfma_f32_16x16x32_bf16 v[148:151], a[228:231], a[140:143], v[148:151]
    s_add_u32 s91, s28, 30720
    ds_read_b64_tr_b16 a[220:221], v92 offset:8448
    v_mfma_f32_16x16x32_bf16 v[148:151], a[224:227], a[136:139], v[148:151]
    buffer_load_dwordx4 v80, s[8:11], s91 offen offset:2048 lds
    v_mfma_f32_16x16x32_bf16 v[152:155], a[224:227], a[144:147], v[152:155]
    ds_read_b64_tr_b16 a[222:223], v92 offset:9472
    v_add_u32 v92, 53248, v92
    v_mfma_f32_16x16x32_bf16 v[152:155], a[228:231], a[148:151], v[152:155]
    ds_read_b128 v[44:47], v86 offset:256
    v_add_u32 v86, 53248, v86
    v_mfma_f32_16x16x32_bf16 v[156:159], a[228:231], a[156:159], v[156:159]
    s_add_u32 s92, s28, 46080
    ds_read_b128 v[48:51], v87 offset:0
    v_mfma_f32_16x16x32_bf16 v[156:159], a[224:227], a[152:155], v[156:159]
    buffer_load_dwordx4 v81, s[8:11], s92 offen offset:3072 lds
    v_mfma_f32_16x16x32_bf16 v[248:251], a[224:227], a[160:163], v[248:251]
    ds_read_b128 v[52:55], v87 offset:256
    v_add_u32 v87, 53248, v87
    v_mfma_f32_16x16x32_bf16 v[248:251], a[228:231], a[164:167], v[248:251]
    ds_read_b64_tr_b16 a[224:225], v91 offset:0
    v_mfma_f32_16x16x32_bf16 v[252:255], a[236:239], a[164:167], v[252:255]
    s_add_u32 m0, s7, 16384
    ds_read_b64_tr_b16 a[226:227], v91 offset:1024
    v_mfma_f32_16x16x32_bf16 v[252:255], a[232:235], a[160:163], v[252:255]
    s_mov_b32 exec_hi, 0
    buffer_load_dwordx4 v82, s[8:11], s28 offen lds
    s_mov_b32 exec_hi, -1
    v_mfma_f32_16x16x32_bf16 v[172:175], a[232:235], a[152:155], v[172:175]
    ds_read_b64_tr_b16 a[228:229], v91 offset:8192
    v_mfma_f32_16x16x32_bf16 v[172:175], a[236:239], a[156:159], v[172:175]
    ds_read_b64_tr_b16 a[230:231], v91 offset:9216
    v_mfma_f32_16x16x32_bf16 v[168:171], a[236:239], a[148:151], v[168:171]
    ds_read_b128 v[56:59], v88 offset:0
    v_mfma_f32_16x16x32_bf16 v[168:171], a[232:235], a[144:147], v[168:171]
    s_add_u32 m0, s6, 20480
    ds_read_b128 v[60:63], v88 offset:256
    v_add_u32 v88, 53248, v88
    v_mfma_f32_16x16x32_bf16 v[164:167], a[232:235], a[136:139], v[164:167]
    buffer_load_dwordx4 v83, s[12:15], s30 offen offset:0 lds
    v_mfma_f32_16x16x32_bf16 v[164:167], a[236:239], a[140:143], v[164:167]
    ds_read_b128 v[64:67], v89 offset:0
    v_mfma_f32_16x16x32_bf16 v[160:163], a[236:239], a[132:135], v[160:163]
    ds_read_b128 v[68:71], v89 offset:256
    v_add_u32 v89, 53248, v89
    v_mfma_f32_16x16x32_bf16 v[160:163], a[232:235], a[128:131], v[160:163]
    s_add_u32 s93, s30, 31744
    ds_read_b64_tr_b16 a[232:233], v93 offset:0
    v_mfma_f32_16x16x32_bf16 v[176:179], a[240:243], a[128:131], v[176:179]
    buffer_load_dwordx4 v83, s[12:15], s93 offen offset:1024 lds
    v_mfma_f32_16x16x32_bf16 v[176:179], a[244:247], a[132:135], v[176:179]
    ds_read_b64_tr_b16 a[234:235], v93 offset:1024
    v_mfma_f32_16x16x32_bf16 v[180:183], a[244:247], a[140:143], v[180:183]
    ds_read_b64_tr_b16 a[236:237], v93 offset:8192
    v_mfma_f32_16x16x32_bf16 v[180:183], a[240:243], a[136:139], v[180:183]
    s_add_u32 s94, s30, 63488
    ds_read_b64_tr_b16 a[238:239], v93 offset:9216
    v_mfma_f32_16x16x32_bf16 v[184:187], a[240:243], a[144:147], v[184:187]
    buffer_load_dwordx4 v84, s[12:15], s94 offen offset:2048 lds
    v_mfma_f32_16x16x32_bf16 v[184:187], a[244:247], a[148:151], v[184:187]
    v_mfma_f32_16x16x32_bf16 v[188:191], a[244:247], a[156:159], v[188:191]
    v_mfma_f32_16x16x32_bf16 v[188:191], a[240:243], a[152:155], v[188:191]
    s_add_u32 s95, s30, 95232
    ds_read_b64_tr_b16 a[240:241], v91 offset:256
    v_mfma_f32_16x16x32_bf16 v[204:207], a[248:251], a[152:155], v[204:207]
    buffer_load_dwordx4 v84, s[12:15], s95 offen offset:3072 lds
    v_mfma_f32_16x16x32_bf16 v[204:207], a[252:255], a[156:159], v[204:207]
    ds_read_b64_tr_b16 a[242:243], v91 offset:1280
    v_mfma_f32_16x16x32_bf16 v[200:203], a[252:255], a[148:151], v[200:203]
    ds_read_b64_tr_b16 a[244:245], v91 offset:8448
    v_mfma_f32_16x16x32_bf16 v[200:203], a[248:251], a[144:147], v[200:203]
    s_add_u32 s96, s30, 256
    ds_read_b64_tr_b16 a[246:247], v91 offset:9472
    v_add_u32 v91, 53248, v91
    v_mfma_f32_16x16x32_bf16 v[196:199], a[248:251], a[136:139], v[196:199]
    s_add_u32 m0, s6, 36864
    v_mfma_f32_16x16x32_bf16 v[196:199], a[252:255], a[140:143], v[196:199]
    buffer_load_dwordx4 v83, s[12:15], s96 offen offset:0 lds
    v_mfma_f32_16x16x32_bf16 v[192:195], a[252:255], a[132:135], v[192:195]
    v_mfma_f32_16x16x32_bf16 v[192:195], a[248:251], a[128:131], v[192:195]
    ds_read_b64_tr_b16 a[248:249], v93 offset:256
    v_mfma_f32_16x16x32_bf16 v[208:211], a[176:179], a[128:131], v[208:211]
    s_add_u32 s97, s30, 32000
    ds_read_b64_tr_b16 a[250:251], v93 offset:1280
    v_mfma_f32_16x16x32_bf16 v[208:211], a[180:183], a[132:135], v[208:211]
    buffer_load_dwordx4 v83, s[12:15], s97 offen offset:1024 lds
    v_mfma_f32_16x16x32_bf16 v[212:215], a[180:183], a[140:143], v[212:215]
    ds_read_b64_tr_b16 a[252:253], v93 offset:8448
    v_mfma_f32_16x16x32_bf16 v[212:215], a[176:179], a[136:139], v[212:215]
    ds_read_b64_tr_b16 a[254:255], v93 offset:9472
    v_add_u32 v93, 53248, v93
    v_mfma_f32_16x16x32_bf16 v[216:219], a[176:179], a[144:147], v[216:219]
    s_add_u32 s90, s30, 63744
    v_mfma_f32_16x16x32_bf16 v[216:219], a[180:183], a[148:151], v[216:219]
    buffer_load_dwordx4 v84, s[12:15], s90 offen offset:2048 lds
    v_mfma_f32_16x16x32_bf16 v[220:223], a[180:183], a[156:159], v[220:223]
    v_mfma_f32_16x16x32_bf16 v[220:223], a[176:179], a[152:155], v[220:223]
    v_mfma_f32_16x16x32_bf16 v[236:239], a[184:187], a[152:155], v[236:239]
    s_add_u32 s91, s30, 95488
    v_mfma_f32_16x16x32_bf16 v[236:239], a[188:191], a[156:159], v[236:239]
    buffer_load_dwordx4 v84, s[12:15], s91 offen offset:3072 lds
    v_mfma_f32_16x16x32_bf16 v[232:235], a[188:191], a[148:151], v[232:235]
    v_mfma_f32_16x16x32_bf16 v[232:235], a[184:187], a[144:147], v[232:235]
    v_mfma_f32_16x16x32_bf16 v[228:231], a[184:187], a[136:139], v[228:231]
    v_mfma_f32_16x16x32_bf16 v[228:231], a[188:191], a[140:143], v[228:231]
    v_mfma_f32_16x16x32_bf16 v[224:227], a[188:191], a[132:135], v[224:227]
    v_mfma_f32_16x16x32_bf16 v[224:227], a[184:187], a[128:131], v[224:227]
    s_waitcnt vmcnt(16) lgkmcnt(0)
    s_barrier
    v_mfma_f32_16x16x32_bf16 v[112:115], a[192:195], v[32:35], v[112:115]
    s_bfe_u32 s28, s101, 0x40000
    ds_read_b64_tr_b16 a[176:177], v90 offset:0
    v_mfma_f32_16x16x32_bf16 v[112:115], a[196:199], v[36:39], v[112:115]
    s_mov_b32 s92, 147456
    ds_read_b64_tr_b16 a[178:179], v90 offset:1024
    v_mfma_f32_16x16x32_bf16 v[116:119], a[196:199], v[44:47], v[116:119]
    buffer_load_dwordx4 a[48:51], v2, s[16:19], s92 offen offset:0 nt
    v_mfma_f32_16x16x32_bf16 v[116:119], a[192:195], v[40:43], v[116:119]
    s_lshl_b32 s30, s28, 19
    ds_read_b64_tr_b16 a[180:181], v90 offset:8192
    v_mfma_f32_16x16x32_bf16 v[120:123], a[192:195], v[48:51], v[120:123]
    s_lshl_b32 s28, s28, 7
    ds_read_b64_tr_b16 a[182:183], v90 offset:9216
    v_mfma_f32_16x16x32_bf16 v[120:123], a[196:199], v[52:55], v[120:123]
    ds_read_b64_tr_b16 a[184:185], v92 offset:0
    v_mfma_f32_16x16x32_bf16 v[124:127], a[196:199], v[60:63], v[124:127]
    buffer_load_dwordx4 a[52:55], v2, s[16:19], s92 offen offset:1024 nt
    v_mfma_f32_16x16x32_bf16 v[124:127], a[192:195], v[56:59], v[124:127]
    ds_read_b64_tr_b16 a[186:187], v92 offset:1024
    v_mfma_f32_16x16x32_bf16 v[240:243], a[192:195], v[64:67], v[240:243]
    ds_read_b64_tr_b16 a[188:189], v92 offset:8192
    v_mfma_f32_16x16x32_bf16 v[240:243], a[196:199], v[68:71], v[240:243]
    ds_read_b64_tr_b16 a[190:191], v92 offset:9216
    v_mfma_f32_16x16x32_bf16 v[244:247], a[204:207], v[68:71], v[244:247]
    buffer_load_dwordx4 a[56:59], v3, s[16:19], s92 offen offset:2048 nt
    v_mfma_f32_16x16x32_bf16 v[244:247], a[200:203], v[64:67], v[244:247]
    ds_read_b64_tr_b16 a[192:193], v90 offset:256
    v_mfma_f32_16x16x32_bf16 v[140:143], a[200:203], v[56:59], v[140:143]
    ds_read_b64_tr_b16 a[194:195], v90 offset:1280
    v_mfma_f32_16x16x32_bf16 v[140:143], a[204:207], v[60:63], v[140:143]
    s_add_u32 m0, s6, 53248
    ds_read_b64_tr_b16 a[196:197], v90 offset:8448
    v_mfma_f32_16x16x32_bf16 v[136:139], a[204:207], v[52:55], v[136:139]
    buffer_load_dwordx4 v80, s[8:11], s29 offen offset:0 lds
    v_mfma_f32_16x16x32_bf16 v[136:139], a[200:203], v[48:51], v[136:139]
    ds_read_b64_tr_b16 a[198:199], v90 offset:9472
    v_add_u32 v90, 4294860800, v90
    v_mfma_f32_16x16x32_bf16 v[132:135], a[200:203], v[40:43], v[132:135]
    ds_read_b128 a[128:131], v85 offset:0
    v_mfma_f32_16x16x32_bf16 v[132:135], a[204:207], v[44:47], v[132:135]
    ds_read_b128 a[132:135], v85 offset:256
    v_add_u32 v85, 4294860800, v85
    v_mfma_f32_16x16x32_bf16 v[128:131], a[204:207], v[36:39], v[128:131]
    s_add_u32 s93, s29, 15360
    ds_read_b128 a[136:139], v86 offset:0
    v_mfma_f32_16x16x32_bf16 v[128:131], a[200:203], v[32:35], v[128:131]
    buffer_load_dwordx4 v81, s[8:11], s93 offen offset:1024 lds
    v_mfma_f32_16x16x32_bf16 v[144:147], a[208:211], v[32:35], v[144:147]
    ds_read_b64_tr_b16 a[200:201], v92 offset:256
    v_mfma_f32_16x16x32_bf16 v[144:147], a[212:215], v[36:39], v[144:147]
    ds_read_b64_tr_b16 a[202:203], v92 offset:1280
    v_mfma_f32_16x16x32_bf16 v[148:151], a[212:215], v[44:47], v[148:151]
    s_add_u32 s94, s29, 30720
    ds_read_b64_tr_b16 a[204:205], v92 offset:8448
    v_mfma_f32_16x16x32_bf16 v[148:151], a[208:211], v[40:43], v[148:151]
    buffer_load_dwordx4 v80, s[8:11], s94 offen offset:2048 lds
    v_mfma_f32_16x16x32_bf16 v[152:155], a[208:211], v[48:51], v[152:155]
    ds_read_b64_tr_b16 a[206:207], v92 offset:9472
    v_add_u32 v92, 4294860800, v92
    v_mfma_f32_16x16x32_bf16 v[152:155], a[212:215], v[52:55], v[152:155]
    ds_read_b128 a[140:143], v86 offset:256
    v_add_u32 v86, 4294860800, v86
    v_mfma_f32_16x16x32_bf16 v[156:159], a[212:215], v[60:63], v[156:159]
    s_add_u32 s95, s29, 46080
    ds_read_b128 a[144:147], v87 offset:0
    v_mfma_f32_16x16x32_bf16 v[156:159], a[208:211], v[56:59], v[156:159]
    buffer_load_dwordx4 v81, s[8:11], s95 offen offset:3072 lds
    v_mfma_f32_16x16x32_bf16 v[248:251], a[208:211], v[64:67], v[248:251]
    ds_read_b128 a[148:151], v87 offset:256
    v_add_u32 v87, 4294860800, v87
    v_mfma_f32_16x16x32_bf16 v[248:251], a[212:215], v[68:71], v[248:251]
    ds_read_b64_tr_b16 a[208:209], v91 offset:0
    v_mfma_f32_16x16x32_bf16 v[252:255], a[220:223], v[68:71], v[252:255]
    s_add_u32 m0, s7, 69632
    ds_read_b64_tr_b16 a[210:211], v91 offset:1024
    v_mfma_f32_16x16x32_bf16 v[252:255], a[216:219], v[64:67], v[252:255]
    s_mov_b32 exec_hi, 0
    buffer_load_dwordx4 v82, s[8:11], s29 offen lds
    s_mov_b32 exec_hi, -1
    v_mfma_f32_16x16x32_bf16 v[172:175], a[216:219], v[56:59], v[172:175]
    ds_read_b64_tr_b16 a[212:213], v91 offset:8192
    v_mfma_f32_16x16x32_bf16 v[172:175], a[220:223], v[60:63], v[172:175]
    ds_read_b64_tr_b16 a[214:215], v91 offset:9216
    v_mfma_f32_16x16x32_bf16 v[168:171], a[220:223], v[52:55], v[168:171]
    ds_read_b128 a[152:155], v88 offset:0
    v_mfma_f32_16x16x32_bf16 v[168:171], a[216:219], v[48:51], v[168:171]
    s_add_u32 m0, s6, 73728
    ds_read_b128 a[156:159], v88 offset:256
    v_add_u32 v88, 4294860800, v88
    v_mfma_f32_16x16x32_bf16 v[164:167], a[216:219], v[40:43], v[164:167]
    buffer_load_dwordx4 v83, s[12:15], s31 offen offset:0 lds
    v_mfma_f32_16x16x32_bf16 v[164:167], a[220:223], v[44:47], v[164:167]
    ds_read_b128 a[160:163], v89 offset:0
    v_mfma_f32_16x16x32_bf16 v[160:163], a[220:223], v[36:39], v[160:163]
    ds_read_b128 a[164:167], v89 offset:256
    v_add_u32 v89, 4294860800, v89
    v_mfma_f32_16x16x32_bf16 v[160:163], a[216:219], v[32:35], v[160:163]
    s_add_u32 s96, s31, 31744
    ds_read_b64_tr_b16 a[216:217], v93 offset:0
    v_mfma_f32_16x16x32_bf16 v[176:179], a[224:227], v[32:35], v[176:179]
    buffer_load_dwordx4 v83, s[12:15], s96 offen offset:1024 lds
    v_mfma_f32_16x16x32_bf16 v[176:179], a[228:231], v[36:39], v[176:179]
    ds_read_b64_tr_b16 a[218:219], v93 offset:1024
    v_mfma_f32_16x16x32_bf16 v[180:183], a[228:231], v[44:47], v[180:183]
    ds_read_b64_tr_b16 a[220:221], v93 offset:8192
    v_mfma_f32_16x16x32_bf16 v[180:183], a[224:227], v[40:43], v[180:183]
    s_add_u32 s97, s31, 63488
    ds_read_b64_tr_b16 a[222:223], v93 offset:9216
    v_mfma_f32_16x16x32_bf16 v[184:187], a[224:227], v[48:51], v[184:187]
    buffer_load_dwordx4 v84, s[12:15], s97 offen offset:2048 lds
    v_mfma_f32_16x16x32_bf16 v[184:187], a[228:231], v[52:55], v[184:187]
    v_mfma_f32_16x16x32_bf16 v[188:191], a[228:231], v[60:63], v[188:191]
    v_mfma_f32_16x16x32_bf16 v[188:191], a[224:227], v[56:59], v[188:191]
    s_add_u32 s90, s31, 95232
    ds_read_b64_tr_b16 a[224:225], v91 offset:256
    v_mfma_f32_16x16x32_bf16 v[204:207], a[232:235], v[56:59], v[204:207]
    buffer_load_dwordx4 v84, s[12:15], s90 offen offset:3072 lds
    v_mfma_f32_16x16x32_bf16 v[204:207], a[236:239], v[60:63], v[204:207]
    ds_read_b64_tr_b16 a[226:227], v91 offset:1280
    v_mfma_f32_16x16x32_bf16 v[200:203], a[236:239], v[52:55], v[200:203]
    ds_read_b64_tr_b16 a[228:229], v91 offset:8448
    v_mfma_f32_16x16x32_bf16 v[200:203], a[232:235], v[48:51], v[200:203]
    s_add_u32 s91, s31, 256
    ds_read_b64_tr_b16 a[230:231], v91 offset:9472
    v_add_u32 v91, 4294860800, v91
    v_mfma_f32_16x16x32_bf16 v[196:199], a[232:235], v[40:43], v[196:199]
    s_add_u32 m0, s6, 90112
    v_mfma_f32_16x16x32_bf16 v[196:199], a[236:239], v[44:47], v[196:199]
    buffer_load_dwordx4 v83, s[12:15], s91 offen offset:0 lds
    v_mfma_f32_16x16x32_bf16 v[192:195], a[236:239], v[36:39], v[192:195]
    v_mfma_f32_16x16x32_bf16 v[192:195], a[232:235], v[32:35], v[192:195]
    ds_read_b64_tr_b16 a[232:233], v93 offset:256
    v_mfma_f32_16x16x32_bf16 v[208:211], a[240:243], v[32:35], v[208:211]
    s_add_u32 s92, s31, 32000
    ds_read_b64_tr_b16 a[234:235], v93 offset:1280
    v_mfma_f32_16x16x32_bf16 v[208:211], a[244:247], v[36:39], v[208:211]
    buffer_load_dwordx4 v83, s[12:15], s92 offen offset:1024 lds
    v_mfma_f32_16x16x32_bf16 v[212:215], a[244:247], v[44:47], v[212:215]
    ds_read_b64_tr_b16 a[236:237], v93 offset:8448
    v_mfma_f32_16x16x32_bf16 v[212:215], a[240:243], v[40:43], v[212:215]
    ds_read_b64_tr_b16 a[238:239], v93 offset:9472
    v_add_u32 v93, 4294860800, v93
    v_mfma_f32_16x16x32_bf16 v[216:219], a[240:243], v[48:51], v[216:219]
    s_add_u32 s93, s31, 63744
    v_mfma_f32_16x16x32_bf16 v[216:219], a[244:247], v[52:55], v[216:219]
    buffer_load_dwordx4 v84, s[12:15], s93 offen offset:2048 lds
    v_mfma_f32_16x16x32_bf16 v[220:223], a[244:247], v[60:63], v[220:223]
    v_mfma_f32_16x16x32_bf16 v[220:223], a[240:243], v[56:59], v[220:223]
    v_mfma_f32_16x16x32_bf16 v[236:239], a[248:251], v[56:59], v[236:239]
    s_add_u32 s94, s31, 95488
    v_mfma_f32_16x16x32_bf16 v[236:239], a[252:255], v[60:63], v[236:239]
    buffer_load_dwordx4 v84, s[12:15], s94 offen offset:3072 lds
    v_mfma_f32_16x16x32_bf16 v[232:235], a[252:255], v[52:55], v[232:235]
    v_mfma_f32_16x16x32_bf16 v[232:235], a[248:251], v[48:51], v[232:235]
    v_mfma_f32_16x16x32_bf16 v[228:231], a[248:251], v[40:43], v[228:231]
    v_mfma_f32_16x16x32_bf16 v[228:231], a[252:255], v[44:47], v[228:231]
    v_mfma_f32_16x16x32_bf16 v[224:227], a[252:255], v[36:39], v[224:227]
    v_mfma_f32_16x16x32_bf16 v[224:227], a[248:251], v[32:35], v[224:227]
    s_waitcnt vmcnt(16) lgkmcnt(0)
    s_barrier
    v_mfma_f32_16x16x32_bf16 v[112:115], a[176:179], a[128:131], v[112:115]
    s_bfe_u32 s29, s101, 0x40004
    ds_read_b64_tr_b16 a[240:241], v90 offset:0
    v_mfma_f32_16x16x32_bf16 v[112:115], a[180:183], a[132:135], v[112:115]
    s_mov_b32 s95, 147456
    ds_read_b64_tr_b16 a[242:243], v90 offset:1024
    v_mfma_f32_16x16x32_bf16 v[116:119], a[180:183], a[140:143], v[116:119]
    buffer_load_dwordx4 a[60:63], v3, s[16:19], s95 offen offset:3072 nt
    v_mfma_f32_16x16x32_bf16 v[116:119], a[176:179], a[136:139], v[116:119]
    s_lshl_b32 s31, s29, 19
    ds_read_b64_tr_b16 a[244:245], v90 offset:8192
    v_mfma_f32_16x16x32_bf16 v[120:123], a[176:179], a[144:147], v[120:123]
    s_lshl_b32 s29, s29, 7
    ds_read_b64_tr_b16 a[246:247], v90 offset:9216
    v_mfma_f32_16x16x32_bf16 v[120:123], a[180:183], a[148:151], v[120:123]
    ds_read_b64_tr_b16 a[248:249], v92 offset:0
    v_mfma_f32_16x16x32_bf16 v[124:127], a[180:183], a[156:159], v[124:127]
    buffer_load_dwordx4 a[64:67], v4, s[20:23], 0 offen offset:0 nt
    v_mfma_f32_16x16x32_bf16 v[124:127], a[176:179], a[152:155], v[124:127]
    ds_read_b64_tr_b16 a[250:251], v92 offset:1024
    v_mfma_f32_16x16x32_bf16 v[240:243], a[176:179], a[160:163], v[240:243]
    ds_read_b64_tr_b16 a[252:253], v92 offset:8192
    v_mfma_f32_16x16x32_bf16 v[240:243], a[180:183], a[164:167], v[240:243]
    ds_read_b64_tr_b16 a[254:255], v92 offset:9216
    v_mfma_f32_16x16x32_bf16 v[244:247], a[188:191], a[164:167], v[244:247]
    buffer_load_dwordx4 a[68:71], v5, s[20:23], 0 offen offset:1024 nt
    v_mfma_f32_16x16x32_bf16 v[244:247], a[184:187], a[160:163], v[244:247]
    ds_read_b64_tr_b16 a[176:177], v90 offset:256
    v_mfma_f32_16x16x32_bf16 v[140:143], a[184:187], a[152:155], v[140:143]
    ds_read_b64_tr_b16 a[178:179], v90 offset:1280
    v_mfma_f32_16x16x32_bf16 v[140:143], a[188:191], a[156:159], v[140:143]
    s_add_u32 m0, s6, 106496
    ds_read_b64_tr_b16 a[180:181], v90 offset:8448
    v_mfma_f32_16x16x32_bf16 v[136:139], a[188:191], a[148:151], v[136:139]
    buffer_load_dwordx4 v80, s[8:11], s28 offen offset:0 lds
    v_mfma_f32_16x16x32_bf16 v[136:139], a[184:187], a[144:147], v[136:139]
    ds_read_b64_tr_b16 a[182:183], v90 offset:9472
    v_add_u32 v90, 53248, v90
    v_mfma_f32_16x16x32_bf16 v[132:135], a[184:187], a[136:139], v[132:135]
    ds_read_b128 v[32:35], v85 offset:0
    v_mfma_f32_16x16x32_bf16 v[132:135], a[188:191], a[140:143], v[132:135]
    ds_read_b128 v[36:39], v85 offset:256
    v_add_u32 v85, 53248, v85
    v_mfma_f32_16x16x32_bf16 v[128:131], a[188:191], a[132:135], v[128:131]
    s_add_u32 s96, s28, 15360
    ds_read_b128 v[40:43], v86 offset:0
    v_mfma_f32_16x16x32_bf16 v[128:131], a[184:187], a[128:131], v[128:131]
    buffer_load_dwordx4 v81, s[8:11], s96 offen offset:1024 lds
    v_mfma_f32_16x16x32_bf16 v[144:147], a[192:195], a[128:131], v[144:147]
    ds_read_b64_tr_b16 a[184:185], v92 offset:256
    v_mfma_f32_16x16x32_bf16 v[144:147], a[196:199], a[132:135], v[144:147]
    ds_read_b64_tr_b16 a[186:187], v92 offset:1280
    v_mfma_f32_16x16x32_bf16 v[148:151], a[196:199], a[140:143], v[148:151]
    s_add_u32 s97, s28, 30720
    ds_read_b64_tr_b16 a[188:189], v92 offset:8448
    v_mfma_f32_16x16x32_bf16 v[148:151], a[192:195], a[136:139], v[148:151]
    buffer_load_dwordx4 v80, s[8:11], s97 offen offset:2048 lds
    v_mfma_f32_16x16x32_bf16 v[152:155], a[192:195], a[144:147], v[152:155]
    ds_read_b64_tr_b16 a[190:191], v92 offset:9472
    v_add_u32 v92, 53248, v92
    v_mfma_f32_16x16x32_bf16 v[152:155], a[196:199], a[148:151], v[152:155]
    ds_read_b128 v[44:47], v86 offset:256
    v_add_u32 v86, 53248, v86
    v_mfma_f32_16x16x32_bf16 v[156:159], a[196:199], a[156:159], v[156:159]
    s_add_u32 s90, s28, 46080
    ds_read_b128 v[48:51], v87 offset:0
    v_mfma_f32_16x16x32_bf16 v[156:159], a[192:195], a[152:155], v[156:159]
    buffer_load_dwordx4 v81, s[8:11], s90 offen offset:3072 lds
    v_mfma_f32_16x16x32_bf16 v[248:251], a[192:195], a[160:163], v[248:251]
    ds_read_b128 v[52:55], v87 offset:256
    v_add_u32 v87, 53248, v87
    v_mfma_f32_16x16x32_bf16 v[248:251], a[196:199], a[164:167], v[248:251]
    ds_read_b64_tr_b16 a[192:193], v91 offset:0
    v_mfma_f32_16x16x32_bf16 v[252:255], a[204:207], a[164:167], v[252:255]
    s_add_u32 m0, s7, 122880
    ds_read_b64_tr_b16 a[194:195], v91 offset:1024
    v_mfma_f32_16x16x32_bf16 v[252:255], a[200:203], a[160:163], v[252:255]
    s_mov_b32 exec_hi, 0
    buffer_load_dwordx4 v82, s[8:11], s28 offen lds
    s_mov_b32 exec_hi, -1
    v_mfma_f32_16x16x32_bf16 v[172:175], a[200:203], a[152:155], v[172:175]
    ds_read_b64_tr_b16 a[196:197], v91 offset:8192
    v_mfma_f32_16x16x32_bf16 v[172:175], a[204:207], a[156:159], v[172:175]
    ds_read_b64_tr_b16 a[198:199], v91 offset:9216
    v_mfma_f32_16x16x32_bf16 v[168:171], a[204:207], a[148:151], v[168:171]
    ds_read_b128 v[56:59], v88 offset:0
    v_mfma_f32_16x16x32_bf16 v[168:171], a[200:203], a[144:147], v[168:171]
    s_add_u32 m0, s6, 126976
    ds_read_b128 v[60:63], v88 offset:256
    v_add_u32 v88, 53248, v88
    v_mfma_f32_16x16x32_bf16 v[164:167], a[200:203], a[136:139], v[164:167]
    buffer_load_dwordx4 v83, s[12:15], s30 offen offset:0 lds
    v_mfma_f32_16x16x32_bf16 v[164:167], a[204:207], a[140:143], v[164:167]
    ds_read_b128 v[64:67], v89 offset:0
    v_mfma_f32_16x16x32_bf16 v[160:163], a[204:207], a[132:135], v[160:163]
    ds_read_b128 v[68:71], v89 offset:256
    v_add_u32 v89, 53248, v89
    v_mfma_f32_16x16x32_bf16 v[160:163], a[200:203], a[128:131], v[160:163]
    s_add_u32 s91, s30, 31744
    ds_read_b64_tr_b16 a[200:201], v93 offset:0
    v_mfma_f32_16x16x32_bf16 v[176:179], a[208:211], a[128:131], v[176:179]
    buffer_load_dwordx4 v83, s[12:15], s91 offen offset:1024 lds
    v_mfma_f32_16x16x32_bf16 v[176:179], a[212:215], a[132:135], v[176:179]
    ds_read_b64_tr_b16 a[202:203], v93 offset:1024
    v_mfma_f32_16x16x32_bf16 v[180:183], a[212:215], a[140:143], v[180:183]
    ds_read_b64_tr_b16 a[204:205], v93 offset:8192
    v_mfma_f32_16x16x32_bf16 v[180:183], a[208:211], a[136:139], v[180:183]
    s_add_u32 s92, s30, 63488
    ds_read_b64_tr_b16 a[206:207], v93 offset:9216
    v_mfma_f32_16x16x32_bf16 v[184:187], a[208:211], a[144:147], v[184:187]
    buffer_load_dwordx4 v84, s[12:15], s92 offen offset:2048 lds
    v_mfma_f32_16x16x32_bf16 v[184:187], a[212:215], a[148:151], v[184:187]
    v_mfma_f32_16x16x32_bf16 v[188:191], a[212:215], a[156:159], v[188:191]
    v_mfma_f32_16x16x32_bf16 v[188:191], a[208:211], a[152:155], v[188:191]
    s_add_u32 s93, s30, 95232
    ds_read_b64_tr_b16 a[208:209], v91 offset:256
    v_mfma_f32_16x16x32_bf16 v[204:207], a[216:219], a[152:155], v[204:207]
    buffer_load_dwordx4 v84, s[12:15], s93 offen offset:3072 lds
    v_mfma_f32_16x16x32_bf16 v[204:207], a[220:223], a[156:159], v[204:207]
    ds_read_b64_tr_b16 a[210:211], v91 offset:1280
    v_mfma_f32_16x16x32_bf16 v[200:203], a[220:223], a[148:151], v[200:203]
    ds_read_b64_tr_b16 a[212:213], v91 offset:8448
    v_mfma_f32_16x16x32_bf16 v[200:203], a[216:219], a[144:147], v[200:203]
    s_add_u32 s94, s30, 256
    ds_read_b64_tr_b16 a[214:215], v91 offset:9472
    v_add_u32 v91, 53248, v91
    v_mfma_f32_16x16x32_bf16 v[196:199], a[216:219], a[136:139], v[196:199]
    s_add_u32 m0, s6, 143360
    v_mfma_f32_16x16x32_bf16 v[196:199], a[220:223], a[140:143], v[196:199]
    buffer_load_dwordx4 v83, s[12:15], s94 offen offset:0 lds
    v_mfma_f32_16x16x32_bf16 v[192:195], a[220:223], a[132:135], v[192:195]
    v_mfma_f32_16x16x32_bf16 v[192:195], a[216:219], a[128:131], v[192:195]
    ds_read_b64_tr_b16 a[216:217], v93 offset:256
    v_mfma_f32_16x16x32_bf16 v[208:211], a[224:227], a[128:131], v[208:211]
    s_add_u32 s95, s30, 32000
    ds_read_b64_tr_b16 a[218:219], v93 offset:1280
    v_mfma_f32_16x16x32_bf16 v[208:211], a[228:231], a[132:135], v[208:211]
    buffer_load_dwordx4 v83, s[12:15], s95 offen offset:1024 lds
    v_mfma_f32_16x16x32_bf16 v[212:215], a[228:231], a[140:143], v[212:215]
    ds_read_b64_tr_b16 a[220:221], v93 offset:8448
    v_mfma_f32_16x16x32_bf16 v[212:215], a[224:227], a[136:139], v[212:215]
    ds_read_b64_tr_b16 a[222:223], v93 offset:9472
    v_add_u32 v93, 53248, v93
    v_mfma_f32_16x16x32_bf16 v[216:219], a[224:227], a[144:147], v[216:219]
    s_add_u32 s96, s30, 63744
    v_mfma_f32_16x16x32_bf16 v[216:219], a[228:231], a[148:151], v[216:219]
    buffer_load_dwordx4 v84, s[12:15], s96 offen offset:2048 lds
    v_mfma_f32_16x16x32_bf16 v[220:223], a[228:231], a[156:159], v[220:223]
    v_mfma_f32_16x16x32_bf16 v[220:223], a[224:227], a[152:155], v[220:223]
    v_mfma_f32_16x16x32_bf16 v[236:239], a[232:235], a[152:155], v[236:239]
    s_add_u32 s97, s30, 95488
    v_mfma_f32_16x16x32_bf16 v[236:239], a[236:239], a[156:159], v[236:239]
    buffer_load_dwordx4 v84, s[12:15], s97 offen offset:3072 lds
    v_mfma_f32_16x16x32_bf16 v[232:235], a[236:239], a[148:151], v[232:235]
    v_mfma_f32_16x16x32_bf16 v[232:235], a[232:235], a[144:147], v[232:235]
    v_mfma_f32_16x16x32_bf16 v[228:231], a[232:235], a[136:139], v[228:231]
    v_mfma_f32_16x16x32_bf16 v[228:231], a[236:239], a[140:143], v[228:231]
    v_mfma_f32_16x16x32_bf16 v[224:227], a[236:239], a[132:135], v[224:227]
    v_mfma_f32_16x16x32_bf16 v[224:227], a[232:235], a[128:131], v[224:227]
    s_waitcnt vmcnt(16) lgkmcnt(0)
    s_barrier
    v_mfma_f32_16x16x32_bf16 v[112:115], a[240:243], v[32:35], v[112:115]
    s_bfe_u32 s28, s101, 0x40008
    ds_read_b64_tr_b16 a[224:225], v90 offset:0
    v_mfma_f32_16x16x32_bf16 v[112:115], a[244:247], v[36:39], v[112:115]
    s_lshl_b32 s30, s28, 19
    ds_read_b64_tr_b16 a[226:227], v90 offset:1024
    v_mfma_f32_16x16x32_bf16 v[116:119], a[244:247], v[44:47], v[116:119]
    buffer_load_dwordx4 a[72:75], v4, s[20:23], 0 offen offset:2048 nt
    v_mfma_f32_16x16x32_bf16 v[116:119], a[240:243], v[40:43], v[116:119]
    s_lshl_b32 s28, s28, 7
    ds_read_b64_tr_b16 a[228:229], v90 offset:8192
    v_mfma_f32_16x16x32_bf16 v[120:123], a[240:243], v[48:51], v[120:123]
    ds_read_b64_tr_b16 a[230:231], v90 offset:9216
    v_mfma_f32_16x16x32_bf16 v[120:123], a[244:247], v[52:55], v[120:123]
    ds_read_b64_tr_b16 a[232:233], v92 offset:0
    v_mfma_f32_16x16x32_bf16 v[124:127], a[244:247], v[60:63], v[124:127]
    buffer_load_dwordx4 a[76:79], v5, s[20:23], 0 offen offset:3072 nt
    v_mfma_f32_16x16x32_bf16 v[124:127], a[240:243], v[56:59], v[124:127]
    ds_read_b64_tr_b16 a[234:235], v92 offset:1024
    v_mfma_f32_16x16x32_bf16 v[240:243], a[240:243], v[64:67], v[240:243]
    ds_read_b64_tr_b16 a[236:237], v92 offset:8192
    v_mfma_f32_16x16x32_bf16 v[240:243], a[244:247], v[68:71], v[240:243]
    s_mov_b32 s90, 131072
    ds_read_b64_tr_b16 a[238:239], v92 offset:9216
    v_mfma_f32_16x16x32_bf16 v[244:247], a[252:255], v[68:71], v[244:247]
    buffer_load_dwordx4 a[80:83], v4, s[20:23], s90 offen offset:0 nt
    v_mfma_f32_16x16x32_bf16 v[244:247], a[248:251], v[64:67], v[244:247]
    ds_read_b64_tr_b16 a[240:241], v90 offset:256
    v_mfma_f32_16x16x32_bf16 v[140:143], a[248:251], v[56:59], v[140:143]
    ds_read_b64_tr_b16 a[242:243], v90 offset:1280
    v_mfma_f32_16x16x32_bf16 v[140:143], a[252:255], v[60:63], v[140:143]
    s_add_u32 m0, s6, 0
    ds_read_b64_tr_b16 a[244:245], v90 offset:8448
    v_mfma_f32_16x16x32_bf16 v[136:139], a[252:255], v[52:55], v[136:139]
    buffer_load_dwordx4 v80, s[8:11], s29 offen offset:0 lds
    v_mfma_f32_16x16x32_bf16 v[136:139], a[248:251], v[48:51], v[136:139]
    ds_read_b64_tr_b16 a[246:247], v90 offset:9472
    v_add_u32 v90, 53248, v90
    v_mfma_f32_16x16x32_bf16 v[132:135], a[248:251], v[40:43], v[132:135]
    ds_read_b128 a[128:131], v85 offset:0
    v_mfma_f32_16x16x32_bf16 v[132:135], a[252:255], v[44:47], v[132:135]
    ds_read_b128 a[132:135], v85 offset:256
    v_add_u32 v85, 53248, v85
    v_mfma_f32_16x16x32_bf16 v[128:131], a[252:255], v[36:39], v[128:131]
    s_add_u32 s91, s29, 15360
    ds_read_b128 a[136:139], v86 offset:0
    v_mfma_f32_16x16x32_bf16 v[128:131], a[248:251], v[32:35], v[128:131]
    buffer_load_dwordx4 v81, s[8:11], s91 offen offset:1024 lds
    v_mfma_f32_16x16x32_bf16 v[144:147], a[176:179], v[32:35], v[144:147]
    ds_read_b64_tr_b16 a[248:249], v92 offset:256
    v_mfma_f32_16x16x32_bf16 v[144:147], a[180:183], v[36:39], v[144:147]
    ds_read_b64_tr_b16 a[250:251], v92 offset:1280
    v_mfma_f32_16x16x32_bf16 v[148:151], a[180:183], v[44:47], v[148:151]
    s_add_u32 s92, s29, 30720
    ds_read_b64_tr_b16 a[252:253], v92 offset:8448
    v_mfma_f32_16x16x32_bf16 v[148:151], a[176:179], v[40:43], v[148:151]
    buffer_load_dwordx4 v80, s[8:11], s92 offen offset:2048 lds
    v_mfma_f32_16x16x32_bf16 v[152:155], a[176:179], v[48:51], v[152:155]
    ds_read_b64_tr_b16 a[254:255], v92 offset:9472
    v_add_u32 v92, 53248, v92
    v_mfma_f32_16x16x32_bf16 v[152:155], a[180:183], v[52:55], v[152:155]
    ds_read_b128 a[140:143], v86 offset:256
    v_add_u32 v86, 53248, v86
    v_mfma_f32_16x16x32_bf16 v[156:159], a[180:183], v[60:63], v[156:159]
    s_add_u32 s93, s29, 46080
    ds_read_b128 a[144:147], v87 offset:0
    v_mfma_f32_16x16x32_bf16 v[156:159], a[176:179], v[56:59], v[156:159]
    buffer_load_dwordx4 v81, s[8:11], s93 offen offset:3072 lds
    v_mfma_f32_16x16x32_bf16 v[248:251], a[176:179], v[64:67], v[248:251]
    ds_read_b128 a[148:151], v87 offset:256
    v_add_u32 v87, 53248, v87
    v_mfma_f32_16x16x32_bf16 v[248:251], a[180:183], v[68:71], v[248:251]
    ds_read_b64_tr_b16 a[176:177], v91 offset:0
    v_mfma_f32_16x16x32_bf16 v[252:255], a[188:191], v[68:71], v[252:255]
    s_add_u32 m0, s7, 16384
    ds_read_b64_tr_b16 a[178:179], v91 offset:1024
    v_mfma_f32_16x16x32_bf16 v[252:255], a[184:187], v[64:67], v[252:255]
    s_mov_b32 exec_hi, 0
    buffer_load_dwordx4 v82, s[8:11], s29 offen lds
    s_mov_b32 exec_hi, -1
    v_mfma_f32_16x16x32_bf16 v[172:175], a[184:187], v[56:59], v[172:175]
    ds_read_b64_tr_b16 a[180:181], v91 offset:8192
    v_mfma_f32_16x16x32_bf16 v[172:175], a[188:191], v[60:63], v[172:175]
    ds_read_b64_tr_b16 a[182:183], v91 offset:9216
    v_mfma_f32_16x16x32_bf16 v[168:171], a[188:191], v[52:55], v[168:171]
    ds_read_b128 a[152:155], v88 offset:0
    v_mfma_f32_16x16x32_bf16 v[168:171], a[184:187], v[48:51], v[168:171]
    s_add_u32 m0, s6, 20480
    ds_read_b128 a[156:159], v88 offset:256
    v_add_u32 v88, 53248, v88
    v_mfma_f32_16x16x32_bf16 v[164:167], a[184:187], v[40:43], v[164:167]
    buffer_load_dwordx4 v83, s[12:15], s31 offen offset:0 lds
    v_mfma_f32_16x16x32_bf16 v[164:167], a[188:191], v[44:47], v[164:167]
    ds_read_b128 a[160:163], v89 offset:0
    v_mfma_f32_16x16x32_bf16 v[160:163], a[188:191], v[36:39], v[160:163]
    ds_read_b128 a[164:167], v89 offset:256
    v_add_u32 v89, 53248, v89
    v_mfma_f32_16x16x32_bf16 v[160:163], a[184:187], v[32:35], v[160:163]
    s_add_u32 s94, s31, 31744
    ds_read_b64_tr_b16 a[184:185], v93 offset:0
    v_mfma_f32_16x16x32_bf16 v[176:179], a[192:195], v[32:35], v[176:179]
    buffer_load_dwordx4 v83, s[12:15], s94 offen offset:1024 lds
    v_mfma_f32_16x16x32_bf16 v[176:179], a[196:199], v[36:39], v[176:179]
    ds_read_b64_tr_b16 a[186:187], v93 offset:1024
    v_mfma_f32_16x16x32_bf16 v[180:183], a[196:199], v[44:47], v[180:183]
    ds_read_b64_tr_b16 a[188:189], v93 offset:8192
    v_mfma_f32_16x16x32_bf16 v[180:183], a[192:195], v[40:43], v[180:183]
    s_add_u32 s95, s31, 63488
    ds_read_b64_tr_b16 a[190:191], v93 offset:9216
    v_mfma_f32_16x16x32_bf16 v[184:187], a[192:195], v[48:51], v[184:187]
    buffer_load_dwordx4 v84, s[12:15], s95 offen offset:2048 lds
    v_mfma_f32_16x16x32_bf16 v[184:187], a[196:199], v[52:55], v[184:187]
    v_mfma_f32_16x16x32_bf16 v[188:191], a[196:199], v[60:63], v[188:191]
    v_mfma_f32_16x16x32_bf16 v[188:191], a[192:195], v[56:59], v[188:191]
    s_add_u32 s96, s31, 95232
    ds_read_b64_tr_b16 a[192:193], v91 offset:256
    v_mfma_f32_16x16x32_bf16 v[204:207], a[200:203], v[56:59], v[204:207]
    buffer_load_dwordx4 v84, s[12:15], s96 offen offset:3072 lds
    v_mfma_f32_16x16x32_bf16 v[204:207], a[204:207], v[60:63], v[204:207]
    ds_read_b64_tr_b16 a[194:195], v91 offset:1280
    v_mfma_f32_16x16x32_bf16 v[200:203], a[204:207], v[52:55], v[200:203]
    ds_read_b64_tr_b16 a[196:197], v91 offset:8448
    v_mfma_f32_16x16x32_bf16 v[200:203], a[200:203], v[48:51], v[200:203]
    s_add_u32 s97, s31, 256
    ds_read_b64_tr_b16 a[198:199], v91 offset:9472
    v_add_u32 v91, 53248, v91
    v_mfma_f32_16x16x32_bf16 v[196:199], a[200:203], v[40:43], v[196:199]
    s_add_u32 m0, s6, 36864
    v_mfma_f32_16x16x32_bf16 v[196:199], a[204:207], v[44:47], v[196:199]
    buffer_load_dwordx4 v83, s[12:15], s97 offen offset:0 lds
    v_mfma_f32_16x16x32_bf16 v[192:195], a[204:207], v[36:39], v[192:195]
    v_mfma_f32_16x16x32_bf16 v[192:195], a[200:203], v[32:35], v[192:195]
    ds_read_b64_tr_b16 a[200:201], v93 offset:256
    v_mfma_f32_16x16x32_bf16 v[208:211], a[208:211], v[32:35], v[208:211]
    s_add_u32 s90, s31, 32000
    ds_read_b64_tr_b16 a[202:203], v93 offset:1280
    v_mfma_f32_16x16x32_bf16 v[208:211], a[212:215], v[36:39], v[208:211]
    buffer_load_dwordx4 v83, s[12:15], s90 offen offset:1024 lds
    v_mfma_f32_16x16x32_bf16 v[212:215], a[212:215], v[44:47], v[212:215]
    ds_read_b64_tr_b16 a[204:205], v93 offset:8448
    v_mfma_f32_16x16x32_bf16 v[212:215], a[208:211], v[40:43], v[212:215]
    ds_read_b64_tr_b16 a[206:207], v93 offset:9472
    v_add_u32 v93, 53248, v93
    v_mfma_f32_16x16x32_bf16 v[216:219], a[208:211], v[48:51], v[216:219]
    s_add_u32 s91, s31, 63744
    v_mfma_f32_16x16x32_bf16 v[216:219], a[212:215], v[52:55], v[216:219]
    buffer_load_dwordx4 v84, s[12:15], s91 offen offset:2048 lds
    v_mfma_f32_16x16x32_bf16 v[220:223], a[212:215], v[60:63], v[220:223]
    v_mfma_f32_16x16x32_bf16 v[220:223], a[208:211], v[56:59], v[220:223]
    v_mfma_f32_16x16x32_bf16 v[236:239], a[216:219], v[56:59], v[236:239]
    s_add_u32 s92, s31, 95488
    v_mfma_f32_16x16x32_bf16 v[236:239], a[220:223], v[60:63], v[236:239]
    buffer_load_dwordx4 v84, s[12:15], s92 offen offset:3072 lds
    v_mfma_f32_16x16x32_bf16 v[232:235], a[220:223], v[52:55], v[232:235]
    v_mfma_f32_16x16x32_bf16 v[232:235], a[216:219], v[48:51], v[232:235]
    v_mfma_f32_16x16x32_bf16 v[228:231], a[216:219], v[40:43], v[228:231]
    v_mfma_f32_16x16x32_bf16 v[228:231], a[220:223], v[44:47], v[228:231]
    v_mfma_f32_16x16x32_bf16 v[224:227], a[220:223], v[36:39], v[224:227]
    v_mfma_f32_16x16x32_bf16 v[224:227], a[216:219], v[32:35], v[224:227]
    s_waitcnt vmcnt(16) lgkmcnt(0)
    s_barrier
    v_mfma_f32_16x16x32_bf16 v[112:115], a[224:227], a[128:131], v[112:115]
    s_bfe_u32 s29, s101, 0x4000c
    ds_read_b64_tr_b16 a[208:209], v90 offset:0
    v_mfma_f32_16x16x32_bf16 v[112:115], a[228:231], a[132:135], v[112:115]
    s_mov_b32 s93, 131072
    ds_read_b64_tr_b16 a[210:211], v90 offset:1024
    v_mfma_f32_16x16x32_bf16 v[116:119], a[228:231], a[140:143], v[116:119]
    buffer_load_dwordx4 a[84:87], v5, s[20:23], s93 offen offset:1024 nt
    v_mfma_f32_16x16x32_bf16 v[116:119], a[224:227], a[136:139], v[116:119]
    s_lshl_b32 s31, s29, 19
    ds_read_b64_tr_b16 a[212:213], v90 offset:8192
    v_mfma_f32_16x16x32_bf16 v[120:123], a[224:227], a[144:147], v[120:123]
    s_lshl_b32 s29, s29, 7
    ds_read_b64_tr_b16 a[214:215], v90 offset:9216
    v_mfma_f32_16x16x32_bf16 v[120:123], a[228:231], a[148:151], v[120:123]
    ds_read_b64_tr_b16 a[216:217], v92 offset:0
    v_mfma_f32_16x16x32_bf16 v[124:127], a[228:231], a[156:159], v[124:127]
    buffer_load_dwordx4 a[88:91], v4, s[20:23], s93 offen offset:2048 nt
    v_mfma_f32_16x16x32_bf16 v[124:127], a[224:227], a[152:155], v[124:127]
    ds_read_b64_tr_b16 a[218:219], v92 offset:1024
    v_mfma_f32_16x16x32_bf16 v[240:243], a[224:227], a[160:163], v[240:243]
    ds_read_b64_tr_b16 a[220:221], v92 offset:8192
    v_mfma_f32_16x16x32_bf16 v[240:243], a[228:231], a[164:167], v[240:243]
    ds_read_b64_tr_b16 a[222:223], v92 offset:9216
    v_mfma_f32_16x16x32_bf16 v[244:247], a[236:239], a[164:167], v[244:247]
    buffer_load_dwordx4 a[92:95], v5, s[20:23], s93 offen offset:3072 nt
    v_mfma_f32_16x16x32_bf16 v[244:247], a[232:235], a[160:163], v[244:247]
    ds_read_b64_tr_b16 a[224:225], v90 offset:256
    v_mfma_f32_16x16x32_bf16 v[140:143], a[232:235], a[152:155], v[140:143]
    ds_read_b64_tr_b16 a[226:227], v90 offset:1280
    v_mfma_f32_16x16x32_bf16 v[140:143], a[236:239], a[156:159], v[140:143]
    s_add_u32 m0, s6, 53248
    ds_read_b64_tr_b16 a[228:229], v90 offset:8448
    v_mfma_f32_16x16x32_bf16 v[136:139], a[236:239], a[148:151], v[136:139]
    buffer_load_dwordx4 v80, s[8:11], s28 offen offset:0 lds
    v_mfma_f32_16x16x32_bf16 v[136:139], a[232:235], a[144:147], v[136:139]
    ds_read_b64_tr_b16 a[230:231], v90 offset:9472
    v_add_u32 v90, 4294860800, v90
    v_mfma_f32_16x16x32_bf16 v[132:135], a[232:235], a[136:139], v[132:135]
    ds_read_b128 v[32:35], v85 offset:0
    v_mfma_f32_16x16x32_bf16 v[132:135], a[236:239], a[140:143], v[132:135]
    ds_read_b128 v[36:39], v85 offset:256
    v_add_u32 v85, 4294860800, v85
    v_mfma_f32_16x16x32_bf16 v[128:131], a[236:239], a[132:135], v[128:131]
    s_add_u32 s94, s28, 15360
    ds_read_b128 v[40:43], v86 offset:0
    v_mfma_f32_16x16x32_bf16 v[128:131], a[232:235], a[128:131], v[128:131]
    buffer_load_dwordx4 v81, s[8:11], s94 offen offset:1024 lds
    v_mfma_f32_16x16x32_bf16 v[144:147], a[240:243], a[128:131], v[144:147]
    ds_read_b64_tr_b16 a[232:233], v92 offset:256
    v_mfma_f32_16x16x32_bf16 v[144:147], a[244:247], a[132:135], v[144:147]
    ds_read_b64_tr_b16 a[234:235], v92 offset:1280
    v_mfma_f32_16x16x32_bf16 v[148:151], a[244:247], a[140:143], v[148:151]
    s_add_u32 s95, s28, 30720
    ds_read_b64_tr_b16 a[236:237], v92 offset:8448
    v_mfma_f32_16x16x32_bf16 v[148:151], a[240:243], a[136:139], v[148:151]
    buffer_load_dwordx4 v80, s[8:11], s95 offen offset:2048 lds
    v_mfma_f32_16x16x32_bf16 v[152:155], a[240:243], a[144:147], v[152:155]
    ds_read_b64_tr_b16 a[238:239], v92 offset:9472
    v_add_u32 v92, 4294860800, v92
    v_mfma_f32_16x16x32_bf16 v[152:155], a[244:247], a[148:151], v[152:155]
    ds_read_b128 v[44:47], v86 offset:256
    v_add_u32 v86, 4294860800, v86
    v_mfma_f32_16x16x32_bf16 v[156:159], a[244:247], a[156:159], v[156:159]
    s_add_u32 s96, s28, 46080
    ds_read_b128 v[48:51], v87 offset:0
    v_mfma_f32_16x16x32_bf16 v[156:159], a[240:243], a[152:155], v[156:159]
    buffer_load_dwordx4 v81, s[8:11], s96 offen offset:3072 lds
    v_mfma_f32_16x16x32_bf16 v[248:251], a[240:243], a[160:163], v[248:251]
    ds_read_b128 v[52:55], v87 offset:256
    v_add_u32 v87, 4294860800, v87
    v_mfma_f32_16x16x32_bf16 v[248:251], a[244:247], a[164:167], v[248:251]
    ds_read_b64_tr_b16 a[240:241], v91 offset:0
    v_mfma_f32_16x16x32_bf16 v[252:255], a[252:255], a[164:167], v[252:255]
    s_add_u32 m0, s7, 69632
    ds_read_b64_tr_b16 a[242:243], v91 offset:1024
    v_mfma_f32_16x16x32_bf16 v[252:255], a[248:251], a[160:163], v[252:255]
    s_mov_b32 exec_hi, 0
    buffer_load_dwordx4 v82, s[8:11], s28 offen lds
    s_mov_b32 exec_hi, -1
    v_mfma_f32_16x16x32_bf16 v[172:175], a[248:251], a[152:155], v[172:175]
    ds_read_b64_tr_b16 a[244:245], v91 offset:8192
    v_mfma_f32_16x16x32_bf16 v[172:175], a[252:255], a[156:159], v[172:175]
    ds_read_b64_tr_b16 a[246:247], v91 offset:9216
    v_mfma_f32_16x16x32_bf16 v[168:171], a[252:255], a[148:151], v[168:171]
    ds_read_b128 v[56:59], v88 offset:0
    v_mfma_f32_16x16x32_bf16 v[168:171], a[248:251], a[144:147], v[168:171]
    s_add_u32 m0, s6, 73728
    ds_read_b128 v[60:63], v88 offset:256
    v_add_u32 v88, 4294860800, v88
    v_mfma_f32_16x16x32_bf16 v[164:167], a[248:251], a[136:139], v[164:167]
    buffer_load_dwordx4 v83, s[12:15], s30 offen offset:0 lds
    v_mfma_f32_16x16x32_bf16 v[164:167], a[252:255], a[140:143], v[164:167]
    ds_read_b128 v[64:67], v89 offset:0
    v_mfma_f32_16x16x32_bf16 v[160:163], a[252:255], a[132:135], v[160:163]
    ds_read_b128 v[68:71], v89 offset:256
    v_add_u32 v89, 4294860800, v89
    v_mfma_f32_16x16x32_bf16 v[160:163], a[248:251], a[128:131], v[160:163]
    s_add_u32 s97, s30, 31744
    ds_read_b64_tr_b16 a[248:249], v93 offset:0
    v_mfma_f32_16x16x32_bf16 v[176:179], a[176:179], a[128:131], v[176:179]
    buffer_load_dwordx4 v83, s[12:15], s97 offen offset:1024 lds
    v_mfma_f32_16x16x32_bf16 v[176:179], a[180:183], a[132:135], v[176:179]
    ds_read_b64_tr_b16 a[250:251], v93 offset:1024
    v_mfma_f32_16x16x32_bf16 v[180:183], a[180:183], a[140:143], v[180:183]
    ds_read_b64_tr_b16 a[252:253], v93 offset:8192
    v_mfma_f32_16x16x32_bf16 v[180:183], a[176:179], a[136:139], v[180:183]
    s_add_u32 s90, s30, 63488
    ds_read_b64_tr_b16 a[254:255], v93 offset:9216
    v_mfma_f32_16x16x32_bf16 v[184:187], a[176:179], a[144:147], v[184:187]
    buffer_load_dwordx4 v84, s[12:15], s90 offen offset:2048 lds
    v_mfma_f32_16x16x32_bf16 v[184:187], a[180:183], a[148:151], v[184:187]
    v_mfma_f32_16x16x32_bf16 v[188:191], a[180:183], a[156:159], v[188:191]
    v_mfma_f32_16x16x32_bf16 v[188:191], a[176:179], a[152:155], v[188:191]
    s_add_u32 s91, s30, 95232
    ds_read_b64_tr_b16 a[176:177], v91 offset:256
    v_mfma_f32_16x16x32_bf16 v[204:207], a[184:187], a[152:155], v[204:207]
    buffer_load_dwordx4 v84, s[12:15], s91 offen offset:3072 lds
    v_mfma_f32_16x16x32_bf16 v[204:207], a[188:191], a[156:159], v[204:207]
    ds_read_b64_tr_b16 a[178:179], v91 offset:1280
    v_mfma_f32_16x16x32_bf16 v[200:203], a[188:191], a[148:151], v[200:203]
    ds_read_b64_tr_b16 a[180:181], v91 offset:8448
    v_mfma_f32_16x16x32_bf16 v[200:203], a[184:187], a[144:147], v[200:203]
    s_add_u32 s92, s30, 256
    ds_read_b64_tr_b16 a[182:183], v91 offset:9472
    v_add_u32 v91, 4294860800, v91
    v_mfma_f32_16x16x32_bf16 v[196:199], a[184:187], a[136:139], v[196:199]
    s_add_u32 m0, s6, 90112
    v_mfma_f32_16x16x32_bf16 v[196:199], a[188:191], a[140:143], v[196:199]
    buffer_load_dwordx4 v83, s[12:15], s92 offen offset:0 lds
    v_mfma_f32_16x16x32_bf16 v[192:195], a[188:191], a[132:135], v[192:195]
    v_mfma_f32_16x16x32_bf16 v[192:195], a[184:187], a[128:131], v[192:195]
    ds_read_b64_tr_b16 a[184:185], v93 offset:256
    v_mfma_f32_16x16x32_bf16 v[208:211], a[192:195], a[128:131], v[208:211]
    s_add_u32 s93, s30, 32000
    ds_read_b64_tr_b16 a[186:187], v93 offset:1280
    v_mfma_f32_16x16x32_bf16 v[208:211], a[196:199], a[132:135], v[208:211]
    buffer_load_dwordx4 v83, s[12:15], s93 offen offset:1024 lds
    v_mfma_f32_16x16x32_bf16 v[212:215], a[196:199], a[140:143], v[212:215]
    ds_read_b64_tr_b16 a[188:189], v93 offset:8448
    v_mfma_f32_16x16x32_bf16 v[212:215], a[192:195], a[136:139], v[212:215]
    ds_read_b64_tr_b16 a[190:191], v93 offset:9472
    v_add_u32 v93, 4294860800, v93
    v_mfma_f32_16x16x32_bf16 v[216:219], a[192:195], a[144:147], v[216:219]
    s_add_u32 s94, s30, 63744
    v_mfma_f32_16x16x32_bf16 v[216:219], a[196:199], a[148:151], v[216:219]
    buffer_load_dwordx4 v84, s[12:15], s94 offen offset:2048 lds
    v_mfma_f32_16x16x32_bf16 v[220:223], a[196:199], a[156:159], v[220:223]
    v_mfma_f32_16x16x32_bf16 v[220:223], a[192:195], a[152:155], v[220:223]
    v_mfma_f32_16x16x32_bf16 v[236:239], a[200:203], a[152:155], v[236:239]
    s_add_u32 s95, s30, 95488
    v_mfma_f32_16x16x32_bf16 v[236:239], a[204:207], a[156:159], v[236:239]
    buffer_load_dwordx4 v84, s[12:15], s95 offen offset:3072 lds
    v_mfma_f32_16x16x32_bf16 v[232:235], a[204:207], a[148:151], v[232:235]
    v_mfma_f32_16x16x32_bf16 v[232:235], a[200:203], a[144:147], v[232:235]
    v_mfma_f32_16x16x32_bf16 v[228:231], a[200:203], a[136:139], v[228:231]
    v_mfma_f32_16x16x32_bf16 v[228:231], a[204:207], a[140:143], v[228:231]
    v_mfma_f32_16x16x32_bf16 v[224:227], a[204:207], a[132:135], v[224:227]
    v_mfma_f32_16x16x32_bf16 v[224:227], a[200:203], a[128:131], v[224:227]
    s_waitcnt vmcnt(16) lgkmcnt(0)
    s_barrier
    v_mfma_f32_16x16x32_bf16 v[112:115], a[208:211], v[32:35], v[112:115]
    s_bfe_u32 s28, s101, 0x40010
    ds_read_b64_tr_b16 a[192:193], v90 offset:0
    v_mfma_f32_16x16x32_bf16 v[112:115], a[212:215], v[36:39], v[112:115]
    s_mov_b32 s96, 32768
    ds_read_b64_tr_b16 a[194:195], v90 offset:1024
    v_mfma_f32_16x16x32_bf16 v[116:119], a[212:215], v[44:47], v[116:119]
    buffer_load_dwordx4 a[96:99], v2, s[16:19], s96 offen offset:0 nt
    v_mfma_f32_16x16x32_bf16 v[116:119], a[208:211], v[40:43], v[116:119]
    s_lshl_b32 s30, s28, 19
    ds_read_b64_tr_b16 a[196:197], v90 offset:8192
    v_mfma_f32_16x16x32_bf16 v[120:123], a[208:211], v[48:51], v[120:123]
    s_lshl_b32 s28, s28, 7
    ds_read_b64_tr_b16 a[198:199], v90 offset:9216
    v_mfma_f32_16x16x32_bf16 v[120:123], a[212:215], v[52:55], v[120:123]
    ds_read_b64_tr_b16 a[200:201], v92 offset:0
    v_mfma_f32_16x16x32_bf16 v[124:127], a[212:215], v[60:63], v[124:127]
    buffer_load_dwordx4 a[100:103], v2, s[16:19], s96 offen offset:1024 nt
    v_mfma_f32_16x16x32_bf16 v[124:127], a[208:211], v[56:59], v[124:127]
    ds_read_b64_tr_b16 a[202:203], v92 offset:1024
    v_mfma_f32_16x16x32_bf16 v[240:243], a[208:211], v[64:67], v[240:243]
    ds_read_b64_tr_b16 a[204:205], v92 offset:8192
    v_mfma_f32_16x16x32_bf16 v[240:243], a[212:215], v[68:71], v[240:243]
    ds_read_b64_tr_b16 a[206:207], v92 offset:9216
    v_mfma_f32_16x16x32_bf16 v[244:247], a[220:223], v[68:71], v[244:247]
    buffer_load_dwordx4 a[104:107], v3, s[16:19], s96 offen offset:2048 nt
    v_mfma_f32_16x16x32_bf16 v[244:247], a[216:219], v[64:67], v[244:247]
    ds_read_b64_tr_b16 a[208:209], v90 offset:256
    v_mfma_f32_16x16x32_bf16 v[140:143], a[216:219], v[56:59], v[140:143]
    ds_read_b64_tr_b16 a[210:211], v90 offset:1280
    v_mfma_f32_16x16x32_bf16 v[140:143], a[220:223], v[60:63], v[140:143]
    s_add_u32 m0, s6, 106496
    ds_read_b64_tr_b16 a[212:213], v90 offset:8448
    v_mfma_f32_16x16x32_bf16 v[136:139], a[220:223], v[52:55], v[136:139]
    buffer_load_dwordx4 v80, s[8:11], s29 offen offset:0 lds
    v_mfma_f32_16x16x32_bf16 v[136:139], a[216:219], v[48:51], v[136:139]
    ds_read_b64_tr_b16 a[214:215], v90 offset:9472
    v_add_u32 v90, 53248, v90
    v_mfma_f32_16x16x32_bf16 v[132:135], a[216:219], v[40:43], v[132:135]
    ds_read_b128 a[128:131], v85 offset:0
    v_mfma_f32_16x16x32_bf16 v[132:135], a[220:223], v[44:47], v[132:135]
    ds_read_b128 a[132:135], v85 offset:256
    v_add_u32 v85, 53248, v85
    v_mfma_f32_16x16x32_bf16 v[128:131], a[220:223], v[36:39], v[128:131]
    s_add_u32 s97, s29, 15360
    ds_read_b128 a[136:139], v86 offset:0
    v_mfma_f32_16x16x32_bf16 v[128:131], a[216:219], v[32:35], v[128:131]
    buffer_load_dwordx4 v81, s[8:11], s97 offen offset:1024 lds
    v_mfma_f32_16x16x32_bf16 v[144:147], a[224:227], v[32:35], v[144:147]
    ds_read_b64_tr_b16 a[216:217], v92 offset:256
    v_mfma_f32_16x16x32_bf16 v[144:147], a[228:231], v[36:39], v[144:147]
    ds_read_b64_tr_b16 a[218:219], v92 offset:1280
    v_mfma_f32_16x16x32_bf16 v[148:151], a[228:231], v[44:47], v[148:151]
    s_add_u32 s90, s29, 30720
    ds_read_b64_tr_b16 a[220:221], v92 offset:8448
    v_mfma_f32_16x16x32_bf16 v[148:151], a[224:227], v[40:43], v[148:151]
    buffer_load_dwordx4 v80, s[8:11], s90 offen offset:2048 lds
    v_mfma_f32_16x16x32_bf16 v[152:155], a[224:227], v[48:51], v[152:155]
    ds_read_b64_tr_b16 a[222:223], v92 offset:9472
    v_add_u32 v92, 53248, v92
    v_mfma_f32_16x16x32_bf16 v[152:155], a[228:231], v[52:55], v[152:155]
    ds_read_b128 a[140:143], v86 offset:256
    v_add_u32 v86, 53248, v86
    v_mfma_f32_16x16x32_bf16 v[156:159], a[228:231], v[60:63], v[156:159]
    s_add_u32 s91, s29, 46080
    ds_read_b128 a[144:147], v87 offset:0
    v_mfma_f32_16x16x32_bf16 v[156:159], a[224:227], v[56:59], v[156:159]
    buffer_load_dwordx4 v81, s[8:11], s91 offen offset:3072 lds
    v_mfma_f32_16x16x32_bf16 v[248:251], a[224:227], v[64:67], v[248:251]
    ds_read_b128 a[148:151], v87 offset:256
    v_add_u32 v87, 53248, v87
    v_mfma_f32_16x16x32_bf16 v[248:251], a[228:231], v[68:71], v[248:251]
    ds_read_b64_tr_b16 a[224:225], v91 offset:0
    v_mfma_f32_16x16x32_bf16 v[252:255], a[236:239], v[68:71], v[252:255]
    s_add_u32 m0, s7, 122880
    ds_read_b64_tr_b16 a[226:227], v91 offset:1024
    v_mfma_f32_16x16x32_bf16 v[252:255], a[232:235], v[64:67], v[252:255]
    s_mov_b32 exec_hi, 0
    buffer_load_dwordx4 v82, s[8:11], s29 offen lds
    s_mov_b32 exec_hi, -1
    v_mfma_f32_16x16x32_bf16 v[172:175], a[232:235], v[56:59], v[172:175]
    ds_read_b64_tr_b16 a[228:229], v91 offset:8192
    v_mfma_f32_16x16x32_bf16 v[172:175], a[236:239], v[60:63], v[172:175]
    ds_read_b64_tr_b16 a[230:231], v91 offset:9216
    v_mfma_f32_16x16x32_bf16 v[168:171], a[236:239], v[52:55], v[168:171]
    ds_read_b128 a[152:155], v88 offset:0
    v_mfma_f32_16x16x32_bf16 v[168:171], a[232:235], v[48:51], v[168:171]
    s_add_u32 m0, s6, 126976
    ds_read_b128 a[156:159], v88 offset:256
    v_add_u32 v88, 53248, v88
    v_mfma_f32_16x16x32_bf16 v[164:167], a[232:235], v[40:43], v[164:167]
    buffer_load_dwordx4 v83, s[12:15], s31 offen offset:0 lds
    v_mfma_f32_16x16x32_bf16 v[164:167], a[236:239], v[44:47], v[164:167]
    ds_read_b128 a[160:163], v89 offset:0
    v_mfma_f32_16x16x32_bf16 v[160:163], a[236:239], v[36:39], v[160:163]
    ds_read_b128 a[164:167], v89 offset:256
    v_add_u32 v89, 53248, v89
    v_mfma_f32_16x16x32_bf16 v[160:163], a[232:235], v[32:35], v[160:163]
    s_add_u32 s92, s31, 31744
    ds_read_b64_tr_b16 a[232:233], v93 offset:0
    v_mfma_f32_16x16x32_bf16 v[176:179], a[240:243], v[32:35], v[176:179]
    buffer_load_dwordx4 v83, s[12:15], s92 offen offset:1024 lds
    v_mfma_f32_16x16x32_bf16 v[176:179], a[244:247], v[36:39], v[176:179]
    ds_read_b64_tr_b16 a[234:235], v93 offset:1024
    v_mfma_f32_16x16x32_bf16 v[180:183], a[244:247], v[44:47], v[180:183]
    ds_read_b64_tr_b16 a[236:237], v93 offset:8192
    v_mfma_f32_16x16x32_bf16 v[180:183], a[240:243], v[40:43], v[180:183]
    s_add_u32 s93, s31, 63488
    ds_read_b64_tr_b16 a[238:239], v93 offset:9216
    v_mfma_f32_16x16x32_bf16 v[184:187], a[240:243], v[48:51], v[184:187]
    buffer_load_dwordx4 v84, s[12:15], s93 offen offset:2048 lds
    v_mfma_f32_16x16x32_bf16 v[184:187], a[244:247], v[52:55], v[184:187]
    v_mfma_f32_16x16x32_bf16 v[188:191], a[244:247], v[60:63], v[188:191]
    v_mfma_f32_16x16x32_bf16 v[188:191], a[240:243], v[56:59], v[188:191]
    s_add_u32 s94, s31, 95232
    ds_read_b64_tr_b16 a[240:241], v91 offset:256
    v_mfma_f32_16x16x32_bf16 v[204:207], a[248:251], v[56:59], v[204:207]
    buffer_load_dwordx4 v84, s[12:15], s94 offen offset:3072 lds
    v_mfma_f32_16x16x32_bf16 v[204:207], a[252:255], v[60:63], v[204:207]
    ds_read_b64_tr_b16 a[242:243], v91 offset:1280
    v_mfma_f32_16x16x32_bf16 v[200:203], a[252:255], v[52:55], v[200:203]
    ds_read_b64_tr_b16 a[244:245], v91 offset:8448
    v_mfma_f32_16x16x32_bf16 v[200:203], a[248:251], v[48:51], v[200:203]
    s_add_u32 s95, s31, 256
    ds_read_b64_tr_b16 a[246:247], v91 offset:9472
    v_add_u32 v91, 53248, v91
    v_mfma_f32_16x16x32_bf16 v[196:199], a[248:251], v[40:43], v[196:199]
    s_add_u32 m0, s6, 143360
    v_mfma_f32_16x16x32_bf16 v[196:199], a[252:255], v[44:47], v[196:199]
    buffer_load_dwordx4 v83, s[12:15], s95 offen offset:0 lds
    v_mfma_f32_16x16x32_bf16 v[192:195], a[252:255], v[36:39], v[192:195]
    v_mfma_f32_16x16x32_bf16 v[192:195], a[248:251], v[32:35], v[192:195]
    ds_read_b64_tr_b16 a[248:249], v93 offset:256
    v_mfma_f32_16x16x32_bf16 v[208:211], a[176:179], v[32:35], v[208:211]
    s_add_u32 s96, s31, 32000
    ds_read_b64_tr_b16 a[250:251], v93 offset:1280
    v_mfma_f32_16x16x32_bf16 v[208:211], a[180:183], v[36:39], v[208:211]
    buffer_load_dwordx4 v83, s[12:15], s96 offen offset:1024 lds
    v_mfma_f32_16x16x32_bf16 v[212:215], a[180:183], v[44:47], v[212:215]
    ds_read_b64_tr_b16 a[252:253], v93 offset:8448
    v_mfma_f32_16x16x32_bf16 v[212:215], a[176:179], v[40:43], v[212:215]
    ds_read_b64_tr_b16 a[254:255], v93 offset:9472
    v_add_u32 v93, 53248, v93
    v_mfma_f32_16x16x32_bf16 v[216:219], a[176:179], v[48:51], v[216:219]
    s_add_u32 s97, s31, 63744
    v_mfma_f32_16x16x32_bf16 v[216:219], a[180:183], v[52:55], v[216:219]
    buffer_load_dwordx4 v84, s[12:15], s97 offen offset:2048 lds
    v_mfma_f32_16x16x32_bf16 v[220:223], a[180:183], v[60:63], v[220:223]
    v_mfma_f32_16x16x32_bf16 v[220:223], a[176:179], v[56:59], v[220:223]
    v_mfma_f32_16x16x32_bf16 v[236:239], a[184:187], v[56:59], v[236:239]
    s_add_u32 s90, s31, 95488
    v_mfma_f32_16x16x32_bf16 v[236:239], a[188:191], v[60:63], v[236:239]
    buffer_load_dwordx4 v84, s[12:15], s90 offen offset:3072 lds
    v_mfma_f32_16x16x32_bf16 v[232:235], a[188:191], v[52:55], v[232:235]
    v_mfma_f32_16x16x32_bf16 v[232:235], a[184:187], v[48:51], v[232:235]
    v_mfma_f32_16x16x32_bf16 v[228:231], a[184:187], v[40:43], v[228:231]
    v_mfma_f32_16x16x32_bf16 v[228:231], a[188:191], v[44:47], v[228:231]
    v_mfma_f32_16x16x32_bf16 v[224:227], a[188:191], v[36:39], v[224:227]
    v_mfma_f32_16x16x32_bf16 v[224:227], a[184:187], v[32:35], v[224:227]
    s_waitcnt vmcnt(16) lgkmcnt(0)
    s_barrier
    v_mfma_f32_16x16x32_bf16 v[112:115], a[192:195], a[128:131], v[112:115]
    s_bfe_u32 s29, s101, 0x40014
    ds_read_b64_tr_b16 a[176:177], v90 offset:0
    v_mfma_f32_16x16x32_bf16 v[112:115], a[196:199], a[132:135], v[112:115]
    s_mov_b32 s91, 49152
    ds_read_b64_tr_b16 a[178:179], v90 offset:1024
    v_mfma_f32_16x16x32_bf16 v[116:119], a[196:199], a[140:143], v[116:119]
    buffer_load_dword v1, v6, s[16:19], s91 offen
    v_mfma_f32_16x16x32_bf16 v[116:119], a[192:195], a[136:139], v[116:119]
    s_lshl_b32 s31, s29, 19
    ds_read_b64_tr_b16 a[180:181], v90 offset:8192
    v_mfma_f32_16x16x32_bf16 v[120:123], a[192:195], a[144:147], v[120:123]
    s_lshl_b32 s29, s29, 7
    ds_read_b64_tr_b16 a[182:183], v90 offset:9216
    v_mfma_f32_16x16x32_bf16 v[120:123], a[196:199], a[148:151], v[120:123]
    s_add_u32 m0, s6, 0
    ds_read_b64_tr_b16 a[184:185], v92 offset:0
    v_mfma_f32_16x16x32_bf16 v[124:127], a[196:199], a[156:159], v[124:127]
    buffer_load_dwordx4 v80, s[8:11], s28 offen offset:0 lds
    v_mfma_f32_16x16x32_bf16 v[124:127], a[192:195], a[152:155], v[124:127]
    ds_read_b64_tr_b16 a[186:187], v92 offset:1024
    v_mfma_f32_16x16x32_bf16 v[240:243], a[192:195], a[160:163], v[240:243]
    ds_read_b64_tr_b16 a[188:189], v92 offset:8192
    v_mfma_f32_16x16x32_bf16 v[240:243], a[196:199], a[164:167], v[240:243]
    ds_read_b64_tr_b16 a[190:191], v92 offset:9216
    v_mfma_f32_16x16x32_bf16 v[244:247], a[204:207], a[164:167], v[244:247]
    s_add_u32 s92, s28, 15360
    ds_read_b64_tr_b16 a[192:193], v90 offset:256
    v_mfma_f32_16x16x32_bf16 v[244:247], a[200:203], a[160:163], v[244:247]
    buffer_load_dwordx4 v81, s[8:11], s92 offen offset:1024 lds
    v_mfma_f32_16x16x32_bf16 v[140:143], a[200:203], a[152:155], v[140:143]
    ds_read_b64_tr_b16 a[194:195], v90 offset:1280
    v_mfma_f32_16x16x32_bf16 v[140:143], a[204:207], a[156:159], v[140:143]
    ds_read_b64_tr_b16 a[196:197], v90 offset:8448
    v_mfma_f32_16x16x32_bf16 v[136:139], a[204:207], a[148:151], v[136:139]
    ds_read_b64_tr_b16 a[198:199], v90 offset:9472
    v_add_u32 v90, 53248, v90
    v_mfma_f32_16x16x32_bf16 v[136:139], a[200:203], a[144:147], v[136:139]
    s_add_u32 s93, s28, 30720
    ds_read_b128 v[32:35], v85 offset:0
    v_mfma_f32_16x16x32_bf16 v[132:135], a[200:203], a[136:139], v[132:135]
    buffer_load_dwordx4 v80, s[8:11], s93 offen offset:2048 lds
    v_mfma_f32_16x16x32_bf16 v[132:135], a[204:207], a[140:143], v[132:135]
    ds_read_b128 v[36:39], v85 offset:256
    v_add_u32 v85, 53248, v85
    v_mfma_f32_16x16x32_bf16 v[128:131], a[204:207], a[132:135], v[128:131]
    ds_read_b128 v[40:43], v86 offset:0
    v_mfma_f32_16x16x32_bf16 v[128:131], a[200:203], a[128:131], v[128:131]
    ds_read_b64_tr_b16 a[200:201], v92 offset:256
    v_mfma_f32_16x16x32_bf16 v[144:147], a[208:211], a[128:131], v[144:147]
    s_add_u32 s94, s28, 46080
    ds_read_b64_tr_b16 a[202:203], v92 offset:1280
    v_mfma_f32_16x16x32_bf16 v[144:147], a[212:215], a[132:135], v[144:147]
    buffer_load_dwordx4 v81, s[8:11], s94 offen offset:3072 lds
    v_mfma_f32_16x16x32_bf16 v[148:151], a[212:215], a[140:143], v[148:151]
    ds_read_b64_tr_b16 a[204:205], v92 offset:8448
    v_mfma_f32_16x16x32_bf16 v[148:151], a[208:211], a[136:139], v[148:151]
    ds_read_b64_tr_b16 a[206:207], v92 offset:9472
    v_add_u32 v92, 53248, v92
    v_mfma_f32_16x16x32_bf16 v[152:155], a[208:211], a[144:147], v[152:155]
    ds_read_b128 v[44:47], v86 offset:256
    v_add_u32 v86, 53248, v86
    v_mfma_f32_16x16x32_bf16 v[152:155], a[212:215], a[148:151], v[152:155]
    s_add_u32 m0, s7, 16384
    ds_read_b128 v[48:51], v87 offset:0
    v_mfma_f32_16x16x32_bf16 v[156:159], a[212:215], a[156:159], v[156:159]
    s_mov_b32 exec_hi, 0
    buffer_load_dwordx4 v82, s[8:11], s28 offen lds
    s_mov_b32 exec_hi, -1
    v_mfma_f32_16x16x32_bf16 v[156:159], a[208:211], a[152:155], v[156:159]
    ds_read_b128 v[52:55], v87 offset:256
    v_add_u32 v87, 53248, v87
    v_mfma_f32_16x16x32_bf16 v[248:251], a[208:211], a[160:163], v[248:251]
    ds_read_b128 v[56:59], v88 offset:0
    v_mfma_f32_16x16x32_bf16 v[248:251], a[212:215], a[164:167], v[248:251]
    ds_read_b64_tr_b16 a[208:209], v91 offset:0
    v_mfma_f32_16x16x32_bf16 v[252:255], a[220:223], a[164:167], v[252:255]
    s_add_u32 m0, s6, 20480
    ds_read_b64_tr_b16 a[210:211], v91 offset:1024
    v_mfma_f32_16x16x32_bf16 v[252:255], a[216:219], a[160:163], v[252:255]
    buffer_load_dwordx4 v83, s[12:15], s30 offen offset:0 lds
    v_mfma_f32_16x16x32_bf16 v[172:175], a[216:219], a[152:155], v[172:175]
    ds_read_b64_tr_b16 a[212:213], v91 offset:8192
    v_mfma_f32_16x16x32_bf16 v[172:175], a[220:223], a[156:159], v[172:175]
    ds_read_b64_tr_b16 a[214:215], v91 offset:9216
    v_mfma_f32_16x16x32_bf16 v[168:171], a[220:223], a[148:151], v[168:171]
    ds_read_b128 v[60:63], v88 offset:256
    v_add_u32 v88, 53248, v88
    v_mfma_f32_16x16x32_bf16 v[168:171], a[216:219], a[144:147], v[168:171]
    s_add_u32 s95, s30, 31744
    ds_read_b128 v[64:67], v89 offset:0
    v_mfma_f32_16x16x32_bf16 v[164:167], a[216:219], a[136:139], v[164:167]
    buffer_load_dwordx4 v83, s[12:15], s95 offen offset:1024 lds
    v_mfma_f32_16x16x32_bf16 v[164:167], a[220:223], a[140:143], v[164:167]
    ds_read_b128 v[68:71], v89 offset:256
    v_add_u32 v89, 53248, v89
    v_mfma_f32_16x16x32_bf16 v[160:163], a[220:223], a[132:135], v[160:163]
    v_mfma_f32_16x16x32_bf16 v[160:163], a[216:219], a[128:131], v[160:163]
    s_add_u32 s96, s30, 63488
    ds_read_b64_tr_b16 a[216:217], v93 offset:0
    v_mfma_f32_16x16x32_bf16 v[176:179], a[224:227], a[128:131], v[176:179]
    buffer_load_dwordx4 v84, s[12:15], s96 offen offset:2048 lds
    v_mfma_f32_16x16x32_bf16 v[176:179], a[228:231], a[132:135], v[176:179]
    ds_read_b64_tr_b16 a[218:219], v93 offset:1024
    v_mfma_f32_16x16x32_bf16 v[180:183], a[228:231], a[140:143], v[180:183]
    ds_read_b64_tr_b16 a[220:221], v93 offset:8192
    v_mfma_f32_16x16x32_bf16 v[180:183], a[224:227], a[136:139], v[180:183]
    ds_read_b64_tr_b16 a[222:223], v93 offset:9216
    v_mfma_f32_16x16x32_bf16 v[184:187], a[224:227], a[144:147], v[184:187]
    s_add_u32 s97, s30, 95232
    v_mfma_f32_16x16x32_bf16 v[184:187], a[228:231], a[148:151], v[184:187]
    buffer_load_dwordx4 v84, s[12:15], s97 offen offset:3072 lds
    v_mfma_f32_16x16x32_bf16 v[188:191], a[228:231], a[156:159], v[188:191]
    v_mfma_f32_16x16x32_bf16 v[188:191], a[224:227], a[152:155], v[188:191]
    ds_read_b64_tr_b16 a[224:225], v91 offset:256
    v_mfma_f32_16x16x32_bf16 v[204:207], a[232:235], a[152:155], v[204:207]
    s_add_u32 s90, s30, 256
    ds_read_b64_tr_b16 a[226:227], v91 offset:1280
    v_mfma_f32_16x16x32_bf16 v[204:207], a[236:239], a[156:159], v[204:207]
    s_add_u32 m0, s6, 36864
    ds_read_b64_tr_b16 a[228:229], v91 offset:8448
    v_mfma_f32_16x16x32_bf16 v[200:203], a[236:239], a[148:151], v[200:203]
    buffer_load_dwordx4 v83, s[12:15], s90 offen offset:0 lds
    v_mfma_f32_16x16x32_bf16 v[200:203], a[232:235], a[144:147], v[200:203]
    ds_read_b64_tr_b16 a[230:231], v91 offset:9472
    v_add_u32 v91, 53248, v91
    v_mfma_f32_16x16x32_bf16 v[196:199], a[232:235], a[136:139], v[196:199]
    v_mfma_f32_16x16x32_bf16 v[196:199], a[236:239], a[140:143], v[196:199]
    v_mfma_f32_16x16x32_bf16 v[192:195], a[236:239], a[132:135], v[192:195]
    s_add_u32 s91, s30, 32000
    v_mfma_f32_16x16x32_bf16 v[192:195], a[232:235], a[128:131], v[192:195]
    buffer_load_dwordx4 v83, s[12:15], s91 offen offset:1024 lds
    v_mfma_f32_16x16x32_bf16 v[208:211], a[240:243], a[128:131], v[208:211]
    ds_read_b64_tr_b16 a[232:233], v93 offset:256
    v_mfma_f32_16x16x32_bf16 v[208:211], a[244:247], a[132:135], v[208:211]
    ds_read_b64_tr_b16 a[234:235], v93 offset:1280
    v_mfma_f32_16x16x32_bf16 v[212:215], a[244:247], a[140:143], v[212:215]
    ds_read_b64_tr_b16 a[236:237], v93 offset:8448
    v_mfma_f32_16x16x32_bf16 v[212:215], a[240:243], a[136:139], v[212:215]
    s_add_u32 s92, s30, 63744
    ds_read_b64_tr_b16 a[238:239], v93 offset:9472
    v_add_u32 v93, 53248, v93
    v_mfma_f32_16x16x32_bf16 v[216:219], a[240:243], a[144:147], v[216:219]
    buffer_load_dwordx4 v84, s[12:15], s92 offen offset:2048 lds
    v_mfma_f32_16x16x32_bf16 v[216:219], a[244:247], a[148:151], v[216:219]
    v_mfma_f32_16x16x32_bf16 v[220:223], a[244:247], a[156:159], v[220:223]
    v_mfma_f32_16x16x32_bf16 v[220:223], a[240:243], a[152:155], v[220:223]
    v_mfma_f32_16x16x32_bf16 v[236:239], a[248:251], a[152:155], v[236:239]
    s_add_u32 s93, s30, 95488
    v_mfma_f32_16x16x32_bf16 v[236:239], a[252:255], a[156:159], v[236:239]
    buffer_load_dwordx4 v84, s[12:15], s93 offen offset:3072 lds
    v_mfma_f32_16x16x32_bf16 v[232:235], a[252:255], a[148:151], v[232:235]
    v_mfma_f32_16x16x32_bf16 v[232:235], a[248:251], a[144:147], v[232:235]
    v_mfma_f32_16x16x32_bf16 v[228:231], a[248:251], a[136:139], v[228:231]
    v_mfma_f32_16x16x32_bf16 v[228:231], a[252:255], a[140:143], v[228:231]
    v_mfma_f32_16x16x32_bf16 v[224:227], a[252:255], a[132:135], v[224:227]
    v_mfma_f32_16x16x32_bf16 v[224:227], a[248:251], a[128:131], v[224:227]
    s_waitcnt vmcnt(14) lgkmcnt(0)
    s_barrier
    v_mfma_f32_16x16x32_bf16 v[112:115], a[176:179], v[32:35], v[112:115]
    s_bfe_u32 s28, s101, 0x40018
    ds_read_b64_tr_b16 a[240:241], v90 offset:0
    v_mfma_f32_16x16x32_bf16 v[112:115], a[180:183], v[36:39], v[112:115]
    s_mov_b32 s94, 32768
    ds_read_b64_tr_b16 a[242:243], v90 offset:1024
    v_mfma_f32_16x16x32_bf16 v[116:119], a[180:183], v[44:47], v[116:119]
    buffer_load_dwordx4 a[108:111], v3, s[16:19], s94 offen offset:3072 nt
    v_mfma_f32_16x16x32_bf16 v[116:119], a[176:179], v[40:43], v[116:119]
    s_lshl_b32 s30, s28, 19
    ds_read_b64_tr_b16 a[244:245], v90 offset:8192
    v_mfma_f32_16x16x32_bf16 v[120:123], a[176:179], v[48:51], v[120:123]
    s_lshl_b32 s28, s28, 7
    ds_read_b64_tr_b16 a[246:247], v90 offset:9216
    v_mfma_f32_16x16x32_bf16 v[120:123], a[180:183], v[52:55], v[120:123]
    s_mov_b32 s95, 163840
    ds_read_b64_tr_b16 a[248:249], v92 offset:0
    v_mfma_f32_16x16x32_bf16 v[124:127], a[180:183], v[60:63], v[124:127]
    buffer_load_dwordx4 a[112:115], v2, s[16:19], s95 offen offset:0 nt
    v_mfma_f32_16x16x32_bf16 v[124:127], a[176:179], v[56:59], v[124:127]
    ds_read_b64_tr_b16 a[250:251], v92 offset:1024
    v_mfma_f32_16x16x32_bf16 v[240:243], a[176:179], v[64:67], v[240:243]
    ds_read_b64_tr_b16 a[252:253], v92 offset:8192
    v_mfma_f32_16x16x32_bf16 v[240:243], a[180:183], v[68:71], v[240:243]
    ds_read_b64_tr_b16 a[254:255], v92 offset:9216
    v_mfma_f32_16x16x32_bf16 v[244:247], a[188:191], v[68:71], v[244:247]
    buffer_load_dwordx4 a[116:119], v2, s[16:19], s95 offen offset:1024 nt
    v_mfma_f32_16x16x32_bf16 v[244:247], a[184:187], v[64:67], v[244:247]
    ds_read_b64_tr_b16 a[176:177], v90 offset:256
    v_mfma_f32_16x16x32_bf16 v[140:143], a[184:187], v[56:59], v[140:143]
    ds_read_b64_tr_b16 a[178:179], v90 offset:1280
    v_mfma_f32_16x16x32_bf16 v[140:143], a[188:191], v[60:63], v[140:143]
    s_add_u32 m0, s6, 53248
    ds_read_b64_tr_b16 a[180:181], v90 offset:8448
    v_mfma_f32_16x16x32_bf16 v[136:139], a[188:191], v[52:55], v[136:139]
    buffer_load_dwordx4 v80, s[8:11], s29 offen offset:0 lds
    v_mfma_f32_16x16x32_bf16 v[136:139], a[184:187], v[48:51], v[136:139]
    ds_read_b64_tr_b16 a[182:183], v90 offset:9472
    v_add_u32 v90, 4294860800, v90
    v_mfma_f32_16x16x32_bf16 v[132:135], a[184:187], v[40:43], v[132:135]
    ds_read_b128 a[128:131], v85 offset:0
    v_mfma_f32_16x16x32_bf16 v[132:135], a[188:191], v[44:47], v[132:135]
    ds_read_b128 a[132:135], v85 offset:256
    v_add_u32 v85, 4294860800, v85
    v_mfma_f32_16x16x32_bf16 v[128:131], a[188:191], v[36:39], v[128:131]
    s_add_u32 s96, s29, 15360
    ds_read_b128 a[136:139], v86 offset:0
    v_mfma_f32_16x16x32_bf16 v[128:131], a[184:187], v[32:35], v[128:131]
    buffer_load_dwordx4 v81, s[8:11], s96 offen offset:1024 lds
    v_mfma_f32_16x16x32_bf16 v[144:147], a[192:195], v[32:35], v[144:147]
    ds_read_b64_tr_b16 a[184:185], v92 offset:256
    v_mfma_f32_16x16x32_bf16 v[144:147], a[196:199], v[36:39], v[144:147]
    ds_read_b64_tr_b16 a[186:187], v92 offset:1280
    v_mfma_f32_16x16x32_bf16 v[148:151], a[196:199], v[44:47], v[148:151]
    s_add_u32 s97, s29, 30720
    ds_read_b64_tr_b16 a[188:189], v92 offset:8448
    v_mfma_f32_16x16x32_bf16 v[148:151], a[192:195], v[40:43], v[148:151]
    buffer_load_dwordx4 v80, s[8:11], s97 offen offset:2048 lds
    v_mfma_f32_16x16x32_bf16 v[152:155], a[192:195], v[48:51], v[152:155]
    ds_read_b64_tr_b16 a[190:191], v92 offset:9472
    v_add_u32 v92, 4294860800, v92
    v_mfma_f32_16x16x32_bf16 v[152:155], a[196:199], v[52:55], v[152:155]
    ds_read_b128 a[140:143], v86 offset:256
    v_add_u32 v86, 4294860800, v86
    v_mfma_f32_16x16x32_bf16 v[156:159], a[196:199], v[60:63], v[156:159]
    s_add_u32 s90, s29, 46080
    ds_read_b128 a[144:147], v87 offset:0
    v_mfma_f32_16x16x32_bf16 v[156:159], a[192:195], v[56:59], v[156:159]
    buffer_load_dwordx4 v81, s[8:11], s90 offen offset:3072 lds
    v_mfma_f32_16x16x32_bf16 v[248:251], a[192:195], v[64:67], v[248:251]
    ds_read_b128 a[148:151], v87 offset:256
    v_add_u32 v87, 4294860800, v87
    v_mfma_f32_16x16x32_bf16 v[248:251], a[196:199], v[68:71], v[248:251]
    ds_read_b64_tr_b16 a[192:193], v91 offset:0
    v_mfma_f32_16x16x32_bf16 v[252:255], a[204:207], v[68:71], v[252:255]
    s_add_u32 m0, s7, 69632
    ds_read_b64_tr_b16 a[194:195], v91 offset:1024
    v_mfma_f32_16x16x32_bf16 v[252:255], a[200:203], v[64:67], v[252:255]
    s_mov_b32 exec_hi, 0
    buffer_load_dwordx4 v82, s[8:11], s29 offen lds
    s_mov_b32 exec_hi, -1
    v_mfma_f32_16x16x32_bf16 v[172:175], a[200:203], v[56:59], v[172:175]
    ds_read_b64_tr_b16 a[196:197], v91 offset:8192
    v_mfma_f32_16x16x32_bf16 v[172:175], a[204:207], v[60:63], v[172:175]
    ds_read_b64_tr_b16 a[198:199], v91 offset:9216
    v_mfma_f32_16x16x32_bf16 v[168:171], a[204:207], v[52:55], v[168:171]
    ds_read_b128 a[152:155], v88 offset:0
    v_mfma_f32_16x16x32_bf16 v[168:171], a[200:203], v[48:51], v[168:171]
    s_add_u32 m0, s6, 73728
    ds_read_b128 a[156:159], v88 offset:256
    v_add_u32 v88, 4294860800, v88
    v_mfma_f32_16x16x32_bf16 v[164:167], a[200:203], v[40:43], v[164:167]
    buffer_load_dwordx4 v83, s[12:15], s31 offen offset:0 lds
    v_mfma_f32_16x16x32_bf16 v[164:167], a[204:207], v[44:47], v[164:167]
    ds_read_b128 a[160:163], v89 offset:0
    v_mfma_f32_16x16x32_bf16 v[160:163], a[204:207], v[36:39], v[160:163]
    ds_read_b128 a[164:167], v89 offset:256
    v_add_u32 v89, 4294860800, v89
    v_mfma_f32_16x16x32_bf16 v[160:163], a[200:203], v[32:35], v[160:163]
    s_add_u32 s91, s31, 31744
    ds_read_b64_tr_b16 a[200:201], v93 offset:0
    v_mfma_f32_16x16x32_bf16 v[176:179], a[208:211], v[32:35], v[176:179]
    buffer_load_dwordx4 v83, s[12:15], s91 offen offset:1024 lds
    v_mfma_f32_16x16x32_bf16 v[176:179], a[212:215], v[36:39], v[176:179]
    ds_read_b64_tr_b16 a[202:203], v93 offset:1024
    v_mfma_f32_16x16x32_bf16 v[180:183], a[212:215], v[44:47], v[180:183]
    ds_read_b64_tr_b16 a[204:205], v93 offset:8192
    v_mfma_f32_16x16x32_bf16 v[180:183], a[208:211], v[40:43], v[180:183]
    s_add_u32 s92, s31, 63488
    ds_read_b64_tr_b16 a[206:207], v93 offset:9216
    v_mfma_f32_16x16x32_bf16 v[184:187], a[208:211], v[48:51], v[184:187]
    buffer_load_dwordx4 v84, s[12:15], s92 offen offset:2048 lds
    v_mfma_f32_16x16x32_bf16 v[184:187], a[212:215], v[52:55], v[184:187]
    v_mfma_f32_16x16x32_bf16 v[188:191], a[212:215], v[60:63], v[188:191]
    v_mfma_f32_16x16x32_bf16 v[188:191], a[208:211], v[56:59], v[188:191]
    s_add_u32 s93, s31, 95232
    ds_read_b64_tr_b16 a[208:209], v91 offset:256
    v_mfma_f32_16x16x32_bf16 v[204:207], a[216:219], v[56:59], v[204:207]
    buffer_load_dwordx4 v84, s[12:15], s93 offen offset:3072 lds
    v_mfma_f32_16x16x32_bf16 v[204:207], a[220:223], v[60:63], v[204:207]
    ds_read_b64_tr_b16 a[210:211], v91 offset:1280
    v_mfma_f32_16x16x32_bf16 v[200:203], a[220:223], v[52:55], v[200:203]
    ds_read_b64_tr_b16 a[212:213], v91 offset:8448
    v_mfma_f32_16x16x32_bf16 v[200:203], a[216:219], v[48:51], v[200:203]
    s_add_u32 s94, s31, 256
    ds_read_b64_tr_b16 a[214:215], v91 offset:9472
    v_add_u32 v91, 4294860800, v91
    v_mfma_f32_16x16x32_bf16 v[196:199], a[216:219], v[40:43], v[196:199]
    s_add_u32 m0, s6, 90112
    v_mfma_f32_16x16x32_bf16 v[196:199], a[220:223], v[44:47], v[196:199]
    buffer_load_dwordx4 v83, s[12:15], s94 offen offset:0 lds
    v_mfma_f32_16x16x32_bf16 v[192:195], a[220:223], v[36:39], v[192:195]
    v_mfma_f32_16x16x32_bf16 v[192:195], a[216:219], v[32:35], v[192:195]
    ds_read_b64_tr_b16 a[216:217], v93 offset:256
    v_mfma_f32_16x16x32_bf16 v[208:211], a[224:227], v[32:35], v[208:211]
    s_add_u32 s95, s31, 32000
    ds_read_b64_tr_b16 a[218:219], v93 offset:1280
    v_mfma_f32_16x16x32_bf16 v[208:211], a[228:231], v[36:39], v[208:211]
    buffer_load_dwordx4 v83, s[12:15], s95 offen offset:1024 lds
    v_mfma_f32_16x16x32_bf16 v[212:215], a[228:231], v[44:47], v[212:215]
    ds_read_b64_tr_b16 a[220:221], v93 offset:8448
    v_mfma_f32_16x16x32_bf16 v[212:215], a[224:227], v[40:43], v[212:215]
    ds_read_b64_tr_b16 a[222:223], v93 offset:9472
    v_add_u32 v93, 4294860800, v93
    v_mfma_f32_16x16x32_bf16 v[216:219], a[224:227], v[48:51], v[216:219]
    s_add_u32 s96, s31, 63744
    v_mfma_f32_16x16x32_bf16 v[216:219], a[228:231], v[52:55], v[216:219]
    buffer_load_dwordx4 v84, s[12:15], s96 offen offset:2048 lds
    v_mfma_f32_16x16x32_bf16 v[220:223], a[228:231], v[60:63], v[220:223]
    v_mfma_f32_16x16x32_bf16 v[220:223], a[224:227], v[56:59], v[220:223]
    v_mfma_f32_16x16x32_bf16 v[236:239], a[232:235], v[56:59], v[236:239]
    s_add_u32 s97, s31, 95488
    v_mfma_f32_16x16x32_bf16 v[236:239], a[236:239], v[60:63], v[236:239]
    buffer_load_dwordx4 v84, s[12:15], s97 offen offset:3072 lds
    v_mfma_f32_16x16x32_bf16 v[232:235], a[236:239], v[52:55], v[232:235]
    v_mfma_f32_16x16x32_bf16 v[232:235], a[232:235], v[48:51], v[232:235]
    v_mfma_f32_16x16x32_bf16 v[228:231], a[232:235], v[40:43], v[228:231]
    v_mfma_f32_16x16x32_bf16 v[228:231], a[236:239], v[44:47], v[228:231]
    v_mfma_f32_16x16x32_bf16 v[224:227], a[236:239], v[36:39], v[224:227]
    v_mfma_f32_16x16x32_bf16 v[224:227], a[232:235], v[32:35], v[224:227]
    s_waitcnt vmcnt(16) lgkmcnt(0)
    s_barrier
    v_mfma_f32_16x16x32_bf16 v[112:115], a[240:243], a[128:131], v[112:115]
    s_bfe_u32 s29, s101, 0x4001c
    ds_read_b64_tr_b16 a[224:225], v90 offset:0
    v_mfma_f32_16x16x32_bf16 v[112:115], a[244:247], a[132:135], v[112:115]
    s_mov_b32 s90, 65536
    ds_read_b64_tr_b16 a[226:227], v90 offset:1024
    v_mfma_f32_16x16x32_bf16 v[116:119], a[244:247], a[140:143], v[116:119]
    s_mov_b32 exec_lo, 0xffffffff
    s_mov_b32 exec_hi, 0xff
    buffer_load_dword v1, v6, s[16:19], s90 offen
    s_mov_b64 exec, -1
    v_mfma_f32_16x16x32_bf16 v[116:119], a[240:243], a[136:139], v[116:119]
    s_lshl_b32 s31, s29, 19
    ds_read_b64_tr_b16 a[228:229], v90 offset:8192
    v_mfma_f32_16x16x32_bf16 v[120:123], a[240:243], a[144:147], v[120:123]
    s_lshl_b32 s29, s29, 7
    ds_read_b64_tr_b16 a[230:231], v90 offset:9216
    v_mfma_f32_16x16x32_bf16 v[120:123], a[244:247], a[148:151], v[120:123]
    s_add_u32 m0, s6, 106496
    ds_read_b64_tr_b16 a[232:233], v92 offset:0
    v_mfma_f32_16x16x32_bf16 v[124:127], a[244:247], a[156:159], v[124:127]
    buffer_load_dwordx4 v80, s[8:11], s28 offen offset:0 lds
    v_mfma_f32_16x16x32_bf16 v[124:127], a[240:243], a[152:155], v[124:127]
    ds_read_b64_tr_b16 a[234:235], v92 offset:1024
    v_mfma_f32_16x16x32_bf16 v[240:243], a[240:243], a[160:163], v[240:243]
    ds_read_b64_tr_b16 a[236:237], v92 offset:8192
    v_mfma_f32_16x16x32_bf16 v[240:243], a[244:247], a[164:167], v[240:243]
    ds_read_b64_tr_b16 a[238:239], v92 offset:9216
    v_mfma_f32_16x16x32_bf16 v[244:247], a[252:255], a[164:167], v[244:247]
    s_add_u32 s91, s28, 15360
    ds_read_b64_tr_b16 a[240:241], v90 offset:256
    v_mfma_f32_16x16x32_bf16 v[244:247], a[248:251], a[160:163], v[244:247]
    buffer_load_dwordx4 v81, s[8:11], s91 offen offset:1024 lds
    v_mfma_f32_16x16x32_bf16 v[140:143], a[248:251], a[152:155], v[140:143]
    ds_read_b64_tr_b16 a[242:243], v90 offset:1280
    v_mfma_f32_16x16x32_bf16 v[140:143], a[252:255], a[156:159], v[140:143]
    ds_read_b64_tr_b16 a[244:245], v90 offset:8448
    v_mfma_f32_16x16x32_bf16 v[136:139], a[252:255], a[148:151], v[136:139]
    ds_read_b64_tr_b16 a[246:247], v90 offset:9472
    v_add_u32 v90, 53248, v90
    v_mfma_f32_16x16x32_bf16 v[136:139], a[248:251], a[144:147], v[136:139]
    s_add_u32 s92, s28, 30720
    ds_read_b128 v[32:35], v85 offset:0
    v_mfma_f32_16x16x32_bf16 v[132:135], a[248:251], a[136:139], v[132:135]
    buffer_load_dwordx4 v80, s[8:11], s92 offen offset:2048 lds
    v_mfma_f32_16x16x32_bf16 v[132:135], a[252:255], a[140:143], v[132:135]
    ds_read_b128 v[36:39], v85 offset:256
    v_add_u32 v85, 53248, v85
    v_mfma_f32_16x16x32_bf16 v[128:131], a[252:255], a[132:135], v[128:131]
    ds_read_b128 v[40:43], v86 offset:0
    v_mfma_f32_16x16x32_bf16 v[128:131], a[248:251], a[128:131], v[128:131]
    ds_read_b64_tr_b16 a[248:249], v92 offset:256
    v_mfma_f32_16x16x32_bf16 v[144:147], a[176:179], a[128:131], v[144:147]
    s_add_u32 s93, s28, 46080
    ds_read_b64_tr_b16 a[250:251], v92 offset:1280
    v_mfma_f32_16x16x32_bf16 v[144:147], a[180:183], a[132:135], v[144:147]
    buffer_load_dwordx4 v81, s[8:11], s93 offen offset:3072 lds
    v_mfma_f32_16x16x32_bf16 v[148:151], a[180:183], a[140:143], v[148:151]
    ds_read_b64_tr_b16 a[252:253], v92 offset:8448
    v_mfma_f32_16x16x32_bf16 v[148:151], a[176:179], a[136:139], v[148:151]
    ds_read_b64_tr_b16 a[254:255], v92 offset:9472
    v_add_u32 v92, 53248, v92
    v_mfma_f32_16x16x32_bf16 v[152:155], a[176:179], a[144:147], v[152:155]
    ds_read_b128 v[44:47], v86 offset:256
    v_add_u32 v86, 53248, v86
    v_mfma_f32_16x16x32_bf16 v[152:155], a[180:183], a[148:151], v[152:155]
    s_add_u32 m0, s7, 122880
    ds_read_b128 v[48:51], v87 offset:0
    v_mfma_f32_16x16x32_bf16 v[156:159], a[180:183], a[156:159], v[156:159]
    s_mov_b32 exec_hi, 0
    buffer_load_dwordx4 v82, s[8:11], s28 offen lds
    s_mov_b32 exec_hi, -1
    v_mfma_f32_16x16x32_bf16 v[156:159], a[176:179], a[152:155], v[156:159]
    ds_read_b128 v[52:55], v87 offset:256
    v_add_u32 v87, 53248, v87
    v_mfma_f32_16x16x32_bf16 v[248:251], a[176:179], a[160:163], v[248:251]
    ds_read_b128 v[56:59], v88 offset:0
    v_mfma_f32_16x16x32_bf16 v[248:251], a[180:183], a[164:167], v[248:251]
    ds_read_b64_tr_b16 a[176:177], v91 offset:0
    v_mfma_f32_16x16x32_bf16 v[252:255], a[188:191], a[164:167], v[252:255]
    s_add_u32 m0, s6, 126976
    ds_read_b64_tr_b16 a[178:179], v91 offset:1024
    v_mfma_f32_16x16x32_bf16 v[252:255], a[184:187], a[160:163], v[252:255]
    buffer_load_dwordx4 v83, s[12:15], s30 offen offset:0 lds
    v_mfma_f32_16x16x32_bf16 v[172:175], a[184:187], a[152:155], v[172:175]
    ds_read_b64_tr_b16 a[180:181], v91 offset:8192
    v_mfma_f32_16x16x32_bf16 v[172:175], a[188:191], a[156:159], v[172:175]
    ds_read_b64_tr_b16 a[182:183], v91 offset:9216
    v_mfma_f32_16x16x32_bf16 v[168:171], a[188:191], a[148:151], v[168:171]
    ds_read_b128 v[60:63], v88 offset:256
    v_add_u32 v88, 53248, v88
    v_mfma_f32_16x16x32_bf16 v[168:171], a[184:187], a[144:147], v[168:171]
    s_add_u32 s94, s30, 31744
    ds_read_b128 v[64:67], v89 offset:0
    v_mfma_f32_16x16x32_bf16 v[164:167], a[184:187], a[136:139], v[164:167]
    buffer_load_dwordx4 v83, s[12:15], s94 offen offset:1024 lds
    v_mfma_f32_16x16x32_bf16 v[164:167], a[188:191], a[140:143], v[164:167]
    ds_read_b128 v[68:71], v89 offset:256
    v_add_u32 v89, 53248, v89
    v_mfma_f32_16x16x32_bf16 v[160:163], a[188:191], a[132:135], v[160:163]
    v_mfma_f32_16x16x32_bf16 v[160:163], a[184:187], a[128:131], v[160:163]
    s_add_u32 s95, s30, 63488
    ds_read_b64_tr_b16 a[184:185], v93 offset:0
    v_mfma_f32_16x16x32_bf16 v[176:179], a[192:195], a[128:131], v[176:179]
    buffer_load_dwordx4 v84, s[12:15], s95 offen offset:2048 lds
    v_mfma_f32_16x16x32_bf16 v[176:179], a[196:199], a[132:135], v[176:179]
    ds_read_b64_tr_b16 a[186:187], v93 offset:1024
    v_mfma_f32_16x16x32_bf16 v[180:183], a[196:199], a[140:143], v[180:183]
    ds_read_b64_tr_b16 a[188:189], v93 offset:8192
    v_mfma_f32_16x16x32_bf16 v[180:183], a[192:195], a[136:139], v[180:183]
    ds_read_b64_tr_b16 a[190:191], v93 offset:9216
    v_mfma_f32_16x16x32_bf16 v[184:187], a[192:195], a[144:147], v[184:187]
    s_add_u32 s96, s30, 95232
    v_mfma_f32_16x16x32_bf16 v[184:187], a[196:199], a[148:151], v[184:187]
    buffer_load_dwordx4 v84, s[12:15], s96 offen offset:3072 lds
    v_mfma_f32_16x16x32_bf16 v[188:191], a[196:199], a[156:159], v[188:191]
    v_mfma_f32_16x16x32_bf16 v[188:191], a[192:195], a[152:155], v[188:191]
    ds_read_b64_tr_b16 a[192:193], v91 offset:256
    v_mfma_f32_16x16x32_bf16 v[204:207], a[200:203], a[152:155], v[204:207]
    s_add_u32 s97, s30, 256
    ds_read_b64_tr_b16 a[194:195], v91 offset:1280
    v_mfma_f32_16x16x32_bf16 v[204:207], a[204:207], a[156:159], v[204:207]
    s_add_u32 m0, s6, 143360
    ds_read_b64_tr_b16 a[196:197], v91 offset:8448
    v_mfma_f32_16x16x32_bf16 v[200:203], a[204:207], a[148:151], v[200:203]
    buffer_load_dwordx4 v83, s[12:15], s97 offen offset:0 lds
    v_mfma_f32_16x16x32_bf16 v[200:203], a[200:203], a[144:147], v[200:203]
    ds_read_b64_tr_b16 a[198:199], v91 offset:9472
    v_add_u32 v91, 53248, v91
    v_mfma_f32_16x16x32_bf16 v[196:199], a[200:203], a[136:139], v[196:199]
    v_mfma_f32_16x16x32_bf16 v[196:199], a[204:207], a[140:143], v[196:199]
    v_mfma_f32_16x16x32_bf16 v[192:195], a[204:207], a[132:135], v[192:195]
    s_add_u32 s90, s30, 32000
    v_mfma_f32_16x16x32_bf16 v[192:195], a[200:203], a[128:131], v[192:195]
    buffer_load_dwordx4 v83, s[12:15], s90 offen offset:1024 lds
    v_mfma_f32_16x16x32_bf16 v[208:211], a[208:211], a[128:131], v[208:211]
    ds_read_b64_tr_b16 a[200:201], v93 offset:256
    v_mfma_f32_16x16x32_bf16 v[208:211], a[212:215], a[132:135], v[208:211]
    ds_read_b64_tr_b16 a[202:203], v93 offset:1280
    v_mfma_f32_16x16x32_bf16 v[212:215], a[212:215], a[140:143], v[212:215]
    ds_read_b64_tr_b16 a[204:205], v93 offset:8448
    v_mfma_f32_16x16x32_bf16 v[212:215], a[208:211], a[136:139], v[212:215]
    s_add_u32 s91, s30, 63744
    ds_read_b64_tr_b16 a[206:207], v93 offset:9472
    v_add_u32 v93, 53248, v93
    v_mfma_f32_16x16x32_bf16 v[216:219], a[208:211], a[144:147], v[216:219]
    buffer_load_dwordx4 v84, s[12:15], s91 offen offset:2048 lds
    v_mfma_f32_16x16x32_bf16 v[216:219], a[212:215], a[148:151], v[216:219]
    v_mfma_f32_16x16x32_bf16 v[220:223], a[212:215], a[156:159], v[220:223]
    v_mfma_f32_16x16x32_bf16 v[220:223], a[208:211], a[152:155], v[220:223]
    v_mfma_f32_16x16x32_bf16 v[236:239], a[216:219], a[152:155], v[236:239]
    s_add_u32 s92, s30, 95488
    v_mfma_f32_16x16x32_bf16 v[236:239], a[220:223], a[156:159], v[236:239]
    buffer_load_dwordx4 v84, s[12:15], s92 offen offset:3072 lds
    v_mfma_f32_16x16x32_bf16 v[232:235], a[220:223], a[148:151], v[232:235]
    v_mfma_f32_16x16x32_bf16 v[232:235], a[216:219], a[144:147], v[232:235]
    v_mfma_f32_16x16x32_bf16 v[228:231], a[216:219], a[136:139], v[228:231]
    v_mfma_f32_16x16x32_bf16 v[228:231], a[220:223], a[140:143], v[228:231]
    v_mfma_f32_16x16x32_bf16 v[224:227], a[220:223], a[132:135], v[224:227]
    v_mfma_f32_16x16x32_bf16 v[224:227], a[216:219], a[128:131], v[224:227]
    s_waitcnt vmcnt(14) lgkmcnt(0)
    s_barrier
    s_getpc_b64 s[52:53]
L_pc2:
    s_lshr_b32 s54, s2, 3
    s_lshl_b32 s54, s54, 9
    s_lshl_b32 s55, s3, 7
    s_add_u32 s54, s54, s55
    s_add_u32 s54, s54, L_trans-L_pc2
    s_min_u32 s54, s54, L_code_end-L_pc2-4
    v_mov_b32 v28, s54
    s_mov_b64 exec, 1
    global_load_dword v1, v28, s[52:53]
    s_mov_b64 exec, -1
    v_mfma_f32_16x16x32_bf16 v[112:115], a[224:227], v[32:35], v[112:115]
    ds_read_b64_tr_b16 a[208:209], v90 offset:0
    v_mfma_f32_16x16x32_bf16 v[112:115], a[228:231], v[36:39], v[112:115]
    s_mov_b32 s93, 163840
    ds_read_b64_tr_b16 a[210:211], v90 offset:1024
    v_mfma_f32_16x16x32_bf16 v[116:119], a[228:231], v[44:47], v[116:119]
    buffer_load_dwordx4 a[120:123], v3, s[16:19], s93 offen offset:2048 nt
    v_mfma_f32_16x16x32_bf16 v[116:119], a[224:227], v[40:43], v[116:119]
    ds_read_b64_tr_b16 a[212:213], v90 offset:8192
    v_mfma_f32_16x16x32_bf16 v[120:123], a[224:227], v[48:51], v[120:123]
    ds_read_b64_tr_b16 a[214:215], v90 offset:9216
    v_mfma_f32_16x16x32_bf16 v[120:123], a[228:231], v[52:55], v[120:123]
    ds_read_b64_tr_b16 a[216:217], v92 offset:0
    v_mfma_f32_16x16x32_bf16 v[124:127], a[228:231], v[60:63], v[124:127]
    buffer_load_dwordx4 a[124:127], v3, s[16:19], s93 offen offset:3072 nt
    v_mfma_f32_16x16x32_bf16 v[124:127], a[224:227], v[56:59], v[124:127]
    ds_read_b64_tr_b16 a[218:219], v92 offset:1024
    v_mfma_f32_16x16x32_bf16 v[240:243], a[224:227], v[64:67], v[240:243]
    ds_read_b64_tr_b16 a[220:221], v92 offset:8192
    v_mfma_f32_16x16x32_bf16 v[240:243], a[228:231], v[68:71], v[240:243]
    ds_read_b64_tr_b16 a[222:223], v92 offset:9216
    v_mfma_f32_16x16x32_bf16 v[244:247], a[236:239], v[68:71], v[244:247]
    s_add_u32 m0, s6, 0
    ds_read_b64_tr_b16 a[224:225], v90 offset:256
    v_mfma_f32_16x16x32_bf16 v[244:247], a[232:235], v[64:67], v[244:247]
    buffer_load_dwordx4 v80, s[8:11], s29 offen offset:0 lds
    v_mfma_f32_16x16x32_bf16 v[140:143], a[232:235], v[56:59], v[140:143]
    ds_read_b64_tr_b16 a[226:227], v90 offset:1280
    v_mfma_f32_16x16x32_bf16 v[140:143], a[236:239], v[60:63], v[140:143]
    ds_read_b64_tr_b16 a[228:229], v90 offset:8448
    v_mfma_f32_16x16x32_bf16 v[136:139], a[236:239], v[52:55], v[136:139]
    s_add_u32 s94, s29, 15360
    ds_read_b64_tr_b16 a[230:231], v90 offset:9472
    v_add_u32 v90, 53248, v90
    v_mfma_f32_16x16x32_bf16 v[136:139], a[232:235], v[48:51], v[136:139]
    buffer_load_dwordx4 v81, s[8:11], s94 offen offset:1024 lds
    v_mfma_f32_16x16x32_bf16 v[132:135], a[232:235], v[40:43], v[132:135]
    ds_read_b128 a[128:131], v85 offset:0
    v_mfma_f32_16x16x32_bf16 v[132:135], a[236:239], v[44:47], v[132:135]
    ds_read_b128 a[132:135], v85 offset:256
    v_add_u32 v85, 53248, v85
    v_mfma_f32_16x16x32_bf16 v[128:131], a[236:239], v[36:39], v[128:131]
    ds_read_b128 a[136:139], v86 offset:0
    v_mfma_f32_16x16x32_bf16 v[128:131], a[232:235], v[32:35], v[128:131]
    s_add_u32 s95, s29, 30720
    ds_read_b64_tr_b16 a[232:233], v92 offset:256
    v_mfma_f32_16x16x32_bf16 v[144:147], a[240:243], v[32:35], v[144:147]
    buffer_load_dwordx4 v80, s[8:11], s95 offen offset:2048 lds
    v_mfma_f32_16x16x32_bf16 v[144:147], a[244:247], v[36:39], v[144:147]
    ds_read_b64_tr_b16 a[234:235], v92 offset:1280
    v_mfma_f32_16x16x32_bf16 v[148:151], a[244:247], v[44:47], v[148:151]
    ds_read_b64_tr_b16 a[236:237], v92 offset:8448
    v_mfma_f32_16x16x32_bf16 v[148:151], a[240:243], v[40:43], v[148:151]
    s_add_u32 s96, s29, 46080
    ds_read_b64_tr_b16 a[238:239], v92 offset:9472
    v_add_u32 v92, 53248, v92
    v_mfma_f32_16x16x32_bf16 v[152:155], a[240:243], v[48:51], v[152:155]
    buffer_load_dwordx4 v81, s[8:11], s96 offen offset:3072 lds
    v_mfma_f32_16x16x32_bf16 v[152:155], a[244:247], v[52:55], v[152:155]
    ds_read_b128 a[140:143], v86 offset:256
    v_add_u32 v86, 53248, v86
    v_mfma_f32_16x16x32_bf16 v[156:159], a[244:247], v[60:63], v[156:159]
    ds_read_b128 a[144:147], v87 offset:0
    v_mfma_f32_16x16x32_bf16 v[156:159], a[240:243], v[56:59], v[156:159]
    ds_read_b128 a[148:151], v87 offset:256
    v_add_u32 v87, 53248, v87
    v_mfma_f32_16x16x32_bf16 v[248:251], a[240:243], v[64:67], v[248:251]
    s_add_u32 m0, s7, 16384
    ds_read_b128 a[152:155], v88 offset:0
    v_mfma_f32_16x16x32_bf16 v[248:251], a[244:247], v[68:71], v[248:251]
    s_mov_b32 exec_hi, 0
    buffer_load_dwordx4 v82, s[8:11], s29 offen lds
    s_mov_b32 exec_hi, -1
    v_mfma_f32_16x16x32_bf16 v[252:255], a[252:255], v[68:71], v[252:255]
    ds_read_b64_tr_b16 a[240:241], v91 offset:0
    v_mfma_f32_16x16x32_bf16 v[252:255], a[248:251], v[64:67], v[252:255]
    ds_read_b64_tr_b16 a[242:243], v91 offset:1024
    v_mfma_f32_16x16x32_bf16 v[172:175], a[248:251], v[56:59], v[172:175]
    s_add_u32 m0, s6, 20480
    ds_read_b64_tr_b16 a[244:245], v91 offset:8192
    v_mfma_f32_16x16x32_bf16 v[172:175], a[252:255], v[60:63], v[172:175]
    buffer_load_dwordx4 v83, s[12:15], s31 offen offset:0 lds
    v_mfma_f32_16x16x32_bf16 v[168:171], a[252:255], v[52:55], v[168:171]
    ds_read_b64_tr_b16 a[246:247], v91 offset:9216
    v_mfma_f32_16x16x32_bf16 v[168:171], a[248:251], v[48:51], v[168:171]
    ds_read_b128 a[156:159], v88 offset:256
    v_add_u32 v88, 53248, v88
    v_mfma_f32_16x16x32_bf16 v[164:167], a[248:251], v[40:43], v[164:167]
    ds_read_b128 a[160:163], v89 offset:0
    v_mfma_f32_16x16x32_bf16 v[164:167], a[252:255], v[44:47], v[164:167]
    s_add_u32 s97, s31, 31744
    ds_read_b128 a[164:167], v89 offset:256
    v_add_u32 v89, 53248, v89
    v_mfma_f32_16x16x32_bf16 v[160:163], a[252:255], v[36:39], v[160:163]
    buffer_load_dwordx4 v83, s[12:15], s97 offen offset:1024 lds
    v_mfma_f32_16x16x32_bf16 v[160:163], a[248:251], v[32:35], v[160:163]
    ds_read_b64_tr_b16 a[248:249], v93 offset:0
    v_mfma_f32_16x16x32_bf16 v[176:179], a[176:179], v[32:35], v[176:179]
    ds_read_b64_tr_b16 a[250:251], v93 offset:1024
    v_mfma_f32_16x16x32_bf16 v[176:179], a[180:183], v[36:39], v[176:179]
    s_add_u32 s90, s31, 63488
    ds_read_b64_tr_b16 a[252:253], v93 offset:8192
    v_mfma_f32_16x16x32_bf16 v[180:183], a[180:183], v[44:47], v[180:183]
    buffer_load_dwordx4 v84, s[12:15], s90 offen offset:2048 lds
    v_mfma_f32_16x16x32_bf16 v[180:183], a[176:179], v[40:43], v[180:183]
    ds_read_b64_tr_b16 a[254:255], v93 offset:9216
    v_mfma_f32_16x16x32_bf16 v[184:187], a[176:179], v[48:51], v[184:187]
    v_mfma_f32_16x16x32_bf16 v[184:187], a[180:183], v[52:55], v[184:187]
    v_mfma_f32_16x16x32_bf16 v[188:191], a[180:183], v[60:63], v[188:191]
    s_add_u32 s91, s31, 95232
    v_mfma_f32_16x16x32_bf16 v[188:191], a[176:179], v[56:59], v[188:191]
    buffer_load_dwordx4 v84, s[12:15], s91 offen offset:3072 lds
    v_mfma_f32_16x16x32_bf16 v[204:207], a[184:187], v[56:59], v[204:207]
    ds_read_b64_tr_b16 a[176:177], v91 offset:256
    v_mfma_f32_16x16x32_bf16 v[204:207], a[188:191], v[60:63], v[204:207]
    s_add_u32 s92, s31, 256
    ds_read_b64_tr_b16 a[178:179], v91 offset:1280
    v_mfma_f32_16x16x32_bf16 v[200:203], a[188:191], v[52:55], v[200:203]
    s_add_u32 m0, s6, 36864
    ds_read_b64_tr_b16 a[180:181], v91 offset:8448
    v_mfma_f32_16x16x32_bf16 v[200:203], a[184:187], v[48:51], v[200:203]
    buffer_load_dwordx4 v83, s[12:15], s92 offen offset:0 lds
    v_mfma_f32_16x16x32_bf16 v[196:199], a[184:187], v[40:43], v[196:199]
    ds_read_b64_tr_b16 a[182:183], v91 offset:9472
    v_add_u32 v91, 53248, v91
    v_mfma_f32_16x16x32_bf16 v[196:199], a[188:191], v[44:47], v[196:199]
    v_mfma_f32_16x16x32_bf16 v[192:195], a[188:191], v[36:39], v[192:195]
    v_mfma_f32_16x16x32_bf16 v[192:195], a[184:187], v[32:35], v[192:195]
    s_add_u32 s93, s31, 32000
    ds_read_b64_tr_b16 a[184:185], v93 offset:256
    v_mfma_f32_16x16x32_bf16 v[208:211], a[192:195], v[32:35], v[208:211]
    buffer_load_dwordx4 v83, s[12:15], s93 offen offset:1024 lds
    v_mfma_f32_16x16x32_bf16 v[208:211], a[196:199], v[36:39], v[208:211]
    ds_read_b64_tr_b16 a[186:187], v93 offset:1280
    v_mfma_f32_16x16x32_bf16 v[212:215], a[196:199], v[44:47], v[212:215]
    ds_read_b64_tr_b16 a[188:189], v93 offset:8448
    v_mfma_f32_16x16x32_bf16 v[212:215], a[192:195], v[40:43], v[212:215]
    s_add_u32 s94, s31, 63744
    ds_read_b64_tr_b16 a[190:191], v93 offset:9472
    v_add_u32 v93, 53248, v93
    v_mfma_f32_16x16x32_bf16 v[216:219], a[192:195], v[48:51], v[216:219]
    buffer_load_dwordx4 v84, s[12:15], s94 offen offset:2048 lds
    v_mfma_f32_16x16x32_bf16 v[216:219], a[196:199], v[52:55], v[216:219]
    v_mfma_f32_16x16x32_bf16 v[220:223], a[196:199], v[60:63], v[220:223]
    v_mfma_f32_16x16x32_bf16 v[220:223], a[192:195], v[56:59], v[220:223]
    v_mfma_f32_16x16x32_bf16 v[236:239], a[200:203], v[56:59], v[236:239]
    s_add_u32 s95, s31, 95488
    v_mfma_f32_16x16x32_bf16 v[236:239], a[204:207], v[60:63], v[236:239]
    buffer_load_dwordx4 v84, s[12:15], s95 offen offset:3072 lds
    v_mfma_f32_16x16x32_bf16 v[232:235], a[204:207], v[52:55], v[232:235]
    v_mfma_f32_16x16x32_bf16 v[232:235], a[200:203], v[48:51], v[232:235]
    v_mfma_f32_16x16x32_bf16 v[228:231], a[200:203], v[40:43], v[228:231]
    v_mfma_f32_16x16x32_bf16 v[228:231], a[204:207], v[44:47], v[228:231]
    v_mfma_f32_16x16x32_bf16 v[224:227], a[204:207], v[36:39], v[224:227]
    v_mfma_f32_16x16x32_bf16 v[224:227], a[200:203], v[32:35], v[224:227]
    s_waitcnt vmcnt(15) lgkmcnt(0)
    s_barrier
    v_mfma_f32_16x16x32_bf16 v[112:115], a[208:211], a[128:131], v[112:115]
    ds_read_b64_tr_b16 a[192:193], v90 offset:0
    v_mfma_f32_16x16x32_bf16 v[112:115], a[212:215], a[132:135], v[112:115]
    ds_read_b64_tr_b16 a[194:195], v90 offset:1024
    v_mfma_f32_16x16x32_bf16 v[116:119], a[212:215], a[140:143], v[116:119]
    buffer_load_dword v12, v13, s[56:59], 0 offen sc1
    v_mfma_f32_16x16x32_bf16 v[116:119], a[208:211], a[136:139], v[116:119]
    ds_read_b64_tr_b16 a[196:197], v90 offset:8192
    v_mfma_f32_16x16x32_bf16 v[120:123], a[208:211], a[144:147], v[120:123]
    ds_read_b64_tr_b16 a[198:199], v90 offset:9216
    v_mfma_f32_16x16x32_bf16 v[120:123], a[212:215], a[148:151], v[120:123]
    ds_read_b64_tr_b16 a[200:201], v92 offset:0
    v_mfma_f32_16x16x32_bf16 v[124:127], a[212:215], a[156:159], v[124:127]
    ds_read_b64_tr_b16 a[202:203], v92 offset:1024
    v_mfma_f32_16x16x32_bf16 v[124:127], a[208:211], a[152:155], v[124:127]
    s_mov_b32 s96, 81920
    ds_read_b64_tr_b16 a[204:205], v92 offset:8192
    v_mfma_f32_16x16x32_bf16 v[240:243], a[208:211], a[160:163], v[240:243]
    s_mov_b32 exec_lo, 0xffffffff
    s_mov_b32 exec_hi, 0xff
    buffer_load_dword v1, v6, s[16:19], s96 offen
    s_mov_b64 exec, -1
    v_mfma_f32_16x16x32_bf16 v[240:243], a[212:215], a[164:167], v[240:243]
    ds_read_b64_tr_b16 a[206:207], v92 offset:9216
    v_mfma_f32_16x16x32_bf16 v[244:247], a[220:223], a[164:167], v[244:247]
    ds_read_b64_tr_b16 a[208:209], v90 offset:256
    v_mfma_f32_16x16x32_bf16 v[244:247], a[216:219], a[160:163], v[244:247]
    ds_read_b64_tr_b16 a[210:211], v90 offset:1280
    v_mfma_f32_16x16x32_bf16 v[140:143], a[216:219], a[152:155], v[140:143]
    ds_read_b64_tr_b16 a[212:213], v90 offset:8448
    v_mfma_f32_16x16x32_bf16 v[140:143], a[220:223], a[156:159], v[140:143]
    ds_read_b64_tr_b16 a[214:215], v90 offset:9472
    v_add_u32 v90, 4294860800, v90
    v_mfma_f32_16x16x32_bf16 v[136:139], a[220:223], a[148:151], v[136:139]
    s_waitcnt vmcnt(63)
    ds_read_b128 v[32:35], v85 offset:0
    v_mfma_f32_16x16x32_bf16 v[136:139], a[216:219], a[144:147], v[136:139]
    ds_write_b128 v105, a[0:3] offset:0
    v_mfma_f32_16x16x32_bf16 v[132:135], a[216:219], a[136:139], v[132:135]
    ds_read_b128 v[36:39], v85 offset:256
    v_add_u32 v85, 4294860800, v85
    v_mfma_f32_16x16x32_bf16 v[132:135], a[220:223], a[140:143], v[132:135]
    ds_read_b128 v[40:43], v86 offset:0
    v_mfma_f32_16x16x32_bf16 v[128:131], a[220:223], a[132:135], v[128:131]
    ds_read_b128 v[44:47], v86 offset:256
    v_add_u32 v86, 4294860800, v86
    v_mfma_f32_16x16x32_bf16 v[128:131], a[216:219], a[128:131], v[128:131]
    ds_read_b64_tr_b16 a[216:217], v92 offset:256
    v_mfma_f32_16x16x32_bf16 v[144:147], a[224:227], a[128:131], v[144:147]
    ds_read_b64_tr_b16 a[218:219], v92 offset:1280
    v_mfma_f32_16x16x32_bf16 v[144:147], a[228:231], a[132:135], v[144:147]
    ds_read_b64_tr_b16 a[220:221], v92 offset:8448
    v_mfma_f32_16x16x32_bf16 v[148:151], a[228:231], a[140:143], v[148:151]
    ds_write_b128 v105, a[4:7] offset:1024
    v_mfma_f32_16x16x32_bf16 v[148:151], a[224:227], a[136:139], v[148:151]
    ds_read_b64_tr_b16 a[222:223], v92 offset:9472
    v_add_u32 v92, 4294860800, v92
    v_mfma_f32_16x16x32_bf16 v[152:155], a[224:227], a[144:147], v[152:155]
    ds_read_b128 v[48:51], v87 offset:0
    v_mfma_f32_16x16x32_bf16 v[152:155], a[228:231], a[148:151], v[152:155]
    ds_read_b128 v[52:55], v87 offset:256
    v_add_u32 v87, 4294860800, v87
    v_mfma_f32_16x16x32_bf16 v[156:159], a[228:231], a[156:159], v[156:159]
    ds_read_b128 v[56:59], v88 offset:0
    v_mfma_f32_16x16x32_bf16 v[156:159], a[224:227], a[152:155], v[156:159]
    ds_read_b128 v[60:63], v88 offset:256
    v_add_u32 v88, 4294860800, v88
    v_mfma_f32_16x16x32_bf16 v[248:251], a[224:227], a[160:163], v[248:251]
    ds_read_b128 v[64:67], v89 offset:0
    v_mfma_f32_16x16x32_bf16 v[248:251], a[228:231], a[164:167], v[248:251]
    ds_write_b128 v105, a[8:11] offset:2048
    v_mfma_f32_16x16x32_bf16 v[252:255], a[236:239], a[164:167], v[252:255]
    ds_read_b64_tr_b16 a[224:225], v91 offset:0
    v_mfma_f32_16x16x32_bf16 v[252:255], a[232:235], a[160:163], v[252:255]
    ds_read_b64_tr_b16 a[226:227], v91 offset:1024
    v_mfma_f32_16x16x32_bf16 v[172:175], a[232:235], a[152:155], v[172:175]
    ds_read_b64_tr_b16 a[228:229], v91 offset:8192
    v_mfma_f32_16x16x32_bf16 v[172:175], a[236:239], a[156:159], v[172:175]
    ds_read_b64_tr_b16 a[230:231], v91 offset:9216
    v_mfma_f32_16x16x32_bf16 v[168:171], a[236:239], a[148:151], v[168:171]
    ds_read_b128 v[68:71], v89 offset:256
    v_add_u32 v89, 4294860800, v89
    v_mfma_f32_16x16x32_bf16 v[168:171], a[232:235], a[144:147], v[168:171]
    v_mfma_f32_16x16x32_bf16 v[164:167], a[232:235], a[136:139], v[164:167]
    ds_write_b128 v105, a[12:15] offset:3072
    v_mfma_f32_16x16x32_bf16 v[164:167], a[236:239], a[140:143], v[164:167]
    v_mfma_f32_16x16x32_bf16 v[160:163], a[236:239], a[132:135], v[160:163]
    v_mfma_f32_16x16x32_bf16 v[160:163], a[232:235], a[128:131], v[160:163]
    ds_read_b64_tr_b16 a[232:233], v93 offset:0
    v_mfma_f32_16x16x32_bf16 v[176:179], a[240:243], a[128:131], v[176:179]
    ds_read_b64_tr_b16 a[234:235], v93 offset:1024
    v_mfma_f32_16x16x32_bf16 v[176:179], a[244:247], a[132:135], v[176:179]
    ds_read_b64_tr_b16 a[236:237], v93 offset:8192
    v_mfma_f32_16x16x32_bf16 v[180:183], a[244:247], a[140:143], v[180:183]
    ds_write_b128 v105, a[16:19] offset:16384
    v_mfma_f32_16x16x32_bf16 v[180:183], a[240:243], a[136:139], v[180:183]
    ds_read_b64_tr_b16 a[238:239], v93 offset:9216
    v_mfma_f32_16x16x32_bf16 v[184:187], a[240:243], a[144:147], v[184:187]
    v_mfma_f32_16x16x32_bf16 v[184:187], a[244:247], a[148:151], v[184:187]
    v_mfma_f32_16x16x32_bf16 v[188:191], a[244:247], a[156:159], v[188:191]
    v_mfma_f32_16x16x32_bf16 v[188:191], a[240:243], a[152:155], v[188:191]
    ds_read_b64_tr_b16 a[240:241], v91 offset:256
    v_mfma_f32_16x16x32_bf16 v[204:207], a[248:251], a[152:155], v[204:207]
    ds_read_b64_tr_b16 a[242:243], v91 offset:1280
    v_mfma_f32_16x16x32_bf16 v[204:207], a[252:255], a[156:159], v[204:207]
    ds_write_b128 v105, a[20:23] offset:17408
    v_mfma_f32_16x16x32_bf16 v[200:203], a[252:255], a[148:151], v[200:203]
    ds_read_b64_tr_b16 a[244:245], v91 offset:8448
    v_mfma_f32_16x16x32_bf16 v[200:203], a[248:251], a[144:147], v[200:203]
    ds_read_b64_tr_b16 a[246:247], v91 offset:9472
    v_add_u32 v91, 4294860800, v91
    v_mfma_f32_16x16x32_bf16 v[196:199], a[248:251], a[136:139], v[196:199]
    v_mfma_f32_16x16x32_bf16 v[196:199], a[252:255], a[140:143], v[196:199]
    v_mfma_f32_16x16x32_bf16 v[192:195], a[252:255], a[132:135], v[192:195]
    v_mfma_f32_16x16x32_bf16 v[192:195], a[248:251], a[128:131], v[192:195]
    ds_read_b64_tr_b16 a[248:249], v93 offset:256
    v_mfma_f32_16x16x32_bf16 v[208:211], a[176:179], a[128:131], v[208:211]
    ds_write_b128 v105, a[24:27] offset:18432
    v_mfma_f32_16x16x32_bf16 v[208:211], a[180:183], a[132:135], v[208:211]
    ds_read_b64_tr_b16 a[250:251], v93 offset:1280
    v_mfma_f32_16x16x32_bf16 v[212:215], a[180:183], a[140:143], v[212:215]
    ds_read_b64_tr_b16 a[252:253], v93 offset:8448
    v_mfma_f32_16x16x32_bf16 v[212:215], a[176:179], a[136:139], v[212:215]
    ds_read_b64_tr_b16 a[254:255], v93 offset:9472
    v_add_u32 v93, 4294860800, v93
    v_mfma_f32_16x16x32_bf16 v[216:219], a[176:179], a[144:147], v[216:219]
    v_mfma_f32_16x16x32_bf16 v[216:219], a[180:183], a[148:151], v[216:219]
    v_mfma_f32_16x16x32_bf16 v[220:223], a[180:183], a[156:159], v[220:223]
    v_mfma_f32_16x16x32_bf16 v[220:223], a[176:179], a[152:155], v[220:223]
    ds_write_b128 v105, a[28:31] offset:19456
    v_mfma_f32_16x16x32_bf16 v[236:239], a[184:187], a[152:155], v[236:239]
    v_mfma_f32_16x16x32_bf16 v[236:239], a[188:191], a[156:159], v[236:239]
    v_mfma_f32_16x16x32_bf16 v[232:235], a[188:191], a[148:151], v[232:235]
    v_mfma_f32_16x16x32_bf16 v[232:235], a[184:187], a[144:147], v[232:235]
    v_mfma_f32_16x16x32_bf16 v[228:231], a[184:187], a[136:139], v[228:231]
    v_mfma_f32_16x16x32_bf16 v[228:231], a[188:191], a[140:143], v[228:231]
    v_mfma_f32_16x16x32_bf16 v[224:227], a[188:191], a[132:135], v[224:227]
    v_mfma_f32_16x16x32_bf16 v[224:227], a[184:187], a[128:131], v[224:227]
    s_waitcnt vmcnt(2) lgkmcnt(0)
    s_barrier
    v_mfma_f32_16x16x32_bf16 v[112:115], a[192:195], v[32:35], v[112:115]
    s_bfe_u32 s54, s2, 0x20003
    ds_read_b64_tr_b16 a[176:177], v90 offset:0
    v_mfma_f32_16x16x32_bf16 v[112:115], a[196:199], v[36:39], v[112:115]
    s_mov_b32 s97, 98304
    ds_read_b64_tr_b16 a[178:179], v90 offset:1024
    v_mfma_f32_16x16x32_bf16 v[116:119], a[196:199], v[44:47], v[116:119]
    s_mov_b32 exec_lo, 0xffffffff
    s_mov_b32 exec_hi, 0xff
    buffer_load_dword v1, v6, s[16:19], s97 offen
    s_mov_b64 exec, -1
    v_mfma_f32_16x16x32_bf16 v[116:119], a[192:195], v[40:43], v[116:119]
    s_and_b32 s55, s2, 1
    ds_read_b64_tr_b16 a[180:181], v90 offset:8192
    v_mfma_f32_16x16x32_bf16 v[120:123], a[192:195], v[48:51], v[120:123]
    s_lshl_b32 s55, s55, 2
    ds_read_b64_tr_b16 a[182:183], v90 offset:9216
    v_mfma_f32_16x16x32_bf16 v[120:123], a[196:199], v[52:55], v[120:123]
    s_waitcnt vmcnt(63)
    ds_read_b64_tr_b16 a[184:185], v92 offset:0
    v_mfma_f32_16x16x32_bf16 v[124:127], a[196:199], v[60:63], v[124:127]
    ds_write_b128 v105, a[32:35] offset:32768
    v_mfma_f32_16x16x32_bf16 v[124:127], a[192:195], v[56:59], v[124:127]
    s_add_u32 s34, s55, s54
    ds_read_b64_tr_b16 a[186:187], v92 offset:1024
    v_mfma_f32_16x16x32_bf16 v[240:243], a[192:195], v[64:67], v[240:243]
    s_lshl_b32 s55, s34, 8
    ds_read_b64_tr_b16 a[188:189], v92 offset:8192
    v_mfma_f32_16x16x32_bf16 v[240:243], a[196:199], v[68:71], v[240:243]
    s_and_b32 s54, s2, 2
    ds_read_b64_tr_b16 a[190:191], v92 offset:9216
    v_mfma_f32_16x16x32_bf16 v[244:247], a[204:207], v[68:71], v[244:247]
    ds_write_b128 v105, a[36:39] offset:33792
    v_mfma_f32_16x16x32_bf16 v[244:247], a[200:203], v[64:67], v[244:247]
    s_lshl_b32 s54, s54, 21
    ds_read_b64_tr_b16 a[192:193], v90 offset:256
    v_mfma_f32_16x16x32_bf16 v[140:143], a[200:203], v[56:59], v[140:143]
    s_add_u32 s54, s54, s55
    ds_read_b64_tr_b16 a[194:195], v90 offset:1280
    v_mfma_f32_16x16x32_bf16 v[140:143], a[204:207], v[60:63], v[140:143]
    s_add_u32 s12, s46, s54
    s_addc_u32 s13, s47, 0
    ds_read_b64_tr_b16 a[196:197], v90 offset:8448
    v_mfma_f32_16x16x32_bf16 v[136:139], a[204:207], v[52:55], v[136:139]
    ds_write_b128 v105, a[40:43] offset:34816
    v_mfma_f32_16x16x32_bf16 v[136:139], a[200:203], v[48:51], v[136:139]
    s_sub_u32 s14, 0x400000, s55
    ds_read_b64_tr_b16 a[198:199], v90 offset:9472
    v_mfma_f32_16x16x32_bf16 v[132:135], a[200:203], v[40:43], v[132:135]
    s_lshl_b32 s28, s34, 19
    ds_read_b128 a[128:131], v85 offset:0
    v_mfma_f32_16x16x32_bf16 v[132:135], a[204:207], v[44:47], v[132:135]
    s_mul_i32 s55, s5, 196608
    ds_read_b128 a[132:135], v85 offset:256
    v_mfma_f32_16x16x32_bf16 v[128:131], a[204:207], v[36:39], v[128:131]
    ds_write_b128 v105, a[44:47] offset:35840
    v_mfma_f32_16x16x32_bf16 v[128:131], a[200:203], v[32:35], v[128:131]
    s_add_u32 s28, s28, s55
    ds_read_b64_tr_b16 a[200:201], v92 offset:256
    v_mfma_f32_16x16x32_bf16 v[144:147], a[208:211], v[32:35], v[144:147]
    s_add_u32 s29, s28, 65536
    ds_read_b64_tr_b16 a[202:203], v92 offset:1280
    v_mfma_f32_16x16x32_bf16 v[144:147], a[212:215], v[36:39], v[144:147]
    s_add_u32 s30, s28, 131072
    ds_read_b64_tr_b16 a[204:205], v92 offset:8448
    v_mfma_f32_16x16x32_bf16 v[148:151], a[212:215], v[44:47], v[148:151]
    ds_write_b128 v105, a[48:51] offset:49152
    v_mfma_f32_16x16x32_bf16 v[148:151], a[208:211], v[40:43], v[148:151]
    s_add_u32 s31, s28, 196608
    ds_read_b64_tr_b16 a[206:207], v92 offset:9472
    v_mfma_f32_16x16x32_bf16 v[152:155], a[208:211], v[48:51], v[152:155]
    s_add_u32 s38, s6, 32768
    ds_read_b128 a[136:139], v86 offset:0
    v_mfma_f32_16x16x32_bf16 v[152:155], a[212:215], v[52:55], v[152:155]
    s_add_u32 s37, s6, 65536
    ds_read_b128 a[140:143], v86 offset:256
    v_mfma_f32_16x16x32_bf16 v[156:159], a[212:215], v[60:63], v[156:159]
    ds_write_b128 v105, a[52:55] offset:50176
    v_mfma_f32_16x16x32_bf16 v[156:159], a[208:211], v[56:59], v[156:159]
    s_mov_b32 s36, 16384
    ds_read_b128 a[144:147], v87 offset:0
    v_mfma_f32_16x16x32_bf16 v[248:251], a[208:211], v[64:67], v[248:251]
    s_mov_b32 s35, 49152
    ds_read_b128 a[148:151], v87 offset:256
    v_mfma_f32_16x16x32_bf16 v[248:251], a[212:215], v[68:71], v[248:251]
    s_mov_b32 s41, 98304
    ds_read_b64_tr_b16 a[208:209], v91 offset:0
    v_mfma_f32_16x16x32_bf16 v[252:255], a[220:223], v[68:71], v[252:255]
    ds_write_b128 v105, a[56:59] offset:51200
    v_mfma_f32_16x16x32_bf16 v[252:255], a[216:219], v[64:67], v[252:255]
    s_mov_b32 s42, 131072
    ds_read_b64_tr_b16 a[210:211], v91 offset:1024
    v_mfma_f32_16x16x32_bf16 v[172:175], a[216:219], v[56:59], v[172:175]
    s_mov_b32 s39, 4294868992
    ds_read_b64_tr_b16 a[212:213], v91 offset:8192
    v_mfma_f32_16x16x32_bf16 v[172:175], a[220:223], v[60:63], v[172:175]
    s_mov_b32 s40, 4294868992
    ds_read_b64_tr_b16 a[214:215], v91 offset:9216
    v_mfma_f32_16x16x32_bf16 v[168:171], a[220:223], v[52:55], v[168:171]
    ds_write_b128 v105, a[60:63] offset:52224
    v_mfma_f32_16x16x32_bf16 v[168:171], a[216:219], v[48:51], v[168:171]
    s_mov_b32 s43, 0
    ds_read_b128 a[152:155], v88 offset:0
    v_mfma_f32_16x16x32_bf16 v[164:167], a[216:219], v[40:43], v[164:167]
    s_lshl_b32 s55, s34, 2
    ds_read_b128 a[156:159], v88 offset:256
    v_mfma_f32_16x16x32_bf16 v[164:167], a[220:223], v[44:47], v[164:167]
    s_waitcnt vmcnt(63)
    ds_read_b128 a[160:163], v89 offset:0
    v_mfma_f32_16x16x32_bf16 v[160:163], a[220:223], v[36:39], v[160:163]
    ds_write_b128 v106, a[64:67] offset:0
    v_mfma_f32_16x16x32_bf16 v[160:163], a[216:219], v[32:35], v[160:163]
    s_and_b32 s44, s55, 12
    ds_read_b64_tr_b16 a[216:217], v93 offset:0
    v_mfma_f32_16x16x32_bf16 v[176:179], a[224:227], v[32:35], v[176:179]
    s_and_b32 s55, s55, 16
    ds_read_b64_tr_b16 a[218:219], v93 offset:1024
    v_mfma_f32_16x16x32_bf16 v[176:179], a[228:231], v[36:39], v[176:179]
    s_lshr_b32 s54, s2, 5
    ds_read_b64_tr_b16 a[220:221], v93 offset:8192
    v_mfma_f32_16x16x32_bf16 v[180:183], a[228:231], v[44:47], v[180:183]
    ds_write_b128 v106, a[68:71] offset:1024
    v_mfma_f32_16x16x32_bf16 v[180:183], a[224:227], v[40:43], v[180:183]
    s_add_u32 s54, s54, 0
    ds_read_b64_tr_b16 a[222:223], v93 offset:9216
    v_mfma_f32_16x16x32_bf16 v[184:187], a[224:227], v[48:51], v[184:187]
    s_cmp_ge_u32 s54, s44
    ds_read_b128 a[164:167], v89 offset:256
    v_mfma_f32_16x16x32_bf16 v[184:187], a[228:231], v[52:55], v[184:187]
    s_cselect_b32 s53, 4, 0
    s_add_u32 s54, s54, s53
    s_xor_b32 s54, s54, s55
    v_mfma_f32_16x16x32_bf16 v[188:191], a[228:231], v[60:63], v[188:191]
    ds_write_b128 v106, a[72:75] offset:2048
    v_mfma_f32_16x16x32_bf16 v[188:191], a[224:227], v[56:59], v[188:191]
    s_lshl_b32 s53, s54, 17
    ds_read_b64_tr_b16 a[224:225], v91 offset:256
    v_mfma_f32_16x16x32_bf16 v[204:207], a[232:235], v[56:59], v[204:207]
    s_lshr_b32 s54, s2, 5
    ds_read_b64_tr_b16 a[226:227], v91 offset:1280
    v_mfma_f32_16x16x32_bf16 v[204:207], a[236:239], v[60:63], v[204:207]
    s_add_u32 s54, s54, 8
    ds_read_b64_tr_b16 a[228:229], v91 offset:8448
    v_mfma_f32_16x16x32_bf16 v[200:203], a[236:239], v[52:55], v[200:203]
    ds_write_b128 v106, a[76:79] offset:3072
    v_mfma_f32_16x16x32_bf16 v[200:203], a[232:235], v[48:51], v[200:203]
    s_cmp_ge_u32 s54, s44
    ds_read_b64_tr_b16 a[230:231], v91 offset:9472
    v_mfma_f32_16x16x32_bf16 v[196:199], a[232:235], v[40:43], v[196:199]
    s_cselect_b32 s52, 4, 0
    s_add_u32 s54, s54, s52
    s_xor_b32 s54, s54, s55
    v_mfma_f32_16x16x32_bf16 v[196:199], a[236:239], v[44:47], v[196:199]
    s_lshl_b32 s52, s54, 17
    s_lshl_b32 s55, s3, 15
    s_add_u32 s53, s53, s55
    v_mfma_f32_16x16x32_bf16 v[192:195], a[236:239], v[36:39], v[192:195]
    ds_write_b128 v106, a[80:83] offset:16384
    v_mfma_f32_16x16x32_bf16 v[192:195], a[232:235], v[32:35], v[192:195]
    s_add_u32 s52, s52, s55
    ds_read_b64_tr_b16 a[232:233], v93 offset:256
    v_mfma_f32_16x16x32_bf16 v[208:211], a[240:243], v[32:35], v[208:211]
    ds_read_b64_tr_b16 a[234:235], v93 offset:1280
    v_mfma_f32_16x16x32_bf16 v[208:211], a[244:247], v[36:39], v[208:211]
    ds_read_b64_tr_b16 a[236:237], v93 offset:8448
    v_mfma_f32_16x16x32_bf16 v[212:215], a[244:247], v[44:47], v[212:215]
    ds_write_b128 v106, a[84:87] offset:17408
    v_mfma_f32_16x16x32_bf16 v[212:215], a[240:243], v[40:43], v[212:215]
    ds_read_b64_tr_b16 a[238:239], v93 offset:9472
    v_mfma_f32_16x16x32_bf16 v[216:219], a[240:243], v[48:51], v[216:219]
    v_mfma_f32_16x16x32_bf16 v[216:219], a[244:247], v[52:55], v[216:219]
    v_mfma_f32_16x16x32_bf16 v[220:223], a[244:247], v[60:63], v[220:223]
    ds_write_b128 v106, a[88:91] offset:18432
    v_mfma_f32_16x16x32_bf16 v[220:223], a[240:243], v[56:59], v[220:223]
    v_mfma_f32_16x16x32_bf16 v[236:239], a[248:251], v[56:59], v[236:239]
    v_mfma_f32_16x16x32_bf16 v[236:239], a[252:255], v[60:63], v[236:239]
    v_mfma_f32_16x16x32_bf16 v[232:235], a[252:255], v[52:55], v[232:235]
    ds_write_b128 v106, a[92:95] offset:19456
    v_mfma_f32_16x16x32_bf16 v[232:235], a[248:251], v[48:51], v[232:235]
    v_mfma_f32_16x16x32_bf16 v[228:231], a[248:251], v[40:43], v[228:231]
    v_mfma_f32_16x16x32_bf16 v[228:231], a[252:255], v[44:47], v[228:231]
    v_mfma_f32_16x16x32_bf16 v[224:227], a[252:255], v[36:39], v[224:227]
    v_mfma_f32_16x16x32_bf16 v[224:227], a[248:251], v[32:35], v[224:227]
    s_waitcnt lgkmcnt(0)
    s_barrier
    s_mov_b32 s90, 114688
    s_mov_b32 exec_lo, 0xffffffff
    s_mov_b32 exec_hi, 0xff
    buffer_load_dword v1, v6, s[16:19], s90 offen
    s_mov_b64 exec, -1
    v_mfma_f32_16x16x32_bf16 v[112:115], a[176:179], a[128:131], v[112:115]
    s_waitcnt vmcnt(17)
    v_add_u32 v25, 32768, v104
    v_xor_b32 v24, 4096, v25
    v_mfma_f32_16x16x32_bf16 v[112:115], a[180:183], a[132:135], v[112:115]
    v_bfe_u32 v28, v0, 1, 4
    v_and_b32 v29, 1, v0
    v_mfma_f32_16x16x32_bf16 v[116:119], a[180:183], a[140:143], v[116:119]
    v_lshlrev_b32 v26, 11, v28
    v_lshl_add_u32 v26, v29, 7, v26
    v_mfma_f32_16x16x32_bf16 v[116:119], a[176:179], a[136:139], v[116:119]
    ds_write_b128 v104, a[96:99] offset:0
    v_mfma_f32_16x16x32_bf16 v[120:123], a[176:179], a[144:147], v[120:123]
    v_mov_b32 v27, 2146435072
    v_add_u32 v26, s53, v26
    v_mfma_f32_16x16x32_bf16 v[120:123], a[180:183], a[148:151], v[120:123]
    ds_write_b128 v104, a[100:103] offset:1024
    v_mfma_f32_16x16x32_bf16 v[124:127], a[180:183], a[156:159], v[124:127]
    v_cmp_gt_u32 vcc, 32, v0
    v_mfma_f32_16x16x32_bf16 v[124:127], a[176:179], a[152:155], v[124:127]
    ds_write_b128 v104, a[104:107] offset:2048
    v_mfma_f32_16x16x32_bf16 v[240:243], a[176:179], a[160:163], v[240:243]
    v_mfma_f32_16x16x32_bf16 v[240:243], a[180:183], a[164:167], v[240:243]
    ds_write_b128 v104, a[108:111] offset:3072
    v_mfma_f32_16x16x32_bf16 v[244:247], a[188:191], a[164:167], v[244:247]
    v_cndmask_b32 v8, v27, v26, vcc
    v_mfma_f32_16x16x32_bf16 v[244:247], a[184:187], a[160:163], v[244:247]
    ds_write_b128 v104, a[112:115] offset:16384
    v_mfma_f32_16x16x32_bf16 v[140:143], a[184:187], a[152:155], v[140:143]
    v_mfma_f32_16x16x32_bf16 v[140:143], a[188:191], a[156:159], v[140:143]
    ds_write_b128 v104, a[116:119] offset:17408
    v_mfma_f32_16x16x32_bf16 v[136:139], a[188:191], a[148:151], v[136:139]
    v_mfma_f32_16x16x32_bf16 v[136:139], a[184:187], a[144:147], v[136:139]
    ds_write_b128 v104, a[120:123] offset:18432
    v_mfma_f32_16x16x32_bf16 v[132:135], a[184:187], a[136:139], v[132:135]
    v_mfma_f32_16x16x32_bf16 v[132:135], a[188:191], a[140:143], v[132:135]
    ds_write_b128 v104, a[124:127] offset:19456
    v_mfma_f32_16x16x32_bf16 v[128:131], a[188:191], a[132:135], v[128:131]
    v_mfma_f32_16x16x32_bf16 v[128:131], a[184:187], a[128:131], v[128:131]
    v_mfma_f32_16x16x32_bf16 v[144:147], a[192:195], a[128:131], v[144:147]
    v_mfma_f32_16x16x32_bf16 v[144:147], a[196:199], a[132:135], v[144:147]
    v_mfma_f32_16x16x32_bf16 v[148:151], a[196:199], a[140:143], v[148:151]
    v_mfma_f32_16x16x32_bf16 v[148:151], a[192:195], a[136:139], v[148:151]
    v_mfma_f32_16x16x32_bf16 v[152:155], a[192:195], a[144:147], v[152:155]
    v_mul_f32 v240, s62, v240
    v_mul_f32 v241, s62, v241
    v_mfma_f32_16x16x32_bf16 v[152:155], a[196:199], a[148:151], v[152:155]
    v_mul_f32 v242, s62, v242
    v_mul_f32 v243, s62, v243
    v_mfma_f32_16x16x32_bf16 v[156:159], a[196:199], a[156:159], v[156:159]
    v_mul_f32 v244, s62, v244
    v_mul_f32 v245, s62, v245
    v_mfma_f32_16x16x32_bf16 v[156:159], a[192:195], a[152:155], v[156:159]
    v_mul_f32 v246, s62, v246
    v_mul_f32 v247, s62, v247
    v_mfma_f32_16x16x32_bf16 v[248:251], a[192:195], a[160:163], v[248:251]
    v_cvt_pk_bf16_f32 v96, v240, v241
    v_cvt_pk_bf16_f32 v98, v244, v245
    v_mfma_f32_16x16x32_bf16 v[248:251], a[196:199], a[164:167], v[248:251]
    v_cvt_pk_bf16_f32 v97, v242, v243
    v_cvt_pk_bf16_f32 v99, v246, v247
    v_mfma_f32_16x16x32_bf16 v[252:255], a[204:207], a[164:167], v[252:255]
    v_permlane16_swap_b32 v96, v98
    v_mfma_f32_16x16x32_bf16 v[252:255], a[200:203], a[160:163], v[252:255]
    v_permlane16_swap_b32 v97, v99
    v_mul_f32 v124, s62, v124
    v_mfma_f32_16x16x32_bf16 v[172:175], a[200:203], a[152:155], v[172:175]
    v_mul_f32 v125, s62, v125
    v_mul_f32 v126, s62, v126
    v_mfma_f32_16x16x32_bf16 v[172:175], a[204:207], a[156:159], v[172:175]
    v_mul_f32 v127, s62, v127
    v_mul_f32 v140, s62, v140
    v_mfma_f32_16x16x32_bf16 v[168:171], a[204:207], a[148:151], v[168:171]
    v_mul_f32 v141, s62, v141
    v_mul_f32 v142, s62, v142
    v_mfma_f32_16x16x32_bf16 v[168:171], a[200:203], a[144:147], v[168:171]
    v_mul_f32 v143, s62, v143
    v_cvt_pk_bf16_f32 v80, v124, v125
    v_mfma_f32_16x16x32_bf16 v[164:167], a[200:203], a[136:139], v[164:167]
    v_cvt_pk_bf16_f32 v82, v140, v141
    v_cvt_pk_bf16_f32 v81, v126, v127
    v_mfma_f32_16x16x32_bf16 v[164:167], a[204:207], a[140:143], v[164:167]
    v_cvt_pk_bf16_f32 v83, v142, v143
    v_permlane16_swap_b32 v80, v82
    v_mfma_f32_16x16x32_bf16 v[160:163], a[204:207], a[132:135], v[160:163]
    v_mfma_f32_16x16x32_bf16 v[160:163], a[200:203], a[128:131], v[160:163]
    v_permlane16_swap_b32 v81, v83
    v_mul_f32 v120, s62, v120
    v_mfma_f32_16x16x32_bf16 v[176:179], a[208:211], a[128:131], v[176:179]
    v_mul_f32 v121, s62, v121
    v_mul_f32 v122, s62, v122
    v_mfma_f32_16x16x32_bf16 v[176:179], a[212:215], a[132:135], v[176:179]
    v_mul_f32 v123, s62, v123
    v_mul_f32 v136, s62, v136
    v_mfma_f32_16x16x32_bf16 v[180:183], a[212:215], a[140:143], v[180:183]
    v_mul_f32 v137, s62, v137
    v_mul_f32 v138, s62, v138
    v_mfma_f32_16x16x32_bf16 v[180:183], a[208:211], a[136:139], v[180:183]
    v_mul_f32 v139, s62, v139
    v_cvt_pk_bf16_f32 v64, v120, v121
    v_mfma_f32_16x16x32_bf16 v[184:187], a[208:211], a[144:147], v[184:187]
    v_cvt_pk_bf16_f32 v66, v136, v137
    v_cvt_pk_bf16_f32 v65, v122, v123
    v_mfma_f32_16x16x32_bf16 v[184:187], a[212:215], a[148:151], v[184:187]
    v_cvt_pk_bf16_f32 v67, v138, v139
    v_permlane16_swap_b32 v64, v66
    v_mfma_f32_16x16x32_bf16 v[188:191], a[212:215], a[156:159], v[188:191]
    v_mfma_f32_16x16x32_bf16 v[188:191], a[208:211], a[152:155], v[188:191]
    v_permlane16_swap_b32 v65, v67
    v_mul_f32 v248, s62, v248
    v_mfma_f32_16x16x32_bf16 v[204:207], a[216:219], a[152:155], v[204:207]
    v_mul_f32 v249, s62, v249
    v_mul_f32 v250, s62, v250
    v_mfma_f32_16x16x32_bf16 v[204:207], a[220:223], a[156:159], v[204:207]
    v_mul_f32 v251, s62, v251
    v_mul_f32 v252, s62, v252
    v_mfma_f32_16x16x32_bf16 v[200:203], a[220:223], a[148:151], v[200:203]
    v_mul_f32 v253, s62, v253
    v_mul_f32 v254, s62, v254
    v_mfma_f32_16x16x32_bf16 v[200:203], a[216:219], a[144:147], v[200:203]
    v_mul_f32 v255, s62, v255
    v_cvt_pk_bf16_f32 v100, v248, v249
    v_mfma_f32_16x16x32_bf16 v[196:199], a[216:219], a[136:139], v[196:199]
    v_cvt_pk_bf16_f32 v102, v252, v253
    v_cvt_pk_bf16_f32 v101, v250, v251
    v_mfma_f32_16x16x32_bf16 v[196:199], a[220:223], a[140:143], v[196:199]
    v_cvt_pk_bf16_f32 v103, v254, v255
    v_permlane16_swap_b32 v100, v102
    v_mfma_f32_16x16x32_bf16 v[192:195], a[220:223], a[132:135], v[192:195]
    v_mfma_f32_16x16x32_bf16 v[192:195], a[216:219], a[128:131], v[192:195]
    v_permlane16_swap_b32 v101, v103
    v_mfma_f32_16x16x32_bf16 v[208:211], a[224:227], a[128:131], v[208:211]
    ds_write_b128 v24, v[96:99]
    v_mfma_f32_16x16x32_bf16 v[208:211], a[228:231], a[132:135], v[208:211]
    ds_write_b128 v24, v[100:103] offset:1024
    v_mfma_f32_16x16x32_bf16 v[212:215], a[228:231], a[140:143], v[212:215]
    v_mul_f32 v116, s62, v116
    v_mul_f32 v117, s62, v117
    v_mfma_f32_16x16x32_bf16 v[212:215], a[224:227], a[136:139], v[212:215]
    v_mul_f32 v118, s62, v118
    v_mul_f32 v119, s62, v119
    v_mfma_f32_16x16x32_bf16 v[216:219], a[224:227], a[144:147], v[216:219]
    v_mul_f32 v132, s62, v132
    v_mul_f32 v133, s62, v133
    v_mfma_f32_16x16x32_bf16 v[216:219], a[228:231], a[148:151], v[216:219]
    v_mul_f32 v134, s62, v134
    v_mul_f32 v135, s62, v135
    v_mfma_f32_16x16x32_bf16 v[220:223], a[228:231], a[156:159], v[220:223]
    v_cvt_pk_bf16_f32 v48, v116, v117
    v_cvt_pk_bf16_f32 v50, v132, v133
    v_mfma_f32_16x16x32_bf16 v[220:223], a[224:227], a[152:155], v[220:223]
    v_cvt_pk_bf16_f32 v49, v118, v119
    v_cvt_pk_bf16_f32 v51, v134, v135
    v_mfma_f32_16x16x32_bf16 v[236:239], a[232:235], a[152:155], v[236:239]
    v_permlane16_swap_b32 v48, v50
    v_mfma_f32_16x16x32_bf16 v[236:239], a[236:239], a[156:159], v[236:239]
    v_permlane16_swap_b32 v49, v51
    v_mul_f32 v112, s62, v112
    v_mfma_f32_16x16x32_bf16 v[232:235], a[236:239], a[148:151], v[232:235]
    v_mul_f32 v113, s62, v113
    v_mul_f32 v114, s62, v114
    v_mfma_f32_16x16x32_bf16 v[232:235], a[232:235], a[144:147], v[232:235]
    v_mul_f32 v115, s62, v115
    v_mul_f32 v128, s62, v128
    v_mfma_f32_16x16x32_bf16 v[228:231], a[232:235], a[136:139], v[228:231]
    v_mul_f32 v129, s62, v129
    v_mul_f32 v130, s62, v130
    v_mfma_f32_16x16x32_bf16 v[228:231], a[236:239], a[140:143], v[228:231]
    v_mul_f32 v131, s62, v131
    v_cvt_pk_bf16_f32 v32, v112, v113
    v_mfma_f32_16x16x32_bf16 v[224:227], a[236:239], a[132:135], v[224:227]
    v_cvt_pk_bf16_f32 v34, v128, v129
    v_cvt_pk_bf16_f32 v33, v114, v115
    v_mfma_f32_16x16x32_bf16 v[224:227], a[232:235], a[128:131], v[224:227]
    v_cvt_pk_bf16_f32 v35, v130, v131
    v_permlane16_swap_b32 v32, v34
    s_nop 1
    v_permlane16_swap_b32 v33, v35
L_trans:
    ds_read_b128 a[160:163], v14 offset:0
    ds_read_b128 a[164:167], v14 offset:256
    ds_read_b128 a[168:171], v15 offset:0
    ds_read_b128 a[172:175], v15 offset:256
    ds_read_b128 a[176:179], v14 offset:4096
    ds_read_b128 a[180:183], v14 offset:4352
    ds_read_b128 a[184:187], v15 offset:4096
    ds_read_b128 a[188:191], v15 offset:4352
    v_pk_mul_f32 v[148:149], v[148:149], s[62:63]
    v_pk_mul_f32 v[150:151], v[150:151], s[62:63]
    v_pk_mul_f32 v[164:165], v[164:165], s[62:63]
    v_pk_mul_f32 v[166:167], v[166:167], s[62:63]
    v_cvt_pk_bf16_f32 v52, v148, v149
    v_cvt_pk_bf16_f32 v54, v164, v165
    v_cvt_pk_bf16_f32 v53, v150, v151
    v_cvt_pk_bf16_f32 v55, v166, v167
    v_pk_mul_f32 v[180:181], v[180:181], s[62:63]
    v_pk_mul_f32 v[182:183], v[182:183], s[62:63]
    v_pk_mul_f32 v[196:197], v[196:197], s[62:63]
    v_pk_mul_f32 v[198:199], v[198:199], s[62:63]
    v_cvt_pk_bf16_f32 v56, v180, v181
    v_cvt_pk_bf16_f32 v58, v196, v197
    v_cvt_pk_bf16_f32 v57, v182, v183
    v_cvt_pk_bf16_f32 v59, v198, v199
    v_pk_mul_f32 v[212:213], v[212:213], s[62:63]
    v_pk_mul_f32 v[214:215], v[214:215], s[62:63]
    v_pk_mul_f32 v[228:229], v[228:229], s[62:63]
    v_pk_mul_f32 v[230:231], v[230:231], s[62:63]
    v_cvt_pk_bf16_f32 v60, v212, v213
    v_cvt_pk_bf16_f32 v62, v228, v229
    v_cvt_pk_bf16_f32 v61, v214, v215
    v_cvt_pk_bf16_f32 v63, v230, v231
    s_nop 1
    v_permlane16_swap_b32 v52, v54
    v_permlane16_swap_b32 v53, v55
    v_permlane16_swap_b32 v56, v58
    v_permlane16_swap_b32 v57, v59
    v_permlane16_swap_b32 v60, v62
    v_permlane16_swap_b32 v61, v63
    s_waitcnt lgkmcnt(0)
    s_barrier
    ds_read_b128 v[104:107], v25
    ds_read_b128 v[108:111], v25 offset:1024
    s_mov_b32 s91, 114688
    s_mov_b32 exec_lo, 0xffffffff
    s_mov_b32 exec_hi, 0xff
    buffer_load_dword v1, v6, s[20:23], s91 offen
    s_mov_b64 exec, -1
    v_pk_mul_f32 v[152:153], v[152:153], s[62:63]
    v_pk_mul_f32 v[154:155], v[154:155], s[62:63]
    v_pk_mul_f32 v[168:169], v[168:169], s[62:63]
    v_pk_mul_f32 v[170:171], v[170:171], s[62:63]
    v_cvt_pk_bf16_f32 v68, v152, v153
    v_cvt_pk_bf16_f32 v70, v168, v169
    v_cvt_pk_bf16_f32 v69, v154, v155
    v_cvt_pk_bf16_f32 v71, v170, v171
    v_pk_mul_f32 v[184:185], v[184:185], s[62:63]
    v_pk_mul_f32 v[186:187], v[186:187], s[62:63]
    v_pk_mul_f32 v[200:201], v[200:201], s[62:63]
    v_pk_mul_f32 v[202:203], v[202:203], s[62:63]
    v_cvt_pk_bf16_f32 v72, v184, v185
    v_cvt_pk_bf16_f32 v74, v200, v201
    v_cvt_pk_bf16_f32 v73, v186, v187
    v_cvt_pk_bf16_f32 v75, v202, v203
    v_pk_mul_f32 v[216:217], v[216:217], s[62:63]
    v_pk_mul_f32 v[218:219], v[218:219], s[62:63]
    v_pk_mul_f32 v[232:233], v[232:233], s[62:63]
    v_pk_mul_f32 v[234:235], v[234:235], s[62:63]
    v_cvt_pk_bf16_f32 v76, v216, v217
    v_cvt_pk_bf16_f32 v78, v232, v233
    v_cvt_pk_bf16_f32 v77, v218, v219
    v_cvt_pk_bf16_f32 v79, v234, v235
    s_nop 1
    v_permlane16_swap_b32 v68, v70
    v_permlane16_swap_b32 v69, v71
    v_permlane16_swap_b32 v72, v74
    v_permlane16_swap_b32 v73, v75
    v_permlane16_swap_b32 v76, v78
    v_permlane16_swap_b32 v77, v79
    v_pk_mul_f32 v[144:145], v[144:145], s[62:63]
    v_pk_mul_f32 v[146:147], v[146:147], s[62:63]
    v_pk_mul_f32 v[160:161], v[160:161], s[62:63]
    v_pk_mul_f32 v[162:163], v[162:163], s[62:63]
    v_cvt_pk_bf16_f32 v36, v144, v145
    v_cvt_pk_bf16_f32 v38, v160, v161
    v_cvt_pk_bf16_f32 v37, v146, v147
    v_cvt_pk_bf16_f32 v39, v162, v163
    v_pk_mul_f32 v[176:177], v[176:177], s[62:63]
    v_pk_mul_f32 v[178:179], v[178:179], s[62:63]
    v_pk_mul_f32 v[192:193], v[192:193], s[62:63]
    v_pk_mul_f32 v[194:195], v[194:195], s[62:63]
    v_cvt_pk_bf16_f32 v40, v176, v177
    v_cvt_pk_bf16_f32 v42, v192, v193
    v_cvt_pk_bf16_f32 v41, v178, v179
    v_cvt_pk_bf16_f32 v43, v194, v195
    v_pk_mul_f32 v[208:209], v[208:209], s[62:63]
    v_pk_mul_f32 v[210:211], v[210:211], s[62:63]
    v_pk_mul_f32 v[224:225], v[224:225], s[62:63]
    v_pk_mul_f32 v[226:227], v[226:227], s[62:63]
    v_cvt_pk_bf16_f32 v44, v208, v209
    v_cvt_pk_bf16_f32 v46, v224, v225
    v_cvt_pk_bf16_f32 v45, v210, v211
    v_cvt_pk_bf16_f32 v47, v226, v227
    s_nop 1
    v_permlane16_swap_b32 v36, v38
    v_permlane16_swap_b32 v37, v39
    v_permlane16_swap_b32 v40, v42
    v_permlane16_swap_b32 v41, v43
    v_permlane16_swap_b32 v44, v46
    v_permlane16_swap_b32 v45, v47
    s_waitcnt vmcnt(4) lgkmcnt(0)
    v_readfirstlane_b32 s100, v12
    v_mov_b32 v24, 0
    s_mov_b32 exec_lo, 0x11111111
    s_mov_b32 exec_hi, 0x11111111
    v_mov_b32 v24, 0x3f803f80
    s_mov_b64 exec, -1
    v_mfma_f32_16x16x32_bf16 v[112:115], a[160:163], v[32:35], 0
    v_mul_f32 v156, s62, v156
    v_mul_f32 v157, s62, v157
    v_mfma_f32_16x16x32_bf16 v[112:115], a[164:167], v[36:39], v[112:115]
    v_mul_f32 v158, s62, v158
    v_mul_f32 v159, s62, v159
    v_mfma_f32_16x16x32_bf16 v[112:115], a[168:171], v[40:43], v[112:115]
    v_mul_f32 v172, s62, v172
    v_mul_f32 v173, s62, v173
    v_mfma_f32_16x16x32_bf16 v[112:115], a[172:175], v[44:47], v[112:115]
    v_mul_f32 v174, s62, v174
    v_mul_f32 v175, s62, v175
    v_mfma_f32_16x16x32_bf16 v[132:135], a[176:179], v[32:35], 0
    v_cvt_pk_bf16_f32 v84, v156, v157
    v_cvt_pk_bf16_f32 v86, v172, v173
    v_mfma_f32_16x16x32_bf16 v[132:135], a[180:183], v[36:39], v[132:135]
    v_cvt_pk_bf16_f32 v85, v158, v159
    v_cvt_pk_bf16_f32 v87, v174, v175
    v_mfma_f32_16x16x32_bf16 v[132:135], a[184:187], v[40:43], v[132:135]
    v_permlane16_swap_b32 v84, v86
    v_accvgpr_write_b32 a244, v24
    v_mfma_f32_16x16x32_bf16 v[132:135], a[188:191], v[44:47], v[132:135]
    v_accvgpr_write_b32 a245, v24
    v_permlane16_swap_b32 v85, v87
    v_mfma_f32_16x16x32_bf16 v[116:119], a[160:163], v[48:51], 0
    v_mul_f32 v188, s62, v188
    v_mul_f32 v189, s62, v189
    v_mfma_f32_16x16x32_bf16 v[116:119], a[164:167], v[52:55], v[116:119]
    v_mul_f32 v190, s62, v190
    v_mul_f32 v191, s62, v191
    v_mfma_f32_16x16x32_bf16 v[116:119], a[168:171], v[56:59], v[116:119]
    v_mul_f32 v204, s62, v204
    v_mul_f32 v205, s62, v205
    v_mfma_f32_16x16x32_bf16 v[116:119], a[172:175], v[60:63], v[116:119]
    v_mul_f32 v206, s62, v206
    v_mul_f32 v207, s62, v207
    v_mfma_f32_16x16x32_bf16 v[136:139], a[176:179], v[48:51], 0
    v_cvt_pk_bf16_f32 v88, v188, v189
    v_cvt_pk_bf16_f32 v90, v204, v205
    v_mfma_f32_16x16x32_bf16 v[136:139], a[180:183], v[52:55], v[136:139]
    v_cvt_pk_bf16_f32 v89, v190, v191
    v_cvt_pk_bf16_f32 v91, v206, v207
    v_mfma_f32_16x16x32_bf16 v[136:139], a[184:187], v[56:59], v[136:139]
    v_permlane16_swap_b32 v88, v90
    v_accvgpr_write_b32 a246, v24
    v_mfma_f32_16x16x32_bf16 v[136:139], a[188:191], v[60:63], v[136:139]
    v_accvgpr_write_b32 a247, v24
    v_permlane16_swap_b32 v89, v91
    v_mfma_f32_16x16x32_bf16 v[120:123], a[160:163], v[64:67], 0
    v_mul_f32 v220, s62, v220
    v_mul_f32 v221, s62, v221
    v_mfma_f32_16x16x32_bf16 v[120:123], a[164:167], v[68:71], v[120:123]
    v_mul_f32 v222, s62, v222
    v_mul_f32 v223, s62, v223
    v_mfma_f32_16x16x32_bf16 v[120:123], a[168:171], v[72:75], v[120:123]
    v_mul_f32 v236, s62, v236
    v_mul_f32 v237, s62, v237
    v_mfma_f32_16x16x32_bf16 v[120:123], a[172:175], v[76:79], v[120:123]
    v_mul_f32 v238, s62, v238
    v_mul_f32 v239, s62, v239
    v_mfma_f32_16x16x32_bf16 v[140:143], a[176:179], v[64:67], 0
    v_cvt_pk_bf16_f32 v92, v220, v221
    v_cvt_pk_bf16_f32 v94, v236, v237
    v_mfma_f32_16x16x32_bf16 v[140:143], a[180:183], v[68:71], v[140:143]
    v_cvt_pk_bf16_f32 v93, v222, v223
    v_cvt_pk_bf16_f32 v95, v238, v239
    v_mfma_f32_16x16x32_bf16 v[140:143], a[184:187], v[72:75], v[140:143]
    v_permlane16_swap_b32 v92, v94
    v_add_u32 v14, 32768, v14
    v_mfma_f32_16x16x32_bf16 v[140:143], a[188:191], v[76:79], v[140:143]
    v_add_u32 v15, 32768, v15
    v_permlane16_swap_b32 v93, v95
    v_mfma_f32_16x16x32_bf16 v[124:127], a[160:163], v[80:83], 0
    v_max3_f32 v220, v112, v113, v114
    v_max3_f32 v221, v115, v132, v133
    v_mfma_f32_16x16x32_bf16 v[124:127], a[164:167], v[84:87], v[124:127]
    v_max3_f32 v220, v134, v135, v220
    v_max_f32 v222, v220, v221
    v_mfma_f32_16x16x32_bf16 v[124:127], a[168:171], v[88:91], v[124:127]
    v_max_f32 v223, v220, v221
    s_nop 1
    v_permlane32_swap_b32 v222, v223
    v_mfma_f32_16x16x32_bf16 v[124:127], a[172:175], v[92:95], v[124:127]
    v_max_f32 v220, v222, v223
    v_max_f32 v221, v222, v223
    v_mfma_f32_16x16x32_bf16 v[144:147], a[176:179], v[80:83], 0
    s_nop 1
    v_permlane16_swap_b32 v220, v221
    v_max_f32 v220, v220, v221
    v_mfma_f32_16x16x32_bf16 v[144:147], a[180:183], v[84:87], v[144:147]
    v_sub_f32 v221, 0xc0e00000, v220
    v_sub_f32 v222, 0xc0e00000, v220
    v_mfma_f32_16x16x32_bf16 v[144:147], a[184:187], v[88:91], v[144:147]
    v_sub_f32 v223, 0xc0e00000, v220
    v_sub_f32 v220, 0xc0e00000, v220
    v_mfma_f32_16x16x32_bf16 v[144:147], a[188:191], v[92:95], v[144:147]
    v_max3_f32 v224, v116, v117, v118
    v_max3_f32 v225, v119, v136, v137
    v_mfma_f32_16x16x32_bf16 v[128:131], a[160:163], v[96:99], 0
    ds_read_b128 a[160:163], v16 offset:0
    v_max3_f32 v224, v138, v139, v224
    v_mfma_f32_16x16x32_bf16 v[128:131], a[164:167], v[100:103], v[128:131]
    ds_read_b128 a[164:167], v16 offset:256
    v_max_f32 v226, v224, v225
    v_mfma_f32_16x16x32_bf16 v[128:131], a[168:171], v[104:107], v[128:131]
    ds_read_b128 a[168:171], v17 offset:0
    v_max_f32 v227, v224, v225
    v_mfma_f32_16x16x32_bf16 v[128:131], a[172:175], v[108:111], v[128:131]
    ds_read_b128 a[172:175], v17 offset:256
    v_add_f32 v112, v112, v220
    v_mfma_f32_16x16x32_bf16 v[148:151], a[176:179], v[96:99], 0
    ds_read_b128 a[176:179], v16 offset:4096
    v_add_f32 v113, v113, v220
    v_mfma_f32_16x16x32_bf16 v[148:151], a[180:183], v[100:103], v[148:151]
    ds_read_b128 a[180:183], v16 offset:4352
    v_permlane32_swap_b32 v226, v227
    v_mfma_f32_16x16x32_bf16 v[148:151], a[184:187], v[104:107], v[148:151]
    ds_read_b128 a[184:187], v17 offset:4096
    v_max_f32 v224, v226, v227
    v_mfma_f32_16x16x32_bf16 v[148:151], a[188:191], v[108:111], v[148:151]
    ds_read_b128 a[188:191], v17 offset:4352
    v_max_f32 v225, v226, v227
    v_add_f32 v114, v114, v220
    v_add_f32 v115, v115, v220
    v_permlane16_swap_b32 v224, v225
    v_max_f32 v224, v224, v225
    v_sub_f32 v225, 0xc0e00000, v224
    v_sub_f32 v226, 0xc0e00000, v224
    v_sub_f32 v227, 0xc0e00000, v224
    v_sub_f32 v224, 0xc0e00000, v224
    v_max3_f32 v228, v120, v121, v122
    v_max3_f32 v229, v123, v140, v141
    v_max3_f32 v228, v142, v143, v228
    v_max_f32 v230, v228, v229
    v_max_f32 v231, v228, v229
    v_add_f32 v132, v132, v220
    v_add_f32 v133, v133, v220
    v_permlane32_swap_b32 v230, v231
    v_max_f32 v228, v230, v231
    v_max_f32 v229, v230, v231
    v_add_f32 v134, v134, v220
    v_add_f32 v135, v135, v220
    s_waitcnt lgkmcnt(0)
    v_mfma_f32_16x16x32_bf16 v[152:155], a[160:163], v[32:35], v[220:223]
    v_permlane16_swap_b32 v228, v229
    v_max_f32 v228, v228, v229
    v_mfma_f32_16x16x32_bf16 v[152:155], a[164:167], v[36:39], v[152:155]
    v_sub_f32 v229, 0xc0e00000, v228
    v_sub_f32 v230, 0xc0e00000, v228
    v_mfma_f32_16x16x32_bf16 v[152:155], a[168:171], v[40:43], v[152:155]
    v_sub_f32 v231, 0xc0e00000, v228
    v_sub_f32 v228, 0xc0e00000, v228
    v_mfma_f32_16x16x32_bf16 v[152:155], a[172:175], v[44:47], v[152:155]
    v_max3_f32 v232, v124, v125, v126
    v_max3_f32 v233, v127, v144, v145
    v_mfma_f32_16x16x32_bf16 v[168:171], a[176:179], v[32:35], v[220:223]
    v_max3_f32 v232, v146, v147, v232
    v_max_f32 v234, v232, v233
    v_mfma_f32_16x16x32_bf16 v[168:171], a[180:183], v[36:39], v[168:171]
    v_max_f32 v235, v232, v233
    v_add_f32 v116, v116, v224
    v_mfma_f32_16x16x32_bf16 v[168:171], a[184:187], v[40:43], v[168:171]
    v_add_f32 v117, v117, v224
    v_permlane32_swap_b32 v234, v235
    v_mfma_f32_16x16x32_bf16 v[168:171], a[188:191], v[44:47], v[168:171]
    v_max_f32 v232, v234, v235
    v_max_f32 v233, v234, v235
    v_mfma_f32_16x16x32_bf16 v[156:159], a[160:163], v[48:51], v[224:227]
    v_add_f32 v118, v118, v224
    v_add_f32 v119, v119, v224
    v_mfma_f32_16x16x32_bf16 v[156:159], a[164:167], v[52:55], v[156:159]
    v_permlane16_swap_b32 v232, v233
    v_max_f32 v232, v232, v233
    v_mfma_f32_16x16x32_bf16 v[156:159], a[168:171], v[56:59], v[156:159]
    v_sub_f32 v233, 0xc0e00000, v232
    v_sub_f32 v234, 0xc0e00000, v232
    v_mfma_f32_16x16x32_bf16 v[156:159], a[172:175], v[60:63], v[156:159]
    v_sub_f32 v235, 0xc0e00000, v232
    v_sub_f32 v232, 0xc0e00000, v232
    v_mfma_f32_16x16x32_bf16 v[172:175], a[176:179], v[48:51], v[224:227]
    v_add_u32 v16, 32768, v16
    v_add_u32 v17, 32768, v17
    v_mfma_f32_16x16x32_bf16 v[172:175], a[180:183], v[52:55], v[172:175]
    v_max3_f32 v236, v128, v129, v130
    v_max3_f32 v237, v131, v148, v149
    v_mfma_f32_16x16x32_bf16 v[172:175], a[184:187], v[56:59], v[172:175]
    v_max3_f32 v236, v150, v151, v236
    v_max_f32 v238, v236, v237
    v_mfma_f32_16x16x32_bf16 v[172:175], a[188:191], v[60:63], v[172:175]
    v_max_f32 v239, v236, v237
    v_add_f32 v136, v136, v224
    v_mfma_f32_16x16x32_bf16 v[160:163], a[160:163], v[64:67], v[228:231]
    v_add_f32 v137, v137, v224
    v_permlane32_swap_b32 v238, v239
    v_mfma_f32_16x16x32_bf16 v[160:163], a[164:167], v[68:71], v[160:163]
    v_max_f32 v236, v238, v239
    v_max_f32 v237, v238, v239
    v_mfma_f32_16x16x32_bf16 v[160:163], a[168:171], v[72:75], v[160:163]
    v_add_f32 v138, v138, v224
    v_add_f32 v139, v139, v224
    v_mfma_f32_16x16x32_bf16 v[160:163], a[172:175], v[76:79], v[160:163]
    v_permlane16_swap_b32 v236, v237
    v_max_f32 v236, v236, v237
    v_mfma_f32_16x16x32_bf16 v[176:179], a[176:179], v[64:67], v[228:231]
    v_sub_f32 v237, 0xc0e00000, v236
    v_sub_f32 v238, 0xc0e00000, v236
    v_mfma_f32_16x16x32_bf16 v[176:179], a[180:183], v[68:71], v[176:179]
    v_sub_f32 v239, 0xc0e00000, v236
    v_sub_f32 v236, 0xc0e00000, v236
    v_mfma_f32_16x16x32_bf16 v[176:179], a[184:187], v[72:75], v[176:179]
    v_add_f32 v120, v120, v228
    v_add_f32 v121, v121, v228
    v_mfma_f32_16x16x32_bf16 v[176:179], a[188:191], v[76:79], v[176:179]
    v_add_f32 v122, v122, v228
    v_add_f32 v123, v123, v228
    v_mfma_f32_16x16x32_bf16 v[164:167], a[160:163], v[80:83], v[232:235]
    ds_read_b128 a[160:163], v14 offset:0
    v_add_f32 v140, v140, v228
    v_mfma_f32_16x16x32_bf16 v[164:167], a[164:167], v[84:87], v[164:167]
    ds_read_b128 a[164:167], v14 offset:256
    v_add_f32 v141, v141, v228
    v_mfma_f32_16x16x32_bf16 v[164:167], a[168:171], v[88:91], v[164:167]
    ds_read_b128 a[168:171], v15 offset:0
    v_add_f32 v142, v142, v228
    v_mfma_f32_16x16x32_bf16 v[164:167], a[172:175], v[92:95], v[164:167]
    ds_read_b128 a[172:175], v15 offset:256
    v_add_f32 v143, v143, v228
    v_mfma_f32_16x16x32_bf16 v[180:183], a[176:179], v[80:83], v[232:235]
    ds_read_b128 a[176:179], v14 offset:4096
    v_add_f32 v124, v124, v232
    v_mfma_f32_16x16x32_bf16 v[180:183], a[180:183], v[84:87], v[180:183]
    ds_read_b128 a[180:183], v14 offset:4352
    v_add_f32 v125, v125, v232
    v_mfma_f32_16x16x32_bf16 v[180:183], a[184:187], v[88:91], v[180:183]
    ds_read_b128 a[184:187], v15 offset:4096
    v_add_f32 v126, v126, v232
    v_mfma_f32_16x16x32_bf16 v[180:183], a[188:191], v[92:95], v[180:183]
    ds_read_b128 a[188:191], v15 offset:4352
    v_add_f32 v127, v127, v232
    v_add_f32 v144, v144, v232
    v_add_f32 v145, v145, v232
    v_add_f32 v146, v146, v232
    v_add_f32 v147, v147, v232
    v_add_f32 v128, v128, v236
    v_add_f32 v129, v129, v236
    v_add_f32 v130, v130, v236
    v_add_f32 v131, v131, v236
    v_add_f32 v148, v148, v236
    v_add_f32 v149, v149, v236
    v_add_f32 v150, v150, v236
    v_add_f32 v151, v151, v236
    v_exp_f32 v240, v112
    v_exp_f32 v241, v113
    v_exp_f32 v242, v114
    v_cvt_pk_bf16_f32 v184, v240, v241
    v_exp_f32 v243, v115
    v_exp_f32 v244, v132
    v_cvt_pk_bf16_f32 v185, v242, v243
    v_exp_f32 v245, v133
    v_exp_f32 v246, v134
    v_cvt_pk_bf16_f32 v186, v244, v245
    v_exp_f32 v247, v135
    v_exp_f32 v248, v116
    v_cvt_pk_bf16_f32 v187, v246, v247
    v_exp_f32 v249, v117
    v_exp_f32 v250, v118
    v_cvt_pk_bf16_f32 v188, v248, v249
    v_exp_f32 v251, v119
    v_exp_f32 v252, v136
    v_cvt_pk_bf16_f32 v189, v250, v251
    v_exp_f32 v253, v137
    v_exp_f32 v254, v138
    v_cvt_pk_bf16_f32 v190, v252, v253
    v_exp_f32 v255, v139
    v_exp_f32 v240, v120
    v_cvt_pk_bf16_f32 v191, v254, v255
    v_exp_f32 v241, v121
    v_exp_f32 v242, v122
    v_cvt_pk_bf16_f32 v192, v240, v241
    v_exp_f32 v243, v123
    v_exp_f32 v244, v140
    v_cvt_pk_bf16_f32 v193, v242, v243
    v_exp_f32 v245, v141
    v_exp_f32 v246, v142
    v_cvt_pk_bf16_f32 v194, v244, v245
    v_exp_f32 v247, v143
    v_exp_f32 v248, v124
    v_cvt_pk_bf16_f32 v195, v246, v247
    v_exp_f32 v249, v125
    v_exp_f32 v250, v126
    v_cvt_pk_bf16_f32 v196, v248, v249
    v_exp_f32 v251, v127
    v_exp_f32 v252, v144
    v_cvt_pk_bf16_f32 v197, v250, v251
    v_exp_f32 v253, v145
    v_exp_f32 v254, v146
    v_cvt_pk_bf16_f32 v198, v252, v253
    v_exp_f32 v255, v147
    v_exp_f32 v240, v128
    v_cvt_pk_bf16_f32 v199, v254, v255
    v_exp_f32 v241, v129
    v_exp_f32 v242, v130
    v_cvt_pk_bf16_f32 v200, v240, v241
    v_exp_f32 v243, v131
    v_exp_f32 v244, v148
    v_cvt_pk_bf16_f32 v201, v242, v243
    v_exp_f32 v245, v149
    v_exp_f32 v246, v150
    v_cvt_pk_bf16_f32 v202, v244, v245
    v_exp_f32 v247, v151
    s_nop 0
    v_cvt_pk_bf16_f32 v203, v246, v247
    s_waitcnt lgkmcnt(0)
    s_barrier
    v_mfma_f32_16x16x32_bf16 v[112:115], a[160:163], v[32:35], v[220:223]
    ds_read_b64_tr_b16 a[192:193], v18 offset:0
    v_add_u32 v20, s43, v20
    v_mfma_f32_16x16x32_bf16 v[112:115], a[164:167], v[36:39], v[112:115]
    s_add_u32 m0, s38, 0
    v_exp_f32 v240, v152
    v_mfma_f32_16x16x32_bf16 v[112:115], a[168:171], v[40:43], v[112:115]
    buffer_load_dwordx4 v4, s[20:23], s36 offen offset:0 nt lds
    v_mfma_f32_16x16x32_bf16 v[112:115], a[172:175], v[44:47], v[112:115]
    ds_read_b64_tr_b16 a[194:195], v18 offset:4096
    v_add_u32 v21, s43, v21
    v_mfma_f32_16x16x32_bf16 v[132:135], a[176:179], v[32:35], v[220:223]
    v_exp_f32 v241, v153
    v_mfma_f32_16x16x32_bf16 v[132:135], a[180:183], v[36:39], v[132:135]
    ds_read_b64_tr_b16 a[196:197], v19 offset:0
    v_cvt_pk_bf16_f32 v204, v240, v241
    v_mfma_f32_16x16x32_bf16 v[132:135], a[184:187], v[40:43], v[132:135]
    v_exp_f32 v242, v154
    v_mfma_f32_16x16x32_bf16 v[132:135], a[188:191], v[44:47], v[132:135]
    buffer_load_dwordx4 v5, s[20:23], s36 offen offset:1024 nt lds
    v_mfma_f32_16x16x32_bf16 v[116:119], a[160:163], v[48:51], v[224:227]
    ds_read_b64_tr_b16 a[198:199], v19 offset:4096
    v_add_u32 v14, s39, v14
    v_mfma_f32_16x16x32_bf16 v[116:119], a[164:167], v[52:55], v[116:119]
    v_exp_f32 v243, v155
    v_mfma_f32_16x16x32_bf16 v[116:119], a[168:171], v[56:59], v[116:119]
    ds_read_b64_tr_b16 a[200:201], v18 offset:256
    v_cvt_pk_bf16_f32 v205, v242, v243
    v_mfma_f32_16x16x32_bf16 v[116:119], a[172:175], v[60:63], v[116:119]
    v_exp_f32 v244, v168
    v_mfma_f32_16x16x32_bf16 v[136:139], a[176:179], v[48:51], v[224:227]
    buffer_load_dwordx4 v4, s[20:23], s36 offen offset:2048 nt lds
    v_mfma_f32_16x16x32_bf16 v[136:139], a[180:183], v[52:55], v[136:139]
    ds_read_b64_tr_b16 a[202:203], v18 offset:4352
    v_add_u32 v15, s39, v15
    v_mfma_f32_16x16x32_bf16 v[136:139], a[184:187], v[56:59], v[136:139]
    v_exp_f32 v245, v169
    v_mfma_f32_16x16x32_bf16 v[136:139], a[188:191], v[60:63], v[136:139]
    ds_read_b64_tr_b16 a[204:205], v19 offset:256
    v_cvt_pk_bf16_f32 v206, v244, v245
    v_mfma_f32_16x16x32_bf16 v[120:123], a[160:163], v[64:67], v[228:231]
    v_exp_f32 v246, v170
    v_mfma_f32_16x16x32_bf16 v[120:123], a[164:167], v[68:71], v[120:123]
    buffer_load_dwordx4 v5, s[20:23], s36 offen offset:3072 nt lds
    v_mfma_f32_16x16x32_bf16 v[120:123], a[168:171], v[72:75], v[120:123]
    ds_read_b64_tr_b16 a[206:207], v19 offset:4352
    v_or3_b32 v22, v204, v205, v206
    v_mfma_f32_16x16x32_bf16 v[120:123], a[172:175], v[76:79], v[120:123]
    v_exp_f32 v247, v171
    v_mfma_f32_16x16x32_bf16 v[140:143], a[176:179], v[64:67], v[228:231]
    s_add_u32 s92, s36, 131072
    ds_read_b64_tr_b16 a[208:209], v18 offset:512
    v_cvt_pk_bf16_f32 v207, v246, v247
    v_mfma_f32_16x16x32_bf16 v[140:143], a[180:183], v[68:71], v[140:143]
    s_add_u32 m0, s38, 16384
    v_exp_f32 v248, v156
    v_mfma_f32_16x16x32_bf16 v[140:143], a[184:187], v[72:75], v[140:143]
    buffer_load_dwordx4 v4, s[20:23], s92 offen offset:0 nt lds
    v_mfma_f32_16x16x32_bf16 v[140:143], a[188:191], v[76:79], v[140:143]
    ds_read_b64_tr_b16 a[210:211], v18 offset:4608
    v_mfma_f32_16x16x32_bf16 v[124:127], a[160:163], v[80:83], v[232:235]
    v_exp_f32 v249, v157
    v_mfma_f32_16x16x32_bf16 v[124:127], a[164:167], v[84:87], v[124:127]
    ds_read_b64_tr_b16 a[212:213], v19 offset:512
    v_cvt_pk_bf16_f32 v208, v248, v249
    v_mfma_f32_16x16x32_bf16 v[124:127], a[168:171], v[88:91], v[124:127]
    v_exp_f32 v250, v158
    v_mfma_f32_16x16x32_bf16 v[124:127], a[172:175], v[92:95], v[124:127]
    buffer_load_dwordx4 v5, s[20:23], s92 offen offset:1024 nt lds
    v_mfma_f32_16x16x32_bf16 v[144:147], a[176:179], v[80:83], v[232:235]
    ds_read_b64_tr_b16 a[214:215], v19 offset:4608
    v_or3_b32 v22, v207, v208, v22
    v_mfma_f32_16x16x32_bf16 v[144:147], a[180:183], v[84:87], v[144:147]
    v_exp_f32 v251, v159
    v_mfma_f32_16x16x32_bf16 v[144:147], a[184:187], v[88:91], v[144:147]
    ds_read_b64_tr_b16 a[216:217], v18 offset:768
    v_cvt_pk_bf16_f32 v209, v250, v251
    v_mfma_f32_16x16x32_bf16 v[144:147], a[188:191], v[92:95], v[144:147]
    v_exp_f32 v252, v172
    v_mfma_f32_16x16x32_bf16 v[128:131], a[160:163], v[96:99], v[236:239]
    buffer_load_dwordx4 v4, s[20:23], s92 offen offset:2048 nt lds
    v_mfma_f32_16x16x32_bf16 v[128:131], a[164:167], v[100:103], v[128:131]
    ds_read_b64_tr_b16 a[218:219], v18 offset:4864
    v_mfma_f32_16x16x32_bf16 v[128:131], a[168:171], v[104:107], v[128:131]
    v_exp_f32 v253, v173
    v_mfma_f32_16x16x32_bf16 v[128:131], a[172:175], v[108:111], v[128:131]
    ds_read_b64_tr_b16 a[220:221], v19 offset:768
    v_cvt_pk_bf16_f32 v210, v252, v253
    v_mfma_f32_16x16x32_bf16 v[148:151], a[176:179], v[96:99], v[236:239]
    v_exp_f32 v254, v174
    v_mfma_f32_16x16x32_bf16 v[148:151], a[180:183], v[100:103], v[148:151]
    buffer_load_dwordx4 v5, s[20:23], s92 offen offset:3072 nt lds
    v_mfma_f32_16x16x32_bf16 v[148:151], a[184:187], v[104:107], v[148:151]
    ds_read_b64_tr_b16 a[222:223], v19 offset:4864
    v_or3_b32 v22, v209, v210, v22
    v_mfma_f32_16x16x32_bf16 v[148:151], a[188:191], v[108:111], v[148:151]
    v_exp_f32 v255, v175
    v_mfma_f32_16x16x32_bf16 a[224:227], a[244:247], v[184:187], 0
    v_exp_f32 v240, v160
    v_mfma_f32_16x16x32_bf16 a[228:231], a[244:247], v[188:191], 0
    v_exp_f32 v241, v161
    v_mfma_f32_16x16x32_bf16 a[232:235], a[244:247], v[192:195], 0
    s_add_u32 m0, s37, 0
    v_exp_f32 v242, v162
    v_mfma_f32_16x16x32_bf16 a[236:239], a[244:247], v[196:199], 0
    buffer_load_dwordx4 v2, s[16:19], s35 offen offset:0 nt lds
    v_mfma_f32_16x16x32_bf16 a[240:243], a[244:247], v[200:203], 0
    s_waitcnt lgkmcnt(0)
    v_exp_f32 v243, v163
    v_mfma_f32_16x16x32_bf16 a[128:131], a[192:195], v[200:203], 0
    ds_read_b128 a[160:163], v16 offset:0
    v_cvt_pk_bf16_f32 v211, v254, v255
    v_mfma_f32_16x16x32_bf16 a[96:99], a[192:195], v[196:199], 0
    v_cvt_pk_bf16_f32 v212, v240, v241
    v_or3_b32 v22, v211, v212, v22
    v_mfma_f32_16x16x32_bf16 a[64:67], a[192:195], v[192:195], 0
    buffer_load_dwordx4 v2, s[16:19], s35 offen offset:1024 nt lds
    v_mfma_f32_16x16x32_bf16 a[32:35], a[192:195], v[188:191], 0
    v_exp_f32 v244, v176
    v_mfma_f32_16x16x32_bf16 a[0:3], a[192:195], v[184:187], 0
    ds_read_b128 a[164:167], v16 offset:256
    v_cvt_pk_bf16_f32 v213, v242, v243
    v_mfma_f32_16x16x32_bf16 a[4:7], a[196:199], v[184:187], 0
    v_exp_f32 v245, v177
    v_mfma_f32_16x16x32_bf16 a[36:39], a[196:199], v[188:191], 0
    buffer_load_dwordx4 v3, s[16:19], s35 offen offset:2048 nt lds
    v_mfma_f32_16x16x32_bf16 a[68:71], a[196:199], v[192:195], 0
    v_exp_f32 v246, v178
    v_mfma_f32_16x16x32_bf16 a[100:103], a[196:199], v[196:199], 0
    ds_read_b128 a[168:171], v17 offset:0
    v_cvt_pk_bf16_f32 v214, v244, v245
    v_mfma_f32_16x16x32_bf16 a[132:135], a[196:199], v[200:203], 0
    v_exp_f32 v247, v179
    v_mfma_f32_16x16x32_bf16 a[136:139], a[200:203], v[200:203], 0
    buffer_load_dwordx4 v3, s[16:19], s35 offen offset:3072 nt lds
    v_mfma_f32_16x16x32_bf16 a[104:107], a[200:203], v[196:199], 0
    v_or3_b32 v22, v213, v214, v22
    v_cvt_pk_bf16_f32 v215, v246, v247
    v_mfma_f32_16x16x32_bf16 a[72:75], a[200:203], v[192:195], 0
    s_add_u32 s93, s35, 131072
    ds_read_b128 a[172:175], v17 offset:256
    v_add_u32 v18, s40, v18
    v_mfma_f32_16x16x32_bf16 a[40:43], a[200:203], v[188:191], 0
    s_add_u32 m0, s37, 16384
    v_exp_f32 v248, v164
    v_mfma_f32_16x16x32_bf16 a[8:11], a[200:203], v[184:187], 0
    buffer_load_dwordx4 v2, s[16:19], s93 offen offset:0 nt lds
    v_mfma_f32_16x16x32_bf16 a[12:15], a[204:207], v[184:187], 0
    v_exp_f32 v249, v165
    v_mfma_f32_16x16x32_bf16 a[44:47], a[204:207], v[188:191], 0
    ds_read_b128 a[176:179], v16 offset:4096
    v_cvt_pk_bf16_f32 v216, v248, v249
    v_mfma_f32_16x16x32_bf16 a[76:79], a[204:207], v[192:195], 0
    v_exp_f32 v250, v166
    v_mfma_f32_16x16x32_bf16 a[108:111], a[204:207], v[196:199], 0
    buffer_load_dwordx4 v2, s[16:19], s93 offen offset:1024 nt lds
    v_mfma_f32_16x16x32_bf16 a[140:143], a[204:207], v[200:203], 0
    v_exp_f32 v251, v167
    v_mfma_f32_16x16x32_bf16 a[144:147], a[208:211], v[200:203], 0
    ds_read_b128 a[180:183], v16 offset:4352
    v_or3_b32 v22, v215, v216, v22
    v_mfma_f32_16x16x32_bf16 a[112:115], a[208:211], v[196:199], 0
    v_cvt_pk_bf16_f32 v217, v250, v251
    v_add_u32 v19, s40, v19
    v_mfma_f32_16x16x32_bf16 a[80:83], a[208:211], v[192:195], 0
    buffer_load_dwordx4 v3, s[16:19], s93 offen offset:2048 nt lds
    v_mfma_f32_16x16x32_bf16 a[48:51], a[208:211], v[188:191], 0
    v_exp_f32 v252, v180
    v_mfma_f32_16x16x32_bf16 a[16:19], a[208:211], v[184:187], 0
    ds_read_b128 a[184:187], v17 offset:4096
    v_mfma_f32_16x16x32_bf16 a[20:23], a[212:215], v[184:187], 0
    v_exp_f32 v253, v181
    v_mfma_f32_16x16x32_bf16 a[52:55], a[212:215], v[188:191], 0
    buffer_load_dwordx4 v3, s[16:19], s93 offen offset:3072 nt lds
    v_mfma_f32_16x16x32_bf16 a[84:87], a[212:215], v[192:195], 0
    s_add_u32 s38, s41, s6
    v_exp_f32 v254, v182
    v_mfma_f32_16x16x32_bf16 a[116:119], a[212:215], v[196:199], 0
    s_add_u32 s37, s42, s6
    ds_read_b128 a[188:191], v17 offset:4352
    v_cvt_pk_bf16_f32 v218, v252, v253
    v_mfma_f32_16x16x32_bf16 a[148:151], a[212:215], v[200:203], 0
    s_add_u32 s41, s41, s39
    v_exp_f32 v255, v183
    v_mfma_f32_16x16x32_bf16 a[152:155], a[216:219], v[200:203], 0
    s_add_u32 s42, s42, s40
    v_or3_b32 v22, v217, v218, v22
    v_cvt_pk_bf16_f32 v219, v254, v255
    v_mfma_f32_16x16x32_bf16 a[120:123], a[216:219], v[196:199], 0
    s_add_u32 s36, s36, 16384
    v_or_b32 v22, v219, v22
    v_and_b32 v23, 0x40004000, v22
    v_mfma_f32_16x16x32_bf16 a[88:91], a[216:219], v[192:195], 0
    s_add_u32 s35, s35, 16384
    v_cmp_ne_u32 vcc, 0, v23
    v_add_u32 v16, s39, v16
    v_mfma_f32_16x16x32_bf16 a[56:59], a[216:219], v[188:191], 0
    v_exp_f32 v240, v112
    v_mfma_f32_16x16x32_bf16 a[24:27], a[216:219], v[184:187], 0
    v_exp_f32 v241, v113
    v_mfma_f32_16x16x32_bf16 a[28:31], a[220:223], v[184:187], 0
    v_exp_f32 v242, v114
    v_mfma_f32_16x16x32_bf16 a[60:63], a[220:223], v[188:191], 0
    v_exp_f32 v243, v115
    v_mfma_f32_16x16x32_bf16 a[92:95], a[220:223], v[192:195], 0
    v_exp_f32 v244, v132
    v_mfma_f32_16x16x32_bf16 a[124:127], a[220:223], v[196:199], 0
    v_exp_f32 v245, v133
    v_mfma_f32_16x16x32_bf16 a[156:159], a[220:223], v[200:203], 0
    s_waitcnt lgkmcnt(0)
    v_add_u32 v17, s39, v17
    s_cbranch_vccnz L_tramp0
L_back0:
    v_mfma_f32_16x16x32_bf16 v[152:155], a[160:163], v[32:35], v[220:223]
    s_mov_b32 s43, s40
    ds_read_b64_tr_b16 a[192:193], v20 offset:0
    v_cvt_pk_bf16_f32 v184, v240, v241
    v_mfma_f32_16x16x32_bf16 v[152:155], a[164:167], v[36:39], v[152:155]
    s_cmp_ge_u32 s41, 98304
    ds_read_b64_tr_b16 a[194:195], v20 offset:4096
    v_cvt_pk_bf16_f32 v185, v242, v243
    v_mfma_f32_16x16x32_bf16 v[152:155], a[168:171], v[40:43], v[152:155]
    s_cselect_b32 s39, 4294868992, s45
    v_exp_f32 v246, v134
    v_mfma_f32_16x16x32_bf16 v[152:155], a[172:175], v[44:47], v[152:155]
    s_cmp_ge_u32 s42, 98304
    ds_read_b64_tr_b16 a[196:197], v21 offset:0
    v_cvt_pk_bf16_f32 v186, v244, v245
    v_mfma_f32_16x16x32_bf16 v[168:171], a[176:179], v[32:35], v[220:223]
    s_cselect_b32 s40, 4294868992, s45
    v_exp_f32 v247, v135
    v_mfma_f32_16x16x32_bf16 v[168:171], a[180:183], v[36:39], v[168:171]
    ds_read_b64_tr_b16 a[198:199], v21 offset:4096
    v_or3_b32 v22, v184, v185, v186
    v_mfma_f32_16x16x32_bf16 v[168:171], a[184:187], v[40:43], v[168:171]
    v_exp_f32 v248, v116
    v_mfma_f32_16x16x32_bf16 v[168:171], a[188:191], v[44:47], v[168:171]
    ds_read_b64_tr_b16 a[200:201], v20 offset:256
    v_cvt_pk_bf16_f32 v187, v246, v247
    v_mfma_f32_16x16x32_bf16 v[156:159], a[160:163], v[48:51], v[224:227]
    ds_read_b64_tr_b16 a[202:203], v20 offset:4352
    v_mfma_f32_16x16x32_bf16 v[156:159], a[164:167], v[52:55], v[156:159]
    v_exp_f32 v249, v117
    v_mfma_f32_16x16x32_bf16 v[156:159], a[168:171], v[56:59], v[156:159]
    ds_read_b64_tr_b16 a[204:205], v21 offset:256
    v_cvt_pk_bf16_f32 v188, v248, v249
    v_mfma_f32_16x16x32_bf16 v[156:159], a[172:175], v[60:63], v[156:159]
    v_exp_f32 v250, v118
    v_mfma_f32_16x16x32_bf16 v[172:175], a[176:179], v[48:51], v[224:227]
    ds_read_b64_tr_b16 a[206:207], v21 offset:4352
    v_or3_b32 v22, v187, v188, v22
    v_mfma_f32_16x16x32_bf16 v[172:175], a[180:183], v[52:55], v[172:175]
    v_exp_f32 v251, v119
    v_mfma_f32_16x16x32_bf16 v[172:175], a[184:187], v[56:59], v[172:175]
    ds_read_b64_tr_b16 a[208:209], v20 offset:512
    v_cvt_pk_bf16_f32 v189, v250, v251
    v_mfma_f32_16x16x32_bf16 v[172:175], a[188:191], v[60:63], v[172:175]
    ds_read_b64_tr_b16 a[210:211], v20 offset:4608
    v_mfma_f32_16x16x32_bf16 v[160:163], a[160:163], v[64:67], v[228:231]
    v_exp_f32 v252, v136
    v_mfma_f32_16x16x32_bf16 v[160:163], a[164:167], v[68:71], v[160:163]
    ds_read_b64_tr_b16 a[212:213], v21 offset:512
    v_mfma_f32_16x16x32_bf16 v[160:163], a[168:171], v[72:75], v[160:163]
    v_exp_f32 v253, v137
    v_mfma_f32_16x16x32_bf16 v[160:163], a[172:175], v[76:79], v[160:163]
    ds_read_b64_tr_b16 a[214:215], v21 offset:4608
    v_cvt_pk_bf16_f32 v190, v252, v253
    v_mfma_f32_16x16x32_bf16 v[176:179], a[176:179], v[64:67], v[228:231]
    v_exp_f32 v254, v138
    v_mfma_f32_16x16x32_bf16 v[176:179], a[180:183], v[68:71], v[176:179]
    ds_read_b64_tr_b16 a[216:217], v20 offset:768
    v_or3_b32 v22, v189, v190, v22
    v_mfma_f32_16x16x32_bf16 v[176:179], a[184:187], v[72:75], v[176:179]
    ds_read_b64_tr_b16 a[218:219], v20 offset:4864
    v_mfma_f32_16x16x32_bf16 v[176:179], a[188:191], v[76:79], v[176:179]
    v_exp_f32 v255, v139
    v_mfma_f32_16x16x32_bf16 v[164:167], a[160:163], v[80:83], v[232:235]
    ds_read_b64_tr_b16 a[220:221], v21 offset:768
    v_cvt_pk_bf16_f32 v191, v254, v255
    v_mfma_f32_16x16x32_bf16 v[164:167], a[164:167], v[84:87], v[164:167]
    v_exp_f32 v240, v120
    v_mfma_f32_16x16x32_bf16 v[164:167], a[168:171], v[88:91], v[164:167]
    ds_read_b64_tr_b16 a[222:223], v21 offset:4864
    v_mfma_f32_16x16x32_bf16 v[164:167], a[172:175], v[92:95], v[164:167]
    v_exp_f32 v241, v121
    v_mfma_f32_16x16x32_bf16 v[180:183], a[176:179], v[80:83], v[232:235]
    v_exp_f32 v242, v122
    v_mfma_f32_16x16x32_bf16 v[180:183], a[180:183], v[84:87], v[180:183]
    v_cvt_pk_bf16_f32 v192, v240, v241
    v_or3_b32 v22, v191, v192, v22
    v_mfma_f32_16x16x32_bf16 v[180:183], a[184:187], v[88:91], v[180:183]
    v_exp_f32 v243, v123
    v_mfma_f32_16x16x32_bf16 v[180:183], a[188:191], v[92:95], v[180:183]
    v_exp_f32 v244, v140
    v_mfma_f32_16x16x32_bf16 a[224:227], a[244:247], v[204:207], a[224:227]
    v_exp_f32 v245, v141
    v_mfma_f32_16x16x32_bf16 a[228:231], a[244:247], v[208:211], a[228:231]
    v_exp_f32 v246, v142
    v_mfma_f32_16x16x32_bf16 a[232:235], a[244:247], v[212:215], a[232:235]
    v_cvt_pk_bf16_f32 v193, v242, v243
    v_cvt_pk_bf16_f32 v194, v244, v245
    v_mfma_f32_16x16x32_bf16 a[236:239], a[244:247], v[216:219], a[236:239]
    s_waitcnt vmcnt(16) lgkmcnt(0)
    s_barrier
    v_mfma_f32_16x16x32_bf16 a[96:99], a[192:195], v[216:219], a[96:99]
    v_exp_f32 v247, v143
    v_mfma_f32_16x16x32_bf16 a[64:67], a[192:195], v[212:215], a[64:67]
    ds_read_b128 a[160:163], v14 offset:0
    v_or3_b32 v22, v193, v194, v22
    v_mfma_f32_16x16x32_bf16 a[32:35], a[192:195], v[208:211], a[32:35]
    v_exp_f32 v248, v124
    v_mfma_f32_16x16x32_bf16 a[0:3], a[192:195], v[204:207], a[0:3]
    v_exp_f32 v249, v125
    v_mfma_f32_16x16x32_bf16 a[4:7], a[196:199], v[204:207], a[4:7]
    ds_read_b128 a[164:167], v14 offset:256
    v_cvt_pk_bf16_f32 v195, v246, v247
    v_mfma_f32_16x16x32_bf16 a[36:39], a[196:199], v[208:211], a[36:39]
    v_exp_f32 v250, v126
    v_mfma_f32_16x16x32_bf16 a[68:71], a[196:199], v[212:215], a[68:71]
    v_cvt_pk_bf16_f32 v196, v248, v249
    v_or3_b32 v22, v195, v196, v22
    v_mfma_f32_16x16x32_bf16 a[100:103], a[196:199], v[216:219], a[100:103]
    ds_read_b128 a[168:171], v15 offset:0
    v_mfma_f32_16x16x32_bf16 a[104:107], a[200:203], v[216:219], a[104:107]
    v_exp_f32 v251, v127
    v_mfma_f32_16x16x32_bf16 a[72:75], a[200:203], v[212:215], a[72:75]
    v_exp_f32 v252, v144
    v_mfma_f32_16x16x32_bf16 a[40:43], a[200:203], v[208:211], a[40:43]
    ds_read_b128 a[172:175], v15 offset:256
    v_cvt_pk_bf16_f32 v197, v250, v251
    v_mfma_f32_16x16x32_bf16 a[8:11], a[200:203], v[204:207], a[8:11]
    v_exp_f32 v253, v145
    v_mfma_f32_16x16x32_bf16 a[12:15], a[204:207], v[204:207], a[12:15]
    v_exp_f32 v254, v146
    v_mfma_f32_16x16x32_bf16 a[44:47], a[204:207], v[208:211], a[44:47]
    ds_read_b128 a[176:179], v14 offset:4096
    v_cvt_pk_bf16_f32 v198, v252, v253
    v_mfma_f32_16x16x32_bf16 a[76:79], a[204:207], v[212:215], a[76:79]
    v_or3_b32 v22, v197, v198, v22
    v_mfma_f32_16x16x32_bf16 a[108:111], a[204:207], v[216:219], a[108:111]
    v_exp_f32 v255, v147
    v_mfma_f32_16x16x32_bf16 a[112:115], a[208:211], v[216:219], a[112:115]
    ds_read_b128 a[180:183], v14 offset:4352
    v_cvt_pk_bf16_f32 v199, v254, v255
    v_mfma_f32_16x16x32_bf16 a[80:83], a[208:211], v[212:215], a[80:83]
    v_exp_f32 v240, v128
    v_mfma_f32_16x16x32_bf16 a[48:51], a[208:211], v[208:211], a[48:51]
    v_exp_f32 v241, v129
    v_mfma_f32_16x16x32_bf16 a[16:19], a[208:211], v[204:207], a[16:19]
    ds_read_b128 a[184:187], v15 offset:4096
    v_cvt_pk_bf16_f32 v200, v240, v241
    v_mfma_f32_16x16x32_bf16 a[20:23], a[212:215], v[204:207], a[20:23]
    v_exp_f32 v242, v130
    v_mfma_f32_16x16x32_bf16 a[52:55], a[212:215], v[208:211], a[52:55]
    v_or3_b32 v22, v199, v200, v22
    v_mfma_f32_16x16x32_bf16 a[84:87], a[212:215], v[212:215], a[84:87]
    ds_read_b128 a[188:191], v15 offset:4352
    v_mfma_f32_16x16x32_bf16 a[116:119], a[212:215], v[216:219], a[116:119]
    v_exp_f32 v243, v131
    v_mfma_f32_16x16x32_bf16 a[120:123], a[216:219], v[216:219], a[120:123]
    v_exp_f32 v244, v148
    v_mfma_f32_16x16x32_bf16 a[88:91], a[216:219], v[212:215], a[88:91]
    v_exp_f32 v245, v149
    v_mfma_f32_16x16x32_bf16 a[56:59], a[216:219], v[208:211], a[56:59]
    v_exp_f32 v246, v150
    v_mfma_f32_16x16x32_bf16 a[24:27], a[216:219], v[204:207], a[24:27]
    v_exp_f32 v247, v151
    v_mfma_f32_16x16x32_bf16 a[28:31], a[220:223], v[204:207], a[28:31]
    v_cvt_pk_bf16_f32 v201, v242, v243
    v_cvt_pk_bf16_f32 v202, v244, v245
    v_mfma_f32_16x16x32_bf16 a[60:63], a[220:223], v[208:211], a[60:63]
    v_or3_b32 v22, v201, v202, v22
    v_cvt_pk_bf16_f32 v203, v246, v247
    v_mfma_f32_16x16x32_bf16 a[92:95], a[220:223], v[212:215], a[92:95]
    v_or_b32 v22, v203, v22
    v_and_b32 v23, 0x40004000, v22
    v_cmp_ne_u32 vcc, 0, v23
    v_mfma_f32_16x16x32_bf16 a[124:127], a[220:223], v[216:219], a[124:127]
    s_waitcnt vmcnt(8) lgkmcnt(0)
    s_barrier
    s_cbranch_vccnz L_tramp1
L_back1:
    s_mov_b32 s32, 4
.p2align 6
L_aloop:
    v_exp_f32 v240, v152
    v_exp_f32 v241, v153
    v_exp_f32 v242, v154
    v_cvt_pk_bf16_f32 v204, v240, v241
    v_exp_f32 v243, v155
    v_exp_f32 v244, v168
    v_cvt_pk_bf16_f32 v205, v242, v243
    v_exp_f32 v245, v169
    v_exp_f32 v246, v170
    v_cvt_pk_bf16_f32 v206, v244, v245
    v_exp_f32 v247, v171
    v_exp_f32 v248, v156
    v_cvt_pk_bf16_f32 v207, v246, v247
    v_exp_f32 v249, v157
    v_exp_f32 v250, v158
    v_cvt_pk_bf16_f32 v208, v248, v249
    v_exp_f32 v251, v159
    v_exp_f32 v252, v172
    v_cvt_pk_bf16_f32 v209, v250, v251
    v_exp_f32 v253, v173
    v_exp_f32 v254, v174
    v_cvt_pk_bf16_f32 v210, v252, v253
    v_exp_f32 v255, v175
    v_exp_f32 v240, v160
    v_cvt_pk_bf16_f32 v211, v254, v255
    v_exp_f32 v241, v161
    v_exp_f32 v242, v162
    v_cvt_pk_bf16_f32 v212, v240, v241
    v_exp_f32 v243, v163
    v_exp_f32 v244, v176
    v_cvt_pk_bf16_f32 v213, v242, v243
    v_exp_f32 v245, v177
    v_exp_f32 v246, v178
    v_cvt_pk_bf16_f32 v214, v244, v245
    v_exp_f32 v247, v179
    v_exp_f32 v248, v164
    v_cvt_pk_bf16_f32 v215, v246, v247
    v_exp_f32 v249, v165
    v_exp_f32 v250, v166
    v_cvt_pk_bf16_f32 v216, v248, v249
    v_exp_f32 v251, v167
    v_exp_f32 v252, v180
    v_cvt_pk_bf16_f32 v217, v250, v251
    v_exp_f32 v253, v181
    v_exp_f32 v254, v182
    v_cvt_pk_bf16_f32 v218, v252, v253
    v_exp_f32 v255, v183
    s_nop 0
    v_cvt_pk_bf16_f32 v219, v254, v255
    v_or3_b32 v22, v204, v205, v206
    v_or3_b32 v22, v207, v208, v22
    v_or3_b32 v22, v209, v210, v22
    v_or3_b32 v22, v211, v212, v22
    v_or3_b32 v22, v213, v214, v22
    v_or3_b32 v22, v215, v216, v22
    v_or3_b32 v22, v217, v218, v22
    v_or_b32 v22, v219, v22
    v_and_b32 v23, 0x40004000, v22
    v_cmp_ne_u32 vcc, 0, v23
    v_mfma_f32_16x16x32_bf16 v[112:115], a[160:163], v[32:35], v[220:223]
    ds_read_b64_tr_b16 a[192:193], v18 offset:0
    v_add_u32 v20, s43, v20
    v_mfma_f32_16x16x32_bf16 v[112:115], a[164:167], v[36:39], v[112:115]
    s_add_u32 m0, s38, 0
    v_add_u32 v21, s43, v21
    v_add_u32 v14, s39, v14
    v_mfma_f32_16x16x32_bf16 v[112:115], a[168:171], v[40:43], v[112:115]
    buffer_load_dwordx4 v4, s[20:23], s36 offen offset:0 nt lds
    v_mfma_f32_16x16x32_bf16 v[112:115], a[172:175], v[44:47], v[112:115]
    ds_read_b64_tr_b16 a[194:195], v18 offset:4096
    v_add_u32 v15, s39, v15
    v_mfma_f32_16x16x32_bf16 v[132:135], a[176:179], v[32:35], v[220:223]
    v_mfma_f32_16x16x32_bf16 v[132:135], a[180:183], v[36:39], v[132:135]
    ds_read_b64_tr_b16 a[196:197], v19 offset:0
    v_mfma_f32_16x16x32_bf16 v[132:135], a[184:187], v[40:43], v[132:135]
    v_mfma_f32_16x16x32_bf16 v[132:135], a[188:191], v[44:47], v[132:135]
    buffer_load_dwordx4 v5, s[20:23], s36 offen offset:1024 nt lds
    v_mfma_f32_16x16x32_bf16 v[116:119], a[160:163], v[48:51], v[224:227]
    ds_read_b64_tr_b16 a[198:199], v19 offset:4096
    v_mfma_f32_16x16x32_bf16 v[116:119], a[164:167], v[52:55], v[116:119]
    v_mfma_f32_16x16x32_bf16 v[116:119], a[168:171], v[56:59], v[116:119]
    ds_read_b64_tr_b16 a[200:201], v18 offset:256
    v_mfma_f32_16x16x32_bf16 v[116:119], a[172:175], v[60:63], v[116:119]
    v_mfma_f32_16x16x32_bf16 v[136:139], a[176:179], v[48:51], v[224:227]
    buffer_load_dwordx4 v4, s[20:23], s36 offen offset:2048 nt lds
    v_mfma_f32_16x16x32_bf16 v[136:139], a[180:183], v[52:55], v[136:139]
    ds_read_b64_tr_b16 a[202:203], v18 offset:4352
    v_mfma_f32_16x16x32_bf16 v[136:139], a[184:187], v[56:59], v[136:139]
    v_mfma_f32_16x16x32_bf16 v[136:139], a[188:191], v[60:63], v[136:139]
    ds_read_b64_tr_b16 a[204:205], v19 offset:256
    v_mfma_f32_16x16x32_bf16 v[120:123], a[160:163], v[64:67], v[228:231]
    v_mfma_f32_16x16x32_bf16 v[120:123], a[164:167], v[68:71], v[120:123]
    buffer_load_dwordx4 v5, s[20:23], s36 offen offset:3072 nt lds
    v_mfma_f32_16x16x32_bf16 v[120:123], a[168:171], v[72:75], v[120:123]
    ds_read_b64_tr_b16 a[206:207], v19 offset:4352
    v_mfma_f32_16x16x32_bf16 v[120:123], a[172:175], v[76:79], v[120:123]
    v_mfma_f32_16x16x32_bf16 v[140:143], a[176:179], v[64:67], v[228:231]
    s_add_u32 s94, s36, 131072
    ds_read_b64_tr_b16 a[208:209], v18 offset:512
    v_mfma_f32_16x16x32_bf16 v[140:143], a[180:183], v[68:71], v[140:143]
    s_add_u32 m0, s38, 16384
    v_mfma_f32_16x16x32_bf16 v[140:143], a[184:187], v[72:75], v[140:143]
    buffer_load_dwordx4 v4, s[20:23], s94 offen offset:0 nt lds
    v_mfma_f32_16x16x32_bf16 v[140:143], a[188:191], v[76:79], v[140:143]
    ds_read_b64_tr_b16 a[210:211], v18 offset:4608
    v_mfma_f32_16x16x32_bf16 v[124:127], a[160:163], v[80:83], v[232:235]
    v_mfma_f32_16x16x32_bf16 v[124:127], a[164:167], v[84:87], v[124:127]
    ds_read_b64_tr_b16 a[212:213], v19 offset:512
    v_mfma_f32_16x16x32_bf16 v[124:127], a[168:171], v[88:91], v[124:127]
    v_mfma_f32_16x16x32_bf16 v[124:127], a[172:175], v[92:95], v[124:127]
    buffer_load_dwordx4 v5, s[20:23], s94 offen offset:1024 nt lds
    v_mfma_f32_16x16x32_bf16 v[144:147], a[176:179], v[80:83], v[232:235]
    ds_read_b64_tr_b16 a[214:215], v19 offset:4608
    v_mfma_f32_16x16x32_bf16 v[144:147], a[180:183], v[84:87], v[144:147]
    v_mfma_f32_16x16x32_bf16 v[144:147], a[184:187], v[88:91], v[144:147]
    ds_read_b64_tr_b16 a[216:217], v18 offset:768
    v_mfma_f32_16x16x32_bf16 v[144:147], a[188:191], v[92:95], v[144:147]
    v_mfma_f32_16x16x32_bf16 v[128:131], a[160:163], v[96:99], v[236:239]
    buffer_load_dwordx4 v4, s[20:23], s94 offen offset:2048 nt lds
    v_mfma_f32_16x16x32_bf16 v[128:131], a[164:167], v[100:103], v[128:131]
    ds_read_b64_tr_b16 a[218:219], v18 offset:4864
    v_mfma_f32_16x16x32_bf16 v[128:131], a[168:171], v[104:107], v[128:131]
    v_mfma_f32_16x16x32_bf16 v[128:131], a[172:175], v[108:111], v[128:131]
    ds_read_b64_tr_b16 a[220:221], v19 offset:768
    v_mfma_f32_16x16x32_bf16 v[148:151], a[176:179], v[96:99], v[236:239]
    v_mfma_f32_16x16x32_bf16 v[148:151], a[180:183], v[100:103], v[148:151]
    buffer_load_dwordx4 v5, s[20:23], s94 offen offset:3072 nt lds
    v_mfma_f32_16x16x32_bf16 v[148:151], a[184:187], v[104:107], v[148:151]
    ds_read_b64_tr_b16 a[222:223], v19 offset:4864
    v_add_u32 v18, s40, v18
    v_mfma_f32_16x16x32_bf16 v[148:151], a[188:191], v[108:111], v[148:151]
    v_add_u32 v19, s40, v19
    v_mfma_f32_16x16x32_bf16 a[224:227], a[244:247], v[184:187], a[224:227]
    v_mfma_f32_16x16x32_bf16 a[228:231], a[244:247], v[188:191], a[228:231]
    v_mfma_f32_16x16x32_bf16 a[232:235], a[244:247], v[192:195], a[232:235]
    s_add_u32 m0, s37, 0
    v_mfma_f32_16x16x32_bf16 a[236:239], a[244:247], v[196:199], a[236:239]
    buffer_load_dwordx4 v2, s[16:19], s35 offen offset:0 nt lds
    v_mfma_f32_16x16x32_bf16 a[240:243], a[244:247], v[200:203], a[240:243]
    s_waitcnt lgkmcnt(0)
    v_mfma_f32_16x16x32_bf16 a[128:131], a[192:195], v[200:203], a[128:131]
    ds_read_b128 a[160:163], v16 offset:0
    v_mfma_f32_16x16x32_bf16 a[96:99], a[192:195], v[196:199], a[96:99]
    v_mfma_f32_16x16x32_bf16 a[64:67], a[192:195], v[192:195], a[64:67]
    buffer_load_dwordx4 v2, s[16:19], s35 offen offset:1024 nt lds
    v_mfma_f32_16x16x32_bf16 a[32:35], a[192:195], v[188:191], a[32:35]
    v_mfma_f32_16x16x32_bf16 a[0:3], a[192:195], v[184:187], a[0:3]
    ds_read_b128 a[164:167], v16 offset:256
    v_mfma_f32_16x16x32_bf16 a[4:7], a[196:199], v[184:187], a[4:7]
    v_mfma_f32_16x16x32_bf16 a[36:39], a[196:199], v[188:191], a[36:39]
    buffer_load_dwordx4 v3, s[16:19], s35 offen offset:2048 nt lds
    v_mfma_f32_16x16x32_bf16 a[68:71], a[196:199], v[192:195], a[68:71]
    v_mfma_f32_16x16x32_bf16 a[100:103], a[196:199], v[196:199], a[100:103]
    ds_read_b128 a[168:171], v17 offset:0
    v_mfma_f32_16x16x32_bf16 a[132:135], a[196:199], v[200:203], a[132:135]
    v_mfma_f32_16x16x32_bf16 a[136:139], a[200:203], v[200:203], a[136:139]
    buffer_load_dwordx4 v3, s[16:19], s35 offen offset:3072 nt lds
    v_mfma_f32_16x16x32_bf16 a[104:107], a[200:203], v[196:199], a[104:107]
    v_mfma_f32_16x16x32_bf16 a[72:75], a[200:203], v[192:195], a[72:75]
    s_add_u32 s95, s35, 131072
    ds_read_b128 a[172:175], v17 offset:256
    v_mfma_f32_16x16x32_bf16 a[40:43], a[200:203], v[188:191], a[40:43]
    s_add_u32 m0, s37, 16384
    v_mfma_f32_16x16x32_bf16 a[8:11], a[200:203], v[184:187], a[8:11]
    buffer_load_dwordx4 v2, s[16:19], s95 offen offset:0 nt lds
    v_mfma_f32_16x16x32_bf16 a[12:15], a[204:207], v[184:187], a[12:15]
    v_mfma_f32_16x16x32_bf16 a[44:47], a[204:207], v[188:191], a[44:47]
    ds_read_b128 a[176:179], v16 offset:4096
    v_mfma_f32_16x16x32_bf16 a[76:79], a[204:207], v[192:195], a[76:79]
    v_mfma_f32_16x16x32_bf16 a[108:111], a[204:207], v[196:199], a[108:111]
    buffer_load_dwordx4 v2, s[16:19], s95 offen offset:1024 nt lds
    v_mfma_f32_16x16x32_bf16 a[140:143], a[204:207], v[200:203], a[140:143]
    v_mfma_f32_16x16x32_bf16 a[144:147], a[208:211], v[200:203], a[144:147]
    ds_read_b128 a[180:183], v16 offset:4352
    v_mfma_f32_16x16x32_bf16 a[112:115], a[208:211], v[196:199], a[112:115]
    v_mfma_f32_16x16x32_bf16 a[80:83], a[208:211], v[192:195], a[80:83]
    buffer_load_dwordx4 v3, s[16:19], s95 offen offset:2048 nt lds
    v_mfma_f32_16x16x32_bf16 a[48:51], a[208:211], v[188:191], a[48:51]
    v_mfma_f32_16x16x32_bf16 a[16:19], a[208:211], v[184:187], a[16:19]
    ds_read_b128 a[184:187], v17 offset:4096
    v_mfma_f32_16x16x32_bf16 a[20:23], a[212:215], v[184:187], a[20:23]
    v_mfma_f32_16x16x32_bf16 a[52:55], a[212:215], v[188:191], a[52:55]
    buffer_load_dwordx4 v3, s[16:19], s95 offen offset:3072 nt lds
    v_mfma_f32_16x16x32_bf16 a[84:87], a[212:215], v[192:195], a[84:87]
    s_add_u32 s38, s41, s6
    s_add_u32 s37, s42, s6
    s_add_u32 s41, s41, s39
    v_mfma_f32_16x16x32_bf16 a[116:119], a[212:215], v[196:199], a[116:119]
    s_add_u32 s42, s42, s40
    ds_read_b128 a[188:191], v17 offset:4352
    v_add_u32 v16, s39, v16
    v_mfma_f32_16x16x32_bf16 a[148:151], a[212:215], v[200:203], a[148:151]
    s_add_u32 s36, s36, 16384
    v_add_u32 v17, s39, v17
    v_mfma_f32_16x16x32_bf16 a[152:155], a[216:219], v[200:203], a[152:155]
    s_add_u32 s35, s35, 16384
    v_mfma_f32_16x16x32_bf16 a[120:123], a[216:219], v[196:199], a[120:123]
    s_mov_b32 s43, s40
    s_cmp_ge_u32 s41, 98304
    s_cselect_b32 s39, 4294868992, s45
    v_mfma_f32_16x16x32_bf16 a[88:91], a[216:219], v[192:195], a[88:91]
    s_cmp_ge_u32 s42, 98304
    s_cselect_b32 s40, 4294868992, s45
    v_mfma_f32_16x16x32_bf16 a[56:59], a[216:219], v[188:191], a[56:59]
    v_exp_f32 v240, v112
    v_mfma_f32_16x16x32_bf16 a[24:27], a[216:219], v[184:187], a[24:27]
    v_exp_f32 v241, v113
    v_mfma_f32_16x16x32_bf16 a[28:31], a[220:223], v[184:187], a[28:31]
    v_exp_f32 v242, v114
    v_mfma_f32_16x16x32_bf16 a[60:63], a[220:223], v[188:191], a[60:63]
    v_exp_f32 v243, v115
    v_mfma_f32_16x16x32_bf16 a[92:95], a[220:223], v[192:195], a[92:95]
    v_exp_f32 v244, v132
    v_mfma_f32_16x16x32_bf16 a[124:127], a[220:223], v[196:199], a[124:127]
    v_exp_f32 v245, v133
    v_mfma_f32_16x16x32_bf16 a[156:159], a[220:223], v[200:203], a[156:159]
    s_waitcnt lgkmcnt(0)
    s_cbranch_vccnz L_tramp2
L_back2:
    v_mfma_f32_16x16x32_bf16 v[152:155], a[160:163], v[32:35], v[220:223]
    ds_read_b64_tr_b16 a[192:193], v20 offset:0
    v_cvt_pk_bf16_f32 v184, v240, v241
    v_mfma_f32_16x16x32_bf16 v[152:155], a[164:167], v[36:39], v[152:155]
    ds_read_b64_tr_b16 a[194:195], v20 offset:4096
    v_cvt_pk_bf16_f32 v185, v242, v243
    v_mfma_f32_16x16x32_bf16 v[152:155], a[168:171], v[40:43], v[152:155]
    v_exp_f32 v246, v134
    v_mfma_f32_16x16x32_bf16 v[152:155], a[172:175], v[44:47], v[152:155]
    ds_read_b64_tr_b16 a[196:197], v21 offset:0
    v_cvt_pk_bf16_f32 v186, v244, v245
    v_mfma_f32_16x16x32_bf16 v[168:171], a[176:179], v[32:35], v[220:223]
    v_exp_f32 v247, v135
    v_mfma_f32_16x16x32_bf16 v[168:171], a[180:183], v[36:39], v[168:171]
    ds_read_b64_tr_b16 a[198:199], v21 offset:4096
    v_or3_b32 v22, v184, v185, v186
    v_mfma_f32_16x16x32_bf16 v[168:171], a[184:187], v[40:43], v[168:171]
    v_exp_f32 v248, v116
    v_mfma_f32_16x16x32_bf16 v[168:171], a[188:191], v[44:47], v[168:171]
    ds_read_b64_tr_b16 a[200:201], v20 offset:256
    v_cvt_pk_bf16_f32 v187, v246, v247
    v_mfma_f32_16x16x32_bf16 v[156:159], a[160:163], v[48:51], v[224:227]
    ds_read_b64_tr_b16 a[202:203], v20 offset:4352
    v_mfma_f32_16x16x32_bf16 v[156:159], a[164:167], v[52:55], v[156:159]
    v_exp_f32 v249, v117
    v_mfma_f32_16x16x32_bf16 v[156:159], a[168:171], v[56:59], v[156:159]
    ds_read_b64_tr_b16 a[204:205], v21 offset:256
    v_cvt_pk_bf16_f32 v188, v248, v249
    v_mfma_f32_16x16x32_bf16 v[156:159], a[172:175], v[60:63], v[156:159]
    v_exp_f32 v250, v118
    v_mfma_f32_16x16x32_bf16 v[172:175], a[176:179], v[48:51], v[224:227]
    ds_read_b64_tr_b16 a[206:207], v21 offset:4352
    v_or3_b32 v22, v187, v188, v22
    v_mfma_f32_16x16x32_bf16 v[172:175], a[180:183], v[52:55], v[172:175]
    v_exp_f32 v251, v119
    v_mfma_f32_16x16x32_bf16 v[172:175], a[184:187], v[56:59], v[172:175]
    ds_read_b64_tr_b16 a[208:209], v20 offset:512
    v_cvt_pk_bf16_f32 v189, v250, v251
    v_mfma_f32_16x16x32_bf16 v[172:175], a[188:191], v[60:63], v[172:175]
    ds_read_b64_tr_b16 a[210:211], v20 offset:4608
    v_mfma_f32_16x16x32_bf16 v[160:163], a[160:163], v[64:67], v[228:231]
    v_exp_f32 v252, v136
    v_mfma_f32_16x16x32_bf16 v[160:163], a[164:167], v[68:71], v[160:163]
    ds_read_b64_tr_b16 a[212:213], v21 offset:512
    v_mfma_f32_16x16x32_bf16 v[160:163], a[168:171], v[72:75], v[160:163]
    v_exp_f32 v253, v137
    v_mfma_f32_16x16x32_bf16 v[160:163], a[172:175], v[76:79], v[160:163]
    ds_read_b64_tr_b16 a[214:215], v21 offset:4608
    v_cvt_pk_bf16_f32 v190, v252, v253
    v_mfma_f32_16x16x32_bf16 v[176:179], a[176:179], v[64:67], v[228:231]
    v_exp_f32 v254, v138
    v_mfma_f32_16x16x32_bf16 v[176:179], a[180:183], v[68:71], v[176:179]
    ds_read_b64_tr_b16 a[216:217], v20 offset:768
    v_or3_b32 v22, v189, v190, v22
    v_mfma_f32_16x16x32_bf16 v[176:179], a[184:187], v[72:75], v[176:179]
    ds_read_b64_tr_b16 a[218:219], v20 offset:4864
    v_mfma_f32_16x16x32_bf16 v[176:179], a[188:191], v[76:79], v[176:179]
    v_exp_f32 v255, v139
    v_mfma_f32_16x16x32_bf16 v[164:167], a[160:163], v[80:83], v[232:235]
    ds_read_b64_tr_b16 a[220:221], v21 offset:768
    v_cvt_pk_bf16_f32 v191, v254, v255
    v_mfma_f32_16x16x32_bf16 v[164:167], a[164:167], v[84:87], v[164:167]
    v_exp_f32 v240, v120
    v_mfma_f32_16x16x32_bf16 v[164:167], a[168:171], v[88:91], v[164:167]
    ds_read_b64_tr_b16 a[222:223], v21 offset:4864
    v_mfma_f32_16x16x32_bf16 v[164:167], a[172:175], v[92:95], v[164:167]
    v_exp_f32 v241, v121
    v_mfma_f32_16x16x32_bf16 v[180:183], a[176:179], v[80:83], v[232:235]
    v_exp_f32 v242, v122
    v_mfma_f32_16x16x32_bf16 v[180:183], a[180:183], v[84:87], v[180:183]
    v_cvt_pk_bf16_f32 v192, v240, v241
    v_or3_b32 v22, v191, v192, v22
    v_mfma_f32_16x16x32_bf16 v[180:183], a[184:187], v[88:91], v[180:183]
    v_exp_f32 v243, v123
    v_mfma_f32_16x16x32_bf16 v[180:183], a[188:191], v[92:95], v[180:183]
    v_exp_f32 v244, v140
    v_mfma_f32_16x16x32_bf16 a[224:227], a[244:247], v[204:207], a[224:227]
    v_exp_f32 v245, v141
    v_mfma_f32_16x16x32_bf16 a[228:231], a[244:247], v[208:211], a[228:231]
    v_exp_f32 v246, v142
    v_mfma_f32_16x16x32_bf16 a[232:235], a[244:247], v[212:215], a[232:235]
    v_cvt_pk_bf16_f32 v193, v242, v243
    v_cvt_pk_bf16_f32 v194, v244, v245
    v_mfma_f32_16x16x32_bf16 a[236:239], a[244:247], v[216:219], a[236:239]
    s_waitcnt vmcnt(16) lgkmcnt(0)
    s_barrier
    v_mfma_f32_16x16x32_bf16 a[96:99], a[192:195], v[216:219], a[96:99]
    v_exp_f32 v247, v143
    v_mfma_f32_16x16x32_bf16 a[64:67], a[192:195], v[212:215], a[64:67]
    ds_read_b128 a[160:163], v14 offset:0
    v_or3_b32 v22, v193, v194, v22
    v_mfma_f32_16x16x32_bf16 a[32:35], a[192:195], v[208:211], a[32:35]
    v_exp_f32 v248, v124
    v_mfma_f32_16x16x32_bf16 a[0:3], a[192:195], v[204:207], a[0:3]
    v_exp_f32 v249, v125
    v_mfma_f32_16x16x32_bf16 a[4:7], a[196:199], v[204:207], a[4:7]
    ds_read_b128 a[164:167], v14 offset:256
    v_cvt_pk_bf16_f32 v195, v246, v247
    v_mfma_f32_16x16x32_bf16 a[36:39], a[196:199], v[208:211], a[36:39]
    v_exp_f32 v250, v126
    v_mfma_f32_16x16x32_bf16 a[68:71], a[196:199], v[212:215], a[68:71]
    v_cvt_pk_bf16_f32 v196, v248, v249
    v_or3_b32 v22, v195, v196, v22
    v_mfma_f32_16x16x32_bf16 a[100:103], a[196:199], v[216:219], a[100:103]
    ds_read_b128 a[168:171], v15 offset:0
    v_mfma_f32_16x16x32_bf16 a[104:107], a[200:203], v[216:219], a[104:107]
    v_exp_f32 v251, v127
    v_mfma_f32_16x16x32_bf16 a[72:75], a[200:203], v[212:215], a[72:75]
    v_exp_f32 v252, v144
    v_mfma_f32_16x16x32_bf16 a[40:43], a[200:203], v[208:211], a[40:43]
    ds_read_b128 a[172:175], v15 offset:256
    v_cvt_pk_bf16_f32 v197, v250, v251
    v_mfma_f32_16x16x32_bf16 a[8:11], a[200:203], v[204:207], a[8:11]
    v_exp_f32 v253, v145
    v_mfma_f32_16x16x32_bf16 a[12:15], a[204:207], v[204:207], a[12:15]
    v_exp_f32 v254, v146
    v_mfma_f32_16x16x32_bf16 a[44:47], a[204:207], v[208:211], a[44:47]
    ds_read_b128 a[176:179], v14 offset:4096
    v_cvt_pk_bf16_f32 v198, v252, v253
    v_mfma_f32_16x16x32_bf16 a[76:79], a[204:207], v[212:215], a[76:79]
    v_or3_b32 v22, v197, v198, v22
    v_mfma_f32_16x16x32_bf16 a[108:111], a[204:207], v[216:219], a[108:111]
    v_exp_f32 v255, v147
    v_mfma_f32_16x16x32_bf16 a[112:115], a[208:211], v[216:219], a[112:115]
    ds_read_b128 a[180:183], v14 offset:4352
    v_cvt_pk_bf16_f32 v199, v254, v255
    v_mfma_f32_16x16x32_bf16 a[80:83], a[208:211], v[212:215], a[80:83]
    v_exp_f32 v240, v128
    v_mfma_f32_16x16x32_bf16 a[48:51], a[208:211], v[208:211], a[48:51]
    v_exp_f32 v241, v129
    v_mfma_f32_16x16x32_bf16 a[16:19], a[208:211], v[204:207], a[16:19]
    ds_read_b128 a[184:187], v15 offset:4096
    v_cvt_pk_bf16_f32 v200, v240, v241
    v_mfma_f32_16x16x32_bf16 a[20:23], a[212:215], v[204:207], a[20:23]
    v_exp_f32 v242, v130
    v_mfma_f32_16x16x32_bf16 a[52:55], a[212:215], v[208:211], a[52:55]
    v_or3_b32 v22, v199, v200, v22
    v_mfma_f32_16x16x32_bf16 a[84:87], a[212:215], v[212:215], a[84:87]
    ds_read_b128 a[188:191], v15 offset:4352
    v_mfma_f32_16x16x32_bf16 a[116:119], a[212:215], v[216:219], a[116:119]
    v_exp_f32 v243, v131
    v_mfma_f32_16x16x32_bf16 a[120:123], a[216:219], v[216:219], a[120:123]
    v_exp_f32 v244, v148
    v_mfma_f32_16x16x32_bf16 a[88:91], a[216:219], v[212:215], a[88:91]
    v_exp_f32 v245, v149
    v_mfma_f32_16x16x32_bf16 a[56:59], a[216:219], v[208:211], a[56:59]
    v_exp_f32 v246, v150
    v_mfma_f32_16x16x32_bf16 a[24:27], a[216:219], v[204:207], a[24:27]
    v_exp_f32 v247, v151
    v_mfma_f32_16x16x32_bf16 a[28:31], a[220:223], v[204:207], a[28:31]
    v_cvt_pk_bf16_f32 v201, v242, v243
    v_cvt_pk_bf16_f32 v202, v244, v245
    v_mfma_f32_16x16x32_bf16 a[60:63], a[220:223], v[208:211], a[60:63]
    v_or3_b32 v22, v201, v202, v22
    v_cvt_pk_bf16_f32 v203, v246, v247
    v_mfma_f32_16x16x32_bf16 a[92:95], a[220:223], v[212:215], a[92:95]
    v_or_b32 v22, v203, v22
    v_and_b32 v23, 0x40004000, v22
    v_cmp_ne_u32 vcc, 0, v23
    v_mfma_f32_16x16x32_bf16 a[124:127], a[220:223], v[216:219], a[124:127]
    s_waitcnt vmcnt(8) lgkmcnt(0)
    s_barrier
    s_cbranch_vccnz L_tramp3
L_back3:
    s_sub_u32 s32, s32, 1
    s_cmp_lg_u32 s32, 0
    s_cbranch_scc1 L_aloop
    s_getpc_b64 s[52:53]
L_pc3:
    s_lshr_b32 s54, s2, 3
    s_lshl_b32 s54, s54, 9
    s_lshl_b32 s55, s3, 7
    s_add_u32 s54, s54, s55
    s_add_u32 s54, s54, L_w4-L_pc3
    s_min_u32 s54, s54, L_code_end-L_pc3-4
    v_mov_b32 v28, s54
    s_mov_b64 exec, 1
    global_load_dword v1, v28, s[52:53]
    s_mov_b64 exec, -1
    v_exp_f32 v240, v152
    v_exp_f32 v241, v153
    v_exp_f32 v242, v154
    v_cvt_pk_bf16_f32 v204, v240, v241
    v_exp_f32 v243, v155
    v_exp_f32 v244, v168
    v_cvt_pk_bf16_f32 v205, v242, v243
    v_exp_f32 v245, v169
    v_exp_f32 v246, v170
    v_cvt_pk_bf16_f32 v206, v244, v245
    v_exp_f32 v247, v171
    v_exp_f32 v248, v156
    v_cvt_pk_bf16_f32 v207, v246, v247
    v_exp_f32 v249, v157
    v_exp_f32 v250, v158
    v_cvt_pk_bf16_f32 v208, v248, v249
    v_exp_f32 v251, v159
    v_exp_f32 v252, v172
    v_cvt_pk_bf16_f32 v209, v250, v251
    v_exp_f32 v253, v173
    v_exp_f32 v254, v174
    v_cvt_pk_bf16_f32 v210, v252, v253
    v_exp_f32 v255, v175
    v_exp_f32 v240, v160
    v_cvt_pk_bf16_f32 v211, v254, v255
    v_exp_f32 v241, v161
    v_exp_f32 v242, v162
    v_cvt_pk_bf16_f32 v212, v240, v241
    v_exp_f32 v243, v163
    v_exp_f32 v244, v176
    v_cvt_pk_bf16_f32 v213, v242, v243
    v_exp_f32 v245, v177
    v_exp_f32 v246, v178
    v_cvt_pk_bf16_f32 v214, v244, v245
    v_exp_f32 v247, v179
    v_exp_f32 v248, v164
    v_cvt_pk_bf16_f32 v215, v246, v247
    v_exp_f32 v249, v165
    v_exp_f32 v250, v166
    v_cvt_pk_bf16_f32 v216, v248, v249
    v_exp_f32 v251, v167
    v_exp_f32 v252, v180
    v_cvt_pk_bf16_f32 v217, v250, v251
    v_exp_f32 v253, v181
    v_exp_f32 v254, v182
    v_cvt_pk_bf16_f32 v218, v252, v253
    v_exp_f32 v255, v183
    s_nop 0
    v_cvt_pk_bf16_f32 v219, v254, v255
    v_or3_b32 v22, v204, v205, v206
    v_or3_b32 v22, v207, v208, v22
    v_or3_b32 v22, v209, v210, v22
    v_or3_b32 v22, v211, v212, v22
    v_or3_b32 v22, v213, v214, v22
    v_or3_b32 v22, v215, v216, v22
    v_or3_b32 v22, v217, v218, v22
    v_or_b32 v22, v219, v22
    v_and_b32 v23, 0x40004000, v22
    v_cmp_ne_u32 vcc, 0, v23
    v_mfma_f32_16x16x32_bf16 v[112:115], a[160:163], v[32:35], v[220:223]
    ds_read_b64_tr_b16 a[192:193], v18 offset:0
    v_add_u32 v20, s43, v20
    v_mfma_f32_16x16x32_bf16 v[112:115], a[164:167], v[36:39], v[112:115]
    s_add_u32 m0, s38, 0
    v_add_u32 v21, s43, v21
    v_add_u32 v14, s39, v14
    v_mfma_f32_16x16x32_bf16 v[112:115], a[168:171], v[40:43], v[112:115]
    buffer_load_dwordx4 v4, s[20:23], s36 offen offset:0 nt lds
    v_mfma_f32_16x16x32_bf16 v[112:115], a[172:175], v[44:47], v[112:115]
    ds_read_b64_tr_b16 a[194:195], v18 offset:4096
    v_add_u32 v15, s39, v15
    v_mfma_f32_16x16x32_bf16 v[132:135], a[176:179], v[32:35], v[220:223]
    v_mfma_f32_16x16x32_bf16 v[132:135], a[180:183], v[36:39], v[132:135]
    ds_read_b64_tr_b16 a[196:197], v19 offset:0
    v_mfma_f32_16x16x32_bf16 v[132:135], a[184:187], v[40:43], v[132:135]
    v_mfma_f32_16x16x32_bf16 v[132:135], a[188:191], v[44:47], v[132:135]
    buffer_load_dwordx4 v5, s[20:23], s36 offen offset:1024 nt lds
    v_mfma_f32_16x16x32_bf16 v[116:119], a[160:163], v[48:51], v[224:227]
    ds_read_b64_tr_b16 a[198:199], v19 offset:4096
    v_mfma_f32_16x16x32_bf16 v[116:119], a[164:167], v[52:55], v[116:119]
    v_mfma_f32_16x16x32_bf16 v[116:119], a[168:171], v[56:59], v[116:119]
    ds_read_b64_tr_b16 a[200:201], v18 offset:256
    v_mfma_f32_16x16x32_bf16 v[116:119], a[172:175], v[60:63], v[116:119]
    v_mfma_f32_16x16x32_bf16 v[136:139], a[176:179], v[48:51], v[224:227]
    buffer_load_dwordx4 v4, s[20:23], s36 offen offset:2048 nt lds
    v_mfma_f32_16x16x32_bf16 v[136:139], a[180:183], v[52:55], v[136:139]
    ds_read_b64_tr_b16 a[202:203], v18 offset:4352
    v_mfma_f32_16x16x32_bf16 v[136:139], a[184:187], v[56:59], v[136:139]
    v_mfma_f32_16x16x32_bf16 v[136:139], a[188:191], v[60:63], v[136:139]
    ds_read_b64_tr_b16 a[204:205], v19 offset:256
    v_mfma_f32_16x16x32_bf16 v[120:123], a[160:163], v[64:67], v[228:231]
    v_mfma_f32_16x16x32_bf16 v[120:123], a[164:167], v[68:71], v[120:123]
    buffer_load_dwordx4 v5, s[20:23], s36 offen offset:3072 nt lds
    v_mfma_f32_16x16x32_bf16 v[120:123], a[168:171], v[72:75], v[120:123]
    ds_read_b64_tr_b16 a[206:207], v19 offset:4352
    v_mfma_f32_16x16x32_bf16 v[120:123], a[172:175], v[76:79], v[120:123]
    v_mfma_f32_16x16x32_bf16 v[140:143], a[176:179], v[64:67], v[228:231]
    s_add_u32 s96, s36, 131072
    ds_read_b64_tr_b16 a[208:209], v18 offset:512
    v_mfma_f32_16x16x32_bf16 v[140:143], a[180:183], v[68:71], v[140:143]
    s_add_u32 m0, s38, 16384
    v_mfma_f32_16x16x32_bf16 v[140:143], a[184:187], v[72:75], v[140:143]
    buffer_load_dwordx4 v4, s[20:23], s96 offen offset:0 nt lds
    v_mfma_f32_16x16x32_bf16 v[140:143], a[188:191], v[76:79], v[140:143]
    ds_read_b64_tr_b16 a[210:211], v18 offset:4608
    v_mfma_f32_16x16x32_bf16 v[124:127], a[160:163], v[80:83], v[232:235]
    v_mfma_f32_16x16x32_bf16 v[124:127], a[164:167], v[84:87], v[124:127]
    ds_read_b64_tr_b16 a[212:213], v19 offset:512
    v_mfma_f32_16x16x32_bf16 v[124:127], a[168:171], v[88:91], v[124:127]
    v_mfma_f32_16x16x32_bf16 v[124:127], a[172:175], v[92:95], v[124:127]
    buffer_load_dwordx4 v5, s[20:23], s96 offen offset:1024 nt lds
    v_mfma_f32_16x16x32_bf16 v[144:147], a[176:179], v[80:83], v[232:235]
    ds_read_b64_tr_b16 a[214:215], v19 offset:4608
    v_mfma_f32_16x16x32_bf16 v[144:147], a[180:183], v[84:87], v[144:147]
    v_mfma_f32_16x16x32_bf16 v[144:147], a[184:187], v[88:91], v[144:147]
    ds_read_b64_tr_b16 a[216:217], v18 offset:768
    v_mfma_f32_16x16x32_bf16 v[144:147], a[188:191], v[92:95], v[144:147]
    v_mfma_f32_16x16x32_bf16 v[128:131], a[160:163], v[96:99], v[236:239]
    buffer_load_dwordx4 v4, s[20:23], s96 offen offset:2048 nt lds
    v_mfma_f32_16x16x32_bf16 v[128:131], a[164:167], v[100:103], v[128:131]
    ds_read_b64_tr_b16 a[218:219], v18 offset:4864
    v_mfma_f32_16x16x32_bf16 v[128:131], a[168:171], v[104:107], v[128:131]
    v_mfma_f32_16x16x32_bf16 v[128:131], a[172:175], v[108:111], v[128:131]
    ds_read_b64_tr_b16 a[220:221], v19 offset:768
    v_mfma_f32_16x16x32_bf16 v[148:151], a[176:179], v[96:99], v[236:239]
    v_mfma_f32_16x16x32_bf16 v[148:151], a[180:183], v[100:103], v[148:151]
    buffer_load_dwordx4 v5, s[20:23], s96 offen offset:3072 nt lds
    v_mfma_f32_16x16x32_bf16 v[148:151], a[184:187], v[104:107], v[148:151]
    ds_read_b64_tr_b16 a[222:223], v19 offset:4864
    v_add_u32 v18, s40, v18
    v_mfma_f32_16x16x32_bf16 v[148:151], a[188:191], v[108:111], v[148:151]
    v_add_u32 v19, s40, v19
    v_mfma_f32_16x16x32_bf16 a[224:227], a[244:247], v[184:187], a[224:227]
    v_mfma_f32_16x16x32_bf16 a[228:231], a[244:247], v[188:191], a[228:231]
    s_mov_b32 s97, 114688
    v_mfma_f32_16x16x32_bf16 a[232:235], a[244:247], v[192:195], a[232:235]
    s_add_u32 m0, s6, 65536
    v_mfma_f32_16x16x32_bf16 a[236:239], a[244:247], v[196:199], a[236:239]
    buffer_load_dwordx4 v4, s[20:23], s97 offen offset:0 nt lds
    v_mfma_f32_16x16x32_bf16 a[240:243], a[244:247], v[200:203], a[240:243]
    s_waitcnt lgkmcnt(0)
    v_mfma_f32_16x16x32_bf16 a[128:131], a[192:195], v[200:203], a[128:131]
    ds_read_b128 a[160:163], v16 offset:0
    v_mfma_f32_16x16x32_bf16 a[96:99], a[192:195], v[196:199], a[96:99]
    v_mfma_f32_16x16x32_bf16 a[64:67], a[192:195], v[192:195], a[64:67]
    buffer_load_dwordx4 v5, s[20:23], s97 offen offset:1024 nt lds
    v_mfma_f32_16x16x32_bf16 a[32:35], a[192:195], v[188:191], a[32:35]
    v_mfma_f32_16x16x32_bf16 a[0:3], a[192:195], v[184:187], a[0:3]
    ds_read_b128 a[164:167], v16 offset:256
    v_mfma_f32_16x16x32_bf16 a[4:7], a[196:199], v[184:187], a[4:7]
    v_mfma_f32_16x16x32_bf16 a[36:39], a[196:199], v[188:191], a[36:39]
    buffer_load_dwordx4 v4, s[20:23], s97 offen offset:2048 nt lds
    v_mfma_f32_16x16x32_bf16 a[68:71], a[196:199], v[192:195], a[68:71]
    v_mfma_f32_16x16x32_bf16 a[100:103], a[196:199], v[196:199], a[100:103]
    ds_read_b128 a[168:171], v17 offset:0
    v_mfma_f32_16x16x32_bf16 a[132:135], a[196:199], v[200:203], a[132:135]
    v_mfma_f32_16x16x32_bf16 a[136:139], a[200:203], v[200:203], a[136:139]
    buffer_load_dwordx4 v5, s[20:23], s97 offen offset:3072 nt lds
    v_mfma_f32_16x16x32_bf16 a[104:107], a[200:203], v[196:199], a[104:107]
    v_mfma_f32_16x16x32_bf16 a[72:75], a[200:203], v[192:195], a[72:75]
    s_mov_b32 s90, 245760
    ds_read_b128 a[172:175], v17 offset:256
    v_mfma_f32_16x16x32_bf16 a[40:43], a[200:203], v[188:191], a[40:43]
    s_add_u32 m0, s6, 81920
    v_mfma_f32_16x16x32_bf16 a[8:11], a[200:203], v[184:187], a[8:11]
    buffer_load_dwordx4 v4, s[20:23], s90 offen offset:0 nt lds
    v_mfma_f32_16x16x32_bf16 a[12:15], a[204:207], v[184:187], a[12:15]
    v_mfma_f32_16x16x32_bf16 a[44:47], a[204:207], v[188:191], a[44:47]
    ds_read_b128 a[176:179], v16 offset:4096
    v_mfma_f32_16x16x32_bf16 a[76:79], a[204:207], v[192:195], a[76:79]
    v_mfma_f32_16x16x32_bf16 a[108:111], a[204:207], v[196:199], a[108:111]
    buffer_load_dwordx4 v5, s[20:23], s90 offen offset:1024 nt lds
    v_mfma_f32_16x16x32_bf16 a[140:143], a[204:207], v[200:203], a[140:143]
    v_mfma_f32_16x16x32_bf16 a[144:147], a[208:211], v[200:203], a[144:147]
    ds_read_b128 a[180:183], v16 offset:4352
    v_mfma_f32_16x16x32_bf16 a[112:115], a[208:211], v[196:199], a[112:115]
    v_mfma_f32_16x16x32_bf16 a[80:83], a[208:211], v[192:195], a[80:83]
    buffer_load_dwordx4 v4, s[20:23], s90 offen offset:2048 nt lds
    v_mfma_f32_16x16x32_bf16 a[48:51], a[208:211], v[188:191], a[48:51]
    v_mfma_f32_16x16x32_bf16 a[16:19], a[208:211], v[184:187], a[16:19]
    ds_read_b128 a[184:187], v17 offset:4096
    v_mfma_f32_16x16x32_bf16 a[20:23], a[212:215], v[184:187], a[20:23]
    v_mfma_f32_16x16x32_bf16 a[52:55], a[212:215], v[188:191], a[52:55]
    buffer_load_dwordx4 v5, s[20:23], s90 offen offset:3072 nt lds
    v_mfma_f32_16x16x32_bf16 a[84:87], a[212:215], v[192:195], a[84:87]
    s_add_u32 s38, s41, s6
    s_add_u32 s37, s42, s6
    s_add_u32 s41, s41, s39
    v_mfma_f32_16x16x32_bf16 a[116:119], a[212:215], v[196:199], a[116:119]
    s_add_u32 s42, s42, s40
    ds_read_b128 a[188:191], v17 offset:4352
    v_add_u32 v16, s39, v16
    v_mfma_f32_16x16x32_bf16 a[148:151], a[212:215], v[200:203], a[148:151]
    s_add_u32 s36, s36, 16384
    v_add_u32 v17, s39, v17
    v_mfma_f32_16x16x32_bf16 a[152:155], a[216:219], v[200:203], a[152:155]
    s_add_u32 s35, s35, 16384
    v_mfma_f32_16x16x32_bf16 a[120:123], a[216:219], v[196:199], a[120:123]
    s_mov_b32 s43, s40
    s_cmp_ge_u32 s41, 98304
    s_cselect_b32 s39, 4294868992, s45
    v_mfma_f32_16x16x32_bf16 a[88:91], a[216:219], v[192:195], a[88:91]
    s_cmp_ge_u32 s42, 98304
    s_cselect_b32 s40, 4294868992, s45
    v_mfma_f32_16x16x32_bf16 a[56:59], a[216:219], v[188:191], a[56:59]
    v_exp_f32 v240, v112
    v_mfma_f32_16x16x32_bf16 a[24:27], a[216:219], v[184:187], a[24:27]
    v_exp_f32 v241, v113
    v_mfma_f32_16x16x32_bf16 a[28:31], a[220:223], v[184:187], a[28:31]
    v_exp_f32 v242, v114
    v_mfma_f32_16x16x32_bf16 a[60:63], a[220:223], v[188:191], a[60:63]
    v_exp_f32 v243, v115
    v_mfma_f32_16x16x32_bf16 a[92:95], a[220:223], v[192:195], a[92:95]
    v_exp_f32 v244, v132
    v_mfma_f32_16x16x32_bf16 a[124:127], a[220:223], v[196:199], a[124:127]
    v_exp_f32 v245, v133
    v_mfma_f32_16x16x32_bf16 a[156:159], a[220:223], v[200:203], a[156:159]
    s_waitcnt lgkmcnt(0)
    s_cbranch_vccnz L_tramp4
L_back4:
    v_mfma_f32_16x16x32_bf16 v[152:155], a[160:163], v[32:35], v[220:223]
    ds_read_b64_tr_b16 a[192:193], v20 offset:0
    v_cvt_pk_bf16_f32 v184, v240, v241
    v_mfma_f32_16x16x32_bf16 v[152:155], a[164:167], v[36:39], v[152:155]
    ds_read_b64_tr_b16 a[194:195], v20 offset:4096
    v_cvt_pk_bf16_f32 v185, v242, v243
    v_mfma_f32_16x16x32_bf16 v[152:155], a[168:171], v[40:43], v[152:155]
    v_exp_f32 v246, v134
    v_mfma_f32_16x16x32_bf16 v[152:155], a[172:175], v[44:47], v[152:155]
    ds_read_b64_tr_b16 a[196:197], v21 offset:0
    v_cvt_pk_bf16_f32 v186, v244, v245
    v_mfma_f32_16x16x32_bf16 v[168:171], a[176:179], v[32:35], v[220:223]
    v_exp_f32 v247, v135
    v_mfma_f32_16x16x32_bf16 v[168:171], a[180:183], v[36:39], v[168:171]
    ds_read_b64_tr_b16 a[198:199], v21 offset:4096
    v_or3_b32 v22, v184, v185, v186
    v_mfma_f32_16x16x32_bf16 v[168:171], a[184:187], v[40:43], v[168:171]
    v_exp_f32 v248, v116
    v_mfma_f32_16x16x32_bf16 v[168:171], a[188:191], v[44:47], v[168:171]
    ds_read_b64_tr_b16 a[200:201], v20 offset:256
    v_cvt_pk_bf16_f32 v187, v246, v247
    v_mfma_f32_16x16x32_bf16 v[156:159], a[160:163], v[48:51], v[224:227]
    ds_read_b64_tr_b16 a[202:203], v20 offset:4352
    v_mfma_f32_16x16x32_bf16 v[156:159], a[164:167], v[52:55], v[156:159]
    v_exp_f32 v249, v117
    v_mfma_f32_16x16x32_bf16 v[156:159], a[168:171], v[56:59], v[156:159]
    ds_read_b64_tr_b16 a[204:205], v21 offset:256
    v_cvt_pk_bf16_f32 v188, v248, v249
    v_mfma_f32_16x16x32_bf16 v[156:159], a[172:175], v[60:63], v[156:159]
    v_exp_f32 v250, v118
    v_mfma_f32_16x16x32_bf16 v[172:175], a[176:179], v[48:51], v[224:227]
    ds_read_b64_tr_b16 a[206:207], v21 offset:4352
    v_or3_b32 v22, v187, v188, v22
    v_mfma_f32_16x16x32_bf16 v[172:175], a[180:183], v[52:55], v[172:175]
    v_exp_f32 v251, v119
    v_mfma_f32_16x16x32_bf16 v[172:175], a[184:187], v[56:59], v[172:175]
    ds_read_b64_tr_b16 a[208:209], v20 offset:512
    v_cvt_pk_bf16_f32 v189, v250, v251
    v_mfma_f32_16x16x32_bf16 v[172:175], a[188:191], v[60:63], v[172:175]
    ds_read_b64_tr_b16 a[210:211], v20 offset:4608
    v_mfma_f32_16x16x32_bf16 v[160:163], a[160:163], v[64:67], v[228:231]
    v_exp_f32 v252, v136
    v_mfma_f32_16x16x32_bf16 v[160:163], a[164:167], v[68:71], v[160:163]
    ds_read_b64_tr_b16 a[212:213], v21 offset:512
    v_mfma_f32_16x16x32_bf16 v[160:163], a[168:171], v[72:75], v[160:163]
    v_exp_f32 v253, v137
    v_mfma_f32_16x16x32_bf16 v[160:163], a[172:175], v[76:79], v[160:163]
    ds_read_b64_tr_b16 a[214:215], v21 offset:4608
    v_cvt_pk_bf16_f32 v190, v252, v253
    v_mfma_f32_16x16x32_bf16 v[176:179], a[176:179], v[64:67], v[228:231]
    v_exp_f32 v254, v138
    v_mfma_f32_16x16x32_bf16 v[176:179], a[180:183], v[68:71], v[176:179]
    ds_read_b64_tr_b16 a[216:217], v20 offset:768
    v_or3_b32 v22, v189, v190, v22
    v_mfma_f32_16x16x32_bf16 v[176:179], a[184:187], v[72:75], v[176:179]
    ds_read_b64_tr_b16 a[218:219], v20 offset:4864
    v_mfma_f32_16x16x32_bf16 v[176:179], a[188:191], v[76:79], v[176:179]
    v_exp_f32 v255, v139
    v_mfma_f32_16x16x32_bf16 v[164:167], a[160:163], v[80:83], v[232:235]
    ds_read_b64_tr_b16 a[220:221], v21 offset:768
    v_cvt_pk_bf16_f32 v191, v254, v255
    v_mfma_f32_16x16x32_bf16 v[164:167], a[164:167], v[84:87], v[164:167]
    v_exp_f32 v240, v120
    v_mfma_f32_16x16x32_bf16 v[164:167], a[168:171], v[88:91], v[164:167]
    ds_read_b64_tr_b16 a[222:223], v21 offset:4864
    v_mfma_f32_16x16x32_bf16 v[164:167], a[172:175], v[92:95], v[164:167]
    v_exp_f32 v241, v121
    v_mfma_f32_16x16x32_bf16 v[180:183], a[176:179], v[80:83], v[232:235]
    v_exp_f32 v242, v122
    v_mfma_f32_16x16x32_bf16 v[180:183], a[180:183], v[84:87], v[180:183]
    v_cvt_pk_bf16_f32 v192, v240, v241
    v_or3_b32 v22, v191, v192, v22
    v_mfma_f32_16x16x32_bf16 v[180:183], a[184:187], v[88:91], v[180:183]
    v_exp_f32 v243, v123
    v_mfma_f32_16x16x32_bf16 v[180:183], a[188:191], v[92:95], v[180:183]
    v_exp_f32 v244, v140
    v_mfma_f32_16x16x32_bf16 a[224:227], a[244:247], v[204:207], a[224:227]
    v_exp_f32 v245, v141
    v_mfma_f32_16x16x32_bf16 a[228:231], a[244:247], v[208:211], a[228:231]
    v_exp_f32 v246, v142
    v_mfma_f32_16x16x32_bf16 a[232:235], a[244:247], v[212:215], a[232:235]
    v_cvt_pk_bf16_f32 v193, v242, v243
    v_cvt_pk_bf16_f32 v194, v244, v245
    v_mfma_f32_16x16x32_bf16 a[236:239], a[244:247], v[216:219], a[236:239]
    s_waitcnt vmcnt(16) lgkmcnt(0)
    s_barrier
    v_mfma_f32_16x16x32_bf16 a[96:99], a[192:195], v[216:219], a[96:99]
    v_exp_f32 v247, v143
    v_mfma_f32_16x16x32_bf16 a[64:67], a[192:195], v[212:215], a[64:67]
    ds_read_b128 a[160:163], v14 offset:0
    v_or3_b32 v22, v193, v194, v22
    v_mfma_f32_16x16x32_bf16 a[32:35], a[192:195], v[208:211], a[32:35]
    v_exp_f32 v248, v124
    v_mfma_f32_16x16x32_bf16 a[0:3], a[192:195], v[204:207], a[0:3]
    v_exp_f32 v249, v125
    v_mfma_f32_16x16x32_bf16 a[4:7], a[196:199], v[204:207], a[4:7]
    ds_read_b128 a[164:167], v14 offset:256
    v_cvt_pk_bf16_f32 v195, v246, v247
    v_mfma_f32_16x16x32_bf16 a[36:39], a[196:199], v[208:211], a[36:39]
    v_exp_f32 v250, v126
    v_mfma_f32_16x16x32_bf16 a[68:71], a[196:199], v[212:215], a[68:71]
    v_cvt_pk_bf16_f32 v196, v248, v249
    v_or3_b32 v22, v195, v196, v22
    v_mfma_f32_16x16x32_bf16 a[100:103], a[196:199], v[216:219], a[100:103]
    ds_read_b128 a[168:171], v15 offset:0
    v_mfma_f32_16x16x32_bf16 a[104:107], a[200:203], v[216:219], a[104:107]
    v_exp_f32 v251, v127
    v_mfma_f32_16x16x32_bf16 a[72:75], a[200:203], v[212:215], a[72:75]
    v_exp_f32 v252, v144
    v_mfma_f32_16x16x32_bf16 a[40:43], a[200:203], v[208:211], a[40:43]
    ds_read_b128 a[172:175], v15 offset:256
    v_cvt_pk_bf16_f32 v197, v250, v251
    v_mfma_f32_16x16x32_bf16 a[8:11], a[200:203], v[204:207], a[8:11]
    v_exp_f32 v253, v145
    v_mfma_f32_16x16x32_bf16 a[12:15], a[204:207], v[204:207], a[12:15]
    v_exp_f32 v254, v146
    v_mfma_f32_16x16x32_bf16 a[44:47], a[204:207], v[208:211], a[44:47]
    ds_read_b128 a[176:179], v14 offset:4096
    v_cvt_pk_bf16_f32 v198, v252, v253
    v_mfma_f32_16x16x32_bf16 a[76:79], a[204:207], v[212:215], a[76:79]
    v_or3_b32 v22, v197, v198, v22
    v_mfma_f32_16x16x32_bf16 a[108:111], a[204:207], v[216:219], a[108:111]
    v_exp_f32 v255, v147
    v_mfma_f32_16x16x32_bf16 a[112:115], a[208:211], v[216:219], a[112:115]
    ds_read_b128 a[180:183], v14 offset:4352
    v_cvt_pk_bf16_f32 v199, v254, v255
    v_mfma_f32_16x16x32_bf16 a[80:83], a[208:211], v[212:215], a[80:83]
    v_exp_f32 v240, v128
    v_mfma_f32_16x16x32_bf16 a[48:51], a[208:211], v[208:211], a[48:51]
    v_exp_f32 v241, v129
    v_mfma_f32_16x16x32_bf16 a[16:19], a[208:211], v[204:207], a[16:19]
    ds_read_b128 a[184:187], v15 offset:4096
    v_cvt_pk_bf16_f32 v200, v240, v241
    v_mfma_f32_16x16x32_bf16 a[20:23], a[212:215], v[204:207], a[20:23]
    v_exp_f32 v242, v130
    v_mfma_f32_16x16x32_bf16 a[52:55], a[212:215], v[208:211], a[52:55]
    v_or3_b32 v22, v199, v200, v22
    v_mfma_f32_16x16x32_bf16 a[84:87], a[212:215], v[212:215], a[84:87]
    ds_read_b128 a[188:191], v15 offset:4352
    v_mfma_f32_16x16x32_bf16 a[116:119], a[212:215], v[216:219], a[116:119]
    v_exp_f32 v243, v131
    v_mfma_f32_16x16x32_bf16 a[120:123], a[216:219], v[216:219], a[120:123]
    v_exp_f32 v244, v148
    v_mfma_f32_16x16x32_bf16 a[88:91], a[216:219], v[212:215], a[88:91]
    v_exp_f32 v245, v149
    v_mfma_f32_16x16x32_bf16 a[56:59], a[216:219], v[208:211], a[56:59]
    v_exp_f32 v246, v150
    v_mfma_f32_16x16x32_bf16 a[24:27], a[216:219], v[204:207], a[24:27]
    v_exp_f32 v247, v151
    v_mfma_f32_16x16x32_bf16 a[28:31], a[220:223], v[204:207], a[28:31]
    v_cvt_pk_bf16_f32 v201, v242, v243
    v_cvt_pk_bf16_f32 v202, v244, v245
    v_mfma_f32_16x16x32_bf16 a[60:63], a[220:223], v[208:211], a[60:63]
    v_or3_b32 v22, v201, v202, v22
    v_cvt_pk_bf16_f32 v203, v246, v247
    v_mfma_f32_16x16x32_bf16 a[92:95], a[220:223], v[212:215], a[92:95]
    v_or_b32 v22, v203, v22
    v_and_b32 v23, 0x40004000, v22
    v_cmp_ne_u32 vcc, 0, v23
    v_mfma_f32_16x16x32_bf16 a[124:127], a[220:223], v[216:219], a[124:127]
    s_waitcnt vmcnt(8) lgkmcnt(0)
    s_barrier
    s_cbranch_vccnz L_tramp5
L_back5:
L_w4:
    v_mfma_f32_16x16x32_bf16 v[112:115], a[160:163], v[32:35], v[220:223]
    ds_read_b64_tr_b16 a[192:193], v18 offset:0
    v_add_u32 v20, s43, v20
    v_mfma_f32_16x16x32_bf16 v[112:115], a[164:167], v[36:39], v[112:115]
    s_add_u32 m0, s6, 98304
    v_exp_f32 v240, v152
    v_mfma_f32_16x16x32_bf16 v[112:115], a[168:171], v[40:43], v[112:115]
    buffer_load_dwordx4 v9, s[12:15], s28 offen offset:0 lds
    v_mfma_f32_16x16x32_bf16 v[112:115], a[172:175], v[44:47], v[112:115]
    ds_read_b64_tr_b16 a[194:195], v18 offset:4096
    v_add_u32 v21, s43, v21
    v_mfma_f32_16x16x32_bf16 v[132:135], a[176:179], v[32:35], v[220:223]
    v_exp_f32 v241, v153
    v_mfma_f32_16x16x32_bf16 v[132:135], a[180:183], v[36:39], v[132:135]
    ds_read_b64_tr_b16 a[196:197], v19 offset:0
    v_cvt_pk_bf16_f32 v204, v240, v241
    v_mfma_f32_16x16x32_bf16 v[132:135], a[184:187], v[40:43], v[132:135]
    s_add_u32 s91, s28, 7168
    v_exp_f32 v242, v154
    v_mfma_f32_16x16x32_bf16 v[132:135], a[188:191], v[44:47], v[132:135]
    buffer_load_dwordx4 v10, s[12:15], s91 offen offset:1024 lds
    v_mfma_f32_16x16x32_bf16 v[116:119], a[160:163], v[48:51], v[224:227]
    ds_read_b64_tr_b16 a[198:199], v19 offset:4096
    v_mfma_f32_16x16x32_bf16 v[116:119], a[164:167], v[52:55], v[116:119]
    v_exp_f32 v243, v155
    v_mfma_f32_16x16x32_bf16 v[116:119], a[168:171], v[56:59], v[116:119]
    ds_read_b64_tr_b16 a[200:201], v18 offset:256
    v_cvt_pk_bf16_f32 v205, v242, v243
    v_mfma_f32_16x16x32_bf16 v[116:119], a[172:175], v[60:63], v[116:119]
    s_add_u32 s92, s28, 14336
    v_exp_f32 v244, v168
    v_mfma_f32_16x16x32_bf16 v[136:139], a[176:179], v[48:51], v[224:227]
    buffer_load_dwordx4 v9, s[12:15], s92 offen offset:2048 lds
    v_mfma_f32_16x16x32_bf16 v[136:139], a[180:183], v[52:55], v[136:139]
    ds_read_b64_tr_b16 a[202:203], v18 offset:4352
    v_mfma_f32_16x16x32_bf16 v[136:139], a[184:187], v[56:59], v[136:139]
    v_exp_f32 v245, v169
    v_mfma_f32_16x16x32_bf16 v[136:139], a[188:191], v[60:63], v[136:139]
    ds_read_b64_tr_b16 a[204:205], v19 offset:256
    v_cvt_pk_bf16_f32 v206, v244, v245
    v_mfma_f32_16x16x32_bf16 v[120:123], a[160:163], v[64:67], v[228:231]
    s_add_u32 s93, s28, 21504
    v_exp_f32 v246, v170
    v_mfma_f32_16x16x32_bf16 v[120:123], a[164:167], v[68:71], v[120:123]
    buffer_load_dwordx4 v10, s[12:15], s93 offen offset:3072 lds
    v_mfma_f32_16x16x32_bf16 v[120:123], a[168:171], v[72:75], v[120:123]
    ds_read_b64_tr_b16 a[206:207], v19 offset:4352
    v_or3_b32 v22, v204, v205, v206
    v_mfma_f32_16x16x32_bf16 v[120:123], a[172:175], v[76:79], v[120:123]
    v_exp_f32 v247, v171
    v_mfma_f32_16x16x32_bf16 v[140:143], a[176:179], v[64:67], v[228:231]
    ds_read_b64_tr_b16 a[208:209], v18 offset:512
    v_cvt_pk_bf16_f32 v207, v246, v247
    v_mfma_f32_16x16x32_bf16 v[140:143], a[180:183], v[68:71], v[140:143]
    s_add_u32 m0, s6, 114688
    v_exp_f32 v248, v156
    v_mfma_f32_16x16x32_bf16 v[140:143], a[184:187], v[72:75], v[140:143]
    buffer_load_dwordx4 v9, s[12:15], s29 offen offset:0 lds
    v_mfma_f32_16x16x32_bf16 v[140:143], a[188:191], v[76:79], v[140:143]
    ds_read_b64_tr_b16 a[210:211], v18 offset:4608
    v_mfma_f32_16x16x32_bf16 v[124:127], a[160:163], v[80:83], v[232:235]
    v_exp_f32 v249, v157
    v_mfma_f32_16x16x32_bf16 v[124:127], a[164:167], v[84:87], v[124:127]
    ds_read_b64_tr_b16 a[212:213], v19 offset:512
    v_cvt_pk_bf16_f32 v208, v248, v249
    v_mfma_f32_16x16x32_bf16 v[124:127], a[168:171], v[88:91], v[124:127]
    s_add_u32 s94, s29, 7168
    v_exp_f32 v250, v158
    v_mfma_f32_16x16x32_bf16 v[124:127], a[172:175], v[92:95], v[124:127]
    buffer_load_dwordx4 v10, s[12:15], s94 offen offset:1024 lds
    v_mfma_f32_16x16x32_bf16 v[144:147], a[176:179], v[80:83], v[232:235]
    ds_read_b64_tr_b16 a[214:215], v19 offset:4608
    v_or3_b32 v22, v207, v208, v22
    v_mfma_f32_16x16x32_bf16 v[144:147], a[180:183], v[84:87], v[144:147]
    v_exp_f32 v251, v159
    v_mfma_f32_16x16x32_bf16 v[144:147], a[184:187], v[88:91], v[144:147]
    ds_read_b64_tr_b16 a[216:217], v18 offset:768
    v_cvt_pk_bf16_f32 v209, v250, v251
    v_mfma_f32_16x16x32_bf16 v[144:147], a[188:191], v[92:95], v[144:147]
    s_add_u32 s95, s29, 14336
    v_exp_f32 v252, v172
    v_mfma_f32_16x16x32_bf16 v[128:131], a[160:163], v[96:99], v[236:239]
    buffer_load_dwordx4 v9, s[12:15], s95 offen offset:2048 lds
    v_mfma_f32_16x16x32_bf16 v[128:131], a[164:167], v[100:103], v[128:131]
    ds_read_b64_tr_b16 a[218:219], v18 offset:4864
    v_mfma_f32_16x16x32_bf16 v[128:131], a[168:171], v[104:107], v[128:131]
    v_exp_f32 v253, v173
    v_mfma_f32_16x16x32_bf16 v[128:131], a[172:175], v[108:111], v[128:131]
    ds_read_b64_tr_b16 a[220:221], v19 offset:768
    v_cvt_pk_bf16_f32 v210, v252, v253
    v_mfma_f32_16x16x32_bf16 v[148:151], a[176:179], v[96:99], v[236:239]
    s_add_u32 s96, s29, 21504
    v_exp_f32 v254, v174
    v_mfma_f32_16x16x32_bf16 v[148:151], a[180:183], v[100:103], v[148:151]
    buffer_load_dwordx4 v10, s[12:15], s96 offen offset:3072 lds
    v_mfma_f32_16x16x32_bf16 v[148:151], a[184:187], v[104:107], v[148:151]
    ds_read_b64_tr_b16 a[222:223], v19 offset:4864
    v_or3_b32 v22, v209, v210, v22
    v_mfma_f32_16x16x32_bf16 v[148:151], a[188:191], v[108:111], v[148:151]
    v_exp_f32 v255, v175
    v_mfma_f32_16x16x32_bf16 a[224:227], a[244:247], v[184:187], a[224:227]
    v_exp_f32 v240, v160
    v_mfma_f32_16x16x32_bf16 a[228:231], a[244:247], v[188:191], a[228:231]
    v_exp_f32 v241, v161
    v_mfma_f32_16x16x32_bf16 a[232:235], a[244:247], v[192:195], a[232:235]
    s_add_u32 m0, s6, 131072
    v_exp_f32 v242, v162
    v_mfma_f32_16x16x32_bf16 a[236:239], a[244:247], v[196:199], a[236:239]
    buffer_load_dwordx4 v9, s[12:15], s30 offen offset:0 lds
    v_mfma_f32_16x16x32_bf16 a[240:243], a[244:247], v[200:203], a[240:243]
    s_waitcnt lgkmcnt(0)
    v_exp_f32 v243, v163
    v_mfma_f32_16x16x32_bf16 a[128:131], a[192:195], v[200:203], a[128:131]
    ds_read_b128 a[160:163], v16 offset:0
    v_cvt_pk_bf16_f32 v211, v254, v255
    v_mfma_f32_16x16x32_bf16 a[96:99], a[192:195], v[196:199], a[96:99]
    s_add_u32 s97, s30, 7168
    v_exp_f32 v244, v176
    v_mfma_f32_16x16x32_bf16 a[64:67], a[192:195], v[192:195], a[64:67]
    buffer_load_dwordx4 v10, s[12:15], s97 offen offset:1024 lds
    v_mfma_f32_16x16x32_bf16 a[32:35], a[192:195], v[188:191], a[32:35]
    v_exp_f32 v245, v177
    v_mfma_f32_16x16x32_bf16 a[0:3], a[192:195], v[184:187], a[0:3]
    ds_read_b128 a[164:167], v16 offset:256
    v_cvt_pk_bf16_f32 v212, v240, v241
    v_mfma_f32_16x16x32_bf16 a[4:7], a[196:199], v[184:187], a[4:7]
    s_add_u32 s90, s30, 14336
    v_or3_b32 v22, v211, v212, v22
    v_cvt_pk_bf16_f32 v213, v242, v243
    v_mfma_f32_16x16x32_bf16 a[36:39], a[196:199], v[188:191], a[36:39]
    buffer_load_dwordx4 v9, s[12:15], s90 offen offset:2048 lds
    v_mfma_f32_16x16x32_bf16 a[68:71], a[196:199], v[192:195], a[68:71]
    v_exp_f32 v246, v178
    v_mfma_f32_16x16x32_bf16 a[100:103], a[196:199], v[196:199], a[100:103]
    ds_read_b128 a[168:171], v17 offset:0
    v_cvt_pk_bf16_f32 v214, v244, v245
    v_mfma_f32_16x16x32_bf16 a[132:135], a[196:199], v[200:203], a[132:135]
    s_add_u32 s91, s30, 21504
    v_exp_f32 v247, v179
    v_mfma_f32_16x16x32_bf16 a[136:139], a[200:203], v[200:203], a[136:139]
    buffer_load_dwordx4 v10, s[12:15], s91 offen offset:3072 lds
    v_mfma_f32_16x16x32_bf16 a[104:107], a[200:203], v[196:199], a[104:107]
    v_exp_f32 v248, v164
    v_mfma_f32_16x16x32_bf16 a[72:75], a[200:203], v[192:195], a[72:75]
    ds_read_b128 a[172:175], v17 offset:256
    v_or3_b32 v22, v213, v214, v22
    v_mfma_f32_16x16x32_bf16 a[40:43], a[200:203], v[188:191], a[40:43]
    s_add_u32 m0, s6, 147456
    v_exp_f32 v249, v165
    v_mfma_f32_16x16x32_bf16 a[8:11], a[200:203], v[184:187], a[8:11]
    buffer_load_dwordx4 v9, s[12:15], s31 offen offset:0 lds
    v_mfma_f32_16x16x32_bf16 a[12:15], a[204:207], v[184:187], a[12:15]
    v_exp_f32 v250, v166
    v_mfma_f32_16x16x32_bf16 a[44:47], a[204:207], v[188:191], a[44:47]
    ds_read_b128 a[176:179], v16 offset:4096
    v_cvt_pk_bf16_f32 v215, v246, v247
    v_mfma_f32_16x16x32_bf16 a[76:79], a[204:207], v[192:195], a[76:79]
    s_add_u32 s92, s31, 7168
    v_cvt_pk_bf16_f32 v216, v248, v249
    v_or3_b32 v22, v215, v216, v22
    v_mfma_f32_16x16x32_bf16 a[108:111], a[204:207], v[196:199], a[108:111]
    buffer_load_dwordx4 v10, s[12:15], s92 offen offset:1024 lds
    v_mfma_f32_16x16x32_bf16 a[140:143], a[204:207], v[200:203], a[140:143]
    v_exp_f32 v251, v167
    v_mfma_f32_16x16x32_bf16 a[144:147], a[208:211], v[200:203], a[144:147]
    ds_read_b128 a[180:183], v16 offset:4352
    v_cvt_pk_bf16_f32 v217, v250, v251
    v_mfma_f32_16x16x32_bf16 a[112:115], a[208:211], v[196:199], a[112:115]
    s_add_u32 s93, s31, 14336
    v_exp_f32 v252, v180
    v_mfma_f32_16x16x32_bf16 a[80:83], a[208:211], v[192:195], a[80:83]
    buffer_load_dwordx4 v9, s[12:15], s93 offen offset:2048 lds
    v_mfma_f32_16x16x32_bf16 a[48:51], a[208:211], v[188:191], a[48:51]
    v_exp_f32 v253, v181
    v_mfma_f32_16x16x32_bf16 a[16:19], a[208:211], v[184:187], a[16:19]
    ds_read_b128 a[184:187], v17 offset:4096
    v_cvt_pk_bf16_f32 v218, v252, v253
    v_mfma_f32_16x16x32_bf16 a[20:23], a[212:215], v[184:187], a[20:23]
    s_add_u32 s94, s31, 21504
    v_exp_f32 v254, v182
    v_mfma_f32_16x16x32_bf16 a[52:55], a[212:215], v[188:191], a[52:55]
    buffer_load_dwordx4 v10, s[12:15], s94 offen offset:3072 lds
    v_mfma_f32_16x16x32_bf16 a[84:87], a[212:215], v[192:195], a[84:87]
    v_exp_f32 v255, v183
    v_mfma_f32_16x16x32_bf16 a[116:119], a[212:215], v[196:199], a[116:119]
    ds_read_b128 a[188:191], v17 offset:4352
    v_or3_b32 v22, v217, v218, v22
    v_mfma_f32_16x16x32_bf16 a[148:151], a[212:215], v[200:203], a[148:151]
    v_cvt_pk_bf16_f32 v219, v254, v255
    v_or_b32 v22, v219, v22
    v_mfma_f32_16x16x32_bf16 a[152:155], a[216:219], v[200:203], a[152:155]
    v_and_b32 v23, 0x40004000, v22
    v_cmp_ne_u32 vcc, 0, v23
    v_mfma_f32_16x16x32_bf16 a[120:123], a[216:219], v[196:199], a[120:123]
    v_add_u32 v18, 32768, v18
    v_add_u32 v19, 32768, v19
    v_mfma_f32_16x16x32_bf16 a[88:91], a[216:219], v[192:195], a[88:91]
    v_exp_f32 v240, v112
    v_mfma_f32_16x16x32_bf16 a[56:59], a[216:219], v[188:191], a[56:59]
    buffer_load_dword v1, v8, s[12:15], 0 offen
    v_mfma_f32_16x16x32_bf16 a[24:27], a[216:219], v[184:187], a[24:27]
    v_exp_f32 v241, v113
    v_mfma_f32_16x16x32_bf16 a[28:31], a[220:223], v[184:187], a[28:31]
    v_exp_f32 v242, v114
    v_mfma_f32_16x16x32_bf16 a[60:63], a[220:223], v[188:191], a[60:63]
    v_exp_f32 v243, v115
    v_mfma_f32_16x16x32_bf16 a[92:95], a[220:223], v[192:195], a[92:95]
    v_exp_f32 v244, v132
    v_mfma_f32_16x16x32_bf16 a[124:127], a[220:223], v[196:199], a[124:127]
    v_exp_f32 v245, v133
    v_mfma_f32_16x16x32_bf16 a[156:159], a[220:223], v[200:203], a[156:159]
    s_waitcnt lgkmcnt(0)
    s_cbranch_vccnz L_tramp6
L_back6:
    v_mfma_f32_16x16x32_bf16 v[152:155], a[160:163], v[32:35], v[220:223]
    ds_read_b64_tr_b16 a[192:193], v20 offset:0
    v_cvt_pk_bf16_f32 v184, v240, v241
    v_mfma_f32_16x16x32_bf16 v[152:155], a[164:167], v[36:39], v[152:155]
    ds_read_b64_tr_b16 a[194:195], v20 offset:4096
    v_cvt_pk_bf16_f32 v185, v242, v243
    v_mfma_f32_16x16x32_bf16 v[152:155], a[168:171], v[40:43], v[152:155]
    v_exp_f32 v246, v134
    v_mfma_f32_16x16x32_bf16 v[152:155], a[172:175], v[44:47], v[152:155]
    ds_read_b64_tr_b16 a[196:197], v21 offset:0
    v_cvt_pk_bf16_f32 v186, v244, v245
    v_mfma_f32_16x16x32_bf16 v[168:171], a[176:179], v[32:35], v[220:223]
    v_exp_f32 v247, v135
    v_mfma_f32_16x16x32_bf16 v[168:171], a[180:183], v[36:39], v[168:171]
    ds_read_b64_tr_b16 a[198:199], v21 offset:4096
    v_or3_b32 v22, v184, v185, v186
    v_mfma_f32_16x16x32_bf16 v[168:171], a[184:187], v[40:43], v[168:171]
    v_exp_f32 v248, v116
    v_mfma_f32_16x16x32_bf16 v[168:171], a[188:191], v[44:47], v[168:171]
    ds_read_b64_tr_b16 a[200:201], v20 offset:256
    v_cvt_pk_bf16_f32 v187, v246, v247
    v_mfma_f32_16x16x32_bf16 v[156:159], a[160:163], v[48:51], v[224:227]
    ds_read_b64_tr_b16 a[202:203], v20 offset:4352
    v_mfma_f32_16x16x32_bf16 v[156:159], a[164:167], v[52:55], v[156:159]
    v_exp_f32 v249, v117
    v_mfma_f32_16x16x32_bf16 v[156:159], a[168:171], v[56:59], v[156:159]
    ds_read_b64_tr_b16 a[204:205], v21 offset:256
    v_cvt_pk_bf16_f32 v188, v248, v249
    v_mfma_f32_16x16x32_bf16 v[156:159], a[172:175], v[60:63], v[156:159]
    v_exp_f32 v250, v118
    v_mfma_f32_16x16x32_bf16 v[172:175], a[176:179], v[48:51], v[224:227]
    ds_read_b64_tr_b16 a[206:207], v21 offset:4352
    v_or3_b32 v22, v187, v188, v22
    v_mfma_f32_16x16x32_bf16 v[172:175], a[180:183], v[52:55], v[172:175]
    v_exp_f32 v251, v119
    v_mfma_f32_16x16x32_bf16 v[172:175], a[184:187], v[56:59], v[172:175]
    ds_read_b64_tr_b16 a[208:209], v20 offset:512
    v_cvt_pk_bf16_f32 v189, v250, v251
    v_mfma_f32_16x16x32_bf16 v[172:175], a[188:191], v[60:63], v[172:175]
    ds_read_b64_tr_b16 a[210:211], v20 offset:4608
    v_mfma_f32_16x16x32_bf16 v[160:163], a[160:163], v[64:67], v[228:231]
    v_exp_f32 v252, v136
    v_mfma_f32_16x16x32_bf16 v[160:163], a[164:167], v[68:71], v[160:163]
    ds_read_b64_tr_b16 a[212:213], v21 offset:512
    v_mfma_f32_16x16x32_bf16 v[160:163], a[168:171], v[72:75], v[160:163]
    v_exp_f32 v253, v137
    v_mfma_f32_16x16x32_bf16 v[160:163], a[172:175], v[76:79], v[160:163]
    ds_read_b64_tr_b16 a[214:215], v21 offset:4608
    v_cvt_pk_bf16_f32 v190, v252, v253
    v_mfma_f32_16x16x32_bf16 v[176:179], a[176:179], v[64:67], v[228:231]
    v_exp_f32 v254, v138
    v_mfma_f32_16x16x32_bf16 v[176:179], a[180:183], v[68:71], v[176:179]
    ds_read_b64_tr_b16 a[216:217], v20 offset:768
    v_or3_b32 v22, v189, v190, v22
    v_mfma_f32_16x16x32_bf16 v[176:179], a[184:187], v[72:75], v[176:179]
    ds_read_b64_tr_b16 a[218:219], v20 offset:4864
    v_mfma_f32_16x16x32_bf16 v[176:179], a[188:191], v[76:79], v[176:179]
    v_exp_f32 v255, v139
    v_mfma_f32_16x16x32_bf16 v[164:167], a[160:163], v[80:83], v[232:235]
    ds_read_b64_tr_b16 a[220:221], v21 offset:768
    v_cvt_pk_bf16_f32 v191, v254, v255
    v_mfma_f32_16x16x32_bf16 v[164:167], a[164:167], v[84:87], v[164:167]
    v_mfma_f32_16x16x32_bf16 v[164:167], a[168:171], v[88:91], v[164:167]
    ds_read_b64_tr_b16 a[222:223], v21 offset:4864
    v_add_u32 v20, 32768, v20
    v_mfma_f32_16x16x32_bf16 v[164:167], a[172:175], v[92:95], v[164:167]
    v_exp_f32 v240, v120
    v_mfma_f32_16x16x32_bf16 v[180:183], a[176:179], v[80:83], v[232:235]
    v_exp_f32 v241, v121
    v_mfma_f32_16x16x32_bf16 v[180:183], a[180:183], v[84:87], v[180:183]
    v_cvt_pk_bf16_f32 v192, v240, v241
    v_or3_b32 v22, v191, v192, v22
    v_mfma_f32_16x16x32_bf16 v[180:183], a[184:187], v[88:91], v[180:183]
    v_exp_f32 v242, v122
    v_mfma_f32_16x16x32_bf16 v[180:183], a[188:191], v[92:95], v[180:183]
    v_exp_f32 v243, v123
    v_mfma_f32_16x16x32_bf16 a[224:227], a[244:247], v[204:207], a[224:227]
    v_cvt_pk_bf16_f32 v193, v242, v243
    v_add_u32 v21, 32768, v21
    v_mfma_f32_16x16x32_bf16 a[228:231], a[244:247], v[208:211], a[228:231]
    v_exp_f32 v244, v140
    v_mfma_f32_16x16x32_bf16 a[232:235], a[244:247], v[212:215], a[232:235]
    v_exp_f32 v245, v141
    v_mfma_f32_16x16x32_bf16 a[236:239], a[244:247], v[216:219], a[236:239]
    s_waitcnt lgkmcnt(0)
    v_cvt_pk_bf16_f32 v194, v244, v245
    v_or3_b32 v22, v193, v194, v22
    v_mfma_f32_16x16x32_bf16 a[96:99], a[192:195], v[216:219], a[96:99]
    v_mfma_f32_16x16x32_bf16 a[64:67], a[192:195], v[212:215], a[64:67]
    v_exp_f32 v246, v142
    v_mfma_f32_16x16x32_bf16 a[32:35], a[192:195], v[208:211], a[32:35]
    v_mfma_f32_16x16x32_bf16 a[0:3], a[192:195], v[204:207], a[0:3]
    v_exp_f32 v247, v143
    v_mfma_f32_16x16x32_bf16 a[4:7], a[196:199], v[204:207], a[4:7]
    v_exp_f32 v248, v124
    v_mfma_f32_16x16x32_bf16 a[36:39], a[196:199], v[208:211], a[36:39]
    v_cvt_pk_bf16_f32 v195, v246, v247
    v_mfma_f32_16x16x32_bf16 a[68:71], a[196:199], v[212:215], a[68:71]
    v_exp_f32 v249, v125
    v_mfma_f32_16x16x32_bf16 a[100:103], a[196:199], v[216:219], a[100:103]
    v_exp_f32 v250, v126
    v_mfma_f32_16x16x32_bf16 a[104:107], a[200:203], v[216:219], a[104:107]
    v_cvt_pk_bf16_f32 v196, v248, v249
    v_or3_b32 v22, v195, v196, v22
    v_mfma_f32_16x16x32_bf16 a[72:75], a[200:203], v[212:215], a[72:75]
    v_exp_f32 v251, v127
    v_mfma_f32_16x16x32_bf16 a[40:43], a[200:203], v[208:211], a[40:43]
    v_exp_f32 v252, v144
    v_mfma_f32_16x16x32_bf16 a[8:11], a[200:203], v[204:207], a[8:11]
    v_cvt_pk_bf16_f32 v197, v250, v251
    v_mfma_f32_16x16x32_bf16 a[12:15], a[204:207], v[204:207], a[12:15]
    v_exp_f32 v253, v145
    v_mfma_f32_16x16x32_bf16 a[44:47], a[204:207], v[208:211], a[44:47]
    v_exp_f32 v254, v146
    v_mfma_f32_16x16x32_bf16 a[76:79], a[204:207], v[212:215], a[76:79]
    v_cvt_pk_bf16_f32 v198, v252, v253
    v_or3_b32 v22, v197, v198, v22
    v_mfma_f32_16x16x32_bf16 a[108:111], a[204:207], v[216:219], a[108:111]
    v_exp_f32 v255, v147
    v_mfma_f32_16x16x32_bf16 a[112:115], a[208:211], v[216:219], a[112:115]
    v_cvt_pk_bf16_f32 v199, v254, v255
    v_mfma_f32_16x16x32_bf16 a[80:83], a[208:211], v[212:215], a[80:83]
    v_exp_f32 v240, v128
    v_mfma_f32_16x16x32_bf16 a[48:51], a[208:211], v[208:211], a[48:51]
    v_exp_f32 v241, v129
    v_mfma_f32_16x16x32_bf16 a[16:19], a[208:211], v[204:207], a[16:19]
    v_cvt_pk_bf16_f32 v200, v240, v241
    v_or3_b32 v22, v199, v200, v22
    v_mfma_f32_16x16x32_bf16 a[20:23], a[212:215], v[204:207], a[20:23]
    v_exp_f32 v242, v130
    v_mfma_f32_16x16x32_bf16 a[52:55], a[212:215], v[208:211], a[52:55]
    v_exp_f32 v243, v131
    v_mfma_f32_16x16x32_bf16 a[84:87], a[212:215], v[212:215], a[84:87]
    v_cvt_pk_bf16_f32 v201, v242, v243
    v_mfma_f32_16x16x32_bf16 a[116:119], a[212:215], v[216:219], a[116:119]
    v_exp_f32 v244, v148
    v_mfma_f32_16x16x32_bf16 a[120:123], a[216:219], v[216:219], a[120:123]
    v_exp_f32 v245, v149
    v_mfma_f32_16x16x32_bf16 a[88:91], a[216:219], v[212:215], a[88:91]
    v_cvt_pk_bf16_f32 v202, v244, v245
    v_or3_b32 v22, v201, v202, v22
    v_mfma_f32_16x16x32_bf16 a[56:59], a[216:219], v[208:211], a[56:59]
    v_exp_f32 v246, v150
    v_mfma_f32_16x16x32_bf16 a[24:27], a[216:219], v[204:207], a[24:27]
    v_exp_f32 v247, v151
    v_mfma_f32_16x16x32_bf16 a[28:31], a[220:223], v[204:207], a[28:31]
    v_cvt_pk_bf16_f32 v203, v246, v247
    v_or_b32 v22, v203, v22
    v_mfma_f32_16x16x32_bf16 a[60:63], a[220:223], v[208:211], a[60:63]
    v_and_b32 v23, 0x40004000, v22
    v_cmp_ne_u32 vcc, 0, v23
    v_mfma_f32_16x16x32_bf16 a[92:95], a[220:223], v[212:215], a[92:95]
    v_mfma_f32_16x16x32_bf16 a[124:127], a[220:223], v[216:219], a[124:127]
    s_waitcnt vmcnt(17) lgkmcnt(0)
    s_barrier
    s_cbranch_vccnz L_tramp7
L_back7:
    ds_read_b64_tr_b16 a[192:193], v18 offset:0
    ds_read_b64_tr_b16 a[194:195], v18 offset:4096
    ds_read_b64_tr_b16 a[196:197], v19 offset:0
    ds_read_b64_tr_b16 a[198:199], v19 offset:4096
    ds_read_b64_tr_b16 a[200:201], v18 offset:256
    ds_read_b64_tr_b16 a[202:203], v18 offset:4352
    ds_read_b64_tr_b16 a[204:205], v19 offset:256
    ds_read_b64_tr_b16 a[206:207], v19 offset:4352
    ds_read_b64_tr_b16 a[208:209], v18 offset:512
    ds_read_b64_tr_b16 a[210:211], v18 offset:4608
    ds_read_b64_tr_b16 a[212:213], v19 offset:512
    ds_read_b64_tr_b16 a[214:215], v19 offset:4608
    ds_read_b64_tr_b16 a[216:217], v18 offset:768
    ds_read_b64_tr_b16 a[218:219], v18 offset:4864
    ds_read_b64_tr_b16 a[220:221], v19 offset:768
    ds_read_b64_tr_b16 a[222:223], v19 offset:4864
    ds_read_b64_tr_b16 a[160:161], v20 offset:0
    ds_read_b64_tr_b16 a[162:163], v20 offset:4096
    ds_read_b64_tr_b16 a[164:165], v21 offset:0
    ds_read_b64_tr_b16 a[166:167], v21 offset:4096
    ds_read_b64_tr_b16 a[168:169], v20 offset:256
    ds_read_b64_tr_b16 a[170:171], v20 offset:4352
    ds_read_b64_tr_b16 a[172:173], v21 offset:256
    ds_read_b64_tr_b16 a[174:175], v21 offset:4352
    ds_read_b64_tr_b16 a[176:177], v20 offset:512
    ds_read_b64_tr_b16 a[178:179], v20 offset:4608
    ds_read_b64_tr_b16 a[180:181], v21 offset:512
    ds_read_b64_tr_b16 a[182:183], v21 offset:4608
    ds_read_b64_tr_b16 a[184:185], v20 offset:768
    ds_read_b64_tr_b16 a[186:187], v20 offset:4864
    ds_read_b64_tr_b16 a[188:189], v21 offset:768
    ds_read_b64_tr_b16 a[190:191], v21 offset:4864
    v_exp_f32 v240, v152
    v_exp_f32 v241, v153
    v_exp_f32 v242, v154
    v_exp_f32 v243, v155
    v_cvt_pk_bf16_f32 v204, v240, v241
    v_exp_f32 v244, v168
    v_exp_f32 v245, v169
    v_cvt_pk_bf16_f32 v205, v242, v243
    v_exp_f32 v246, v170
    v_exp_f32 v247, v171
    v_cvt_pk_bf16_f32 v206, v244, v245
    v_or3_b32 v22, v204, v205, v206
    v_cvt_pk_bf16_f32 v207, v246, v247
    v_or_b32 v22, v207, v22
    v_and_b32 v23, 0x40004000, v22
    v_cmp_ne_u32 s[28:29], 0, v23
    s_mul_i32 s55, s5, 36864
    s_lshl_b32 s54, s4, 12
    s_add_u32 s55, s55, s54
    s_xor_b32 s36, s33, 0
    s_lshl_b32 s36, s36, 10
    s_add_u32 s36, s36, s55
    s_xor_b32 s37, s33, 1
    s_lshl_b32 s37, s37, 10
    s_add_u32 s37, s37, s55
    s_xor_b32 s38, s33, 2
    s_lshl_b32 s38, s38, 10
    s_add_u32 s38, s38, s55
    s_xor_b32 s39, s33, 3
    s_lshl_b32 s39, s39, 10
    s_add_u32 s39, s39, s55
    s_mul_i32 s55, s3, 14336
    v_add_u32 v24, s55, v7
    s_mul_i32 s54, s5, 28672
    s_lshl_b32 s53, s4, 12
    s_add_u32 s53, s53, s54
    v_add_u32 v30, s53, v7
    v_add_u32 v31, s54, v7
    s_waitcnt lgkmcnt(0)
    v_mfma_f32_16x16x32_bf16 a[224:227], a[244:247], v[184:187], a[224:227]
    v_exp_f32 v248, v156
    v_mfma_f32_16x16x32_bf16 a[0:3], a[192:195], v[184:187], a[0:3]
    v_exp_f32 v249, v157
    v_mfma_f32_16x16x32_bf16 a[4:7], a[196:199], v[184:187], a[4:7]
    v_exp_f32 v250, v158
    v_mfma_f32_16x16x32_bf16 a[8:11], a[200:203], v[184:187], a[8:11]
    v_exp_f32 v251, v159
    v_mfma_f32_16x16x32_bf16 a[12:15], a[204:207], v[184:187], a[12:15]
    v_cvt_pk_bf16_f32 v208, v248, v249
    v_mfma_f32_16x16x32_bf16 a[16:19], a[208:211], v[184:187], a[16:19]
    v_exp_f32 v252, v172
    v_mfma_f32_16x16x32_bf16 a[20:23], a[212:215], v[184:187], a[20:23]
    v_exp_f32 v253, v173
    v_mfma_f32_16x16x32_bf16 a[24:27], a[216:219], v[184:187], a[24:27]
    v_cvt_pk_bf16_f32 v209, v250, v251
    v_mfma_f32_16x16x32_bf16 a[28:31], a[220:223], v[184:187], a[28:31]
    v_exp_f32 v254, v174
    s_cmp_lg_u64 s[28:29], 0
    s_cbranch_scc1 L_tslow0
L_tback0:
    v_mfma_f32_16x16x32_bf16 a[224:227], a[244:247], v[204:207], a[224:227]
    v_exp_f32 v255, v175
    v_mfma_f32_16x16x32_bf16 a[0:3], a[160:163], v[204:207], a[0:3]
    v_cvt_pk_bf16_f32 v210, v252, v253
    v_or3_b32 v22, v208, v209, v210
    v_mfma_f32_16x16x32_bf16 a[4:7], a[164:167], v[204:207], a[4:7]
    v_cvt_pk_bf16_f32 v211, v254, v255
    v_or_b32 v22, v211, v22
    v_mfma_f32_16x16x32_bf16 a[8:11], a[168:171], v[204:207], a[8:11]
    v_and_b32 v23, 0x40004000, v22
    v_cmp_ne_u32 s[30:31], 0, v23
    v_mfma_f32_16x16x32_bf16 a[12:15], a[172:175], v[204:207], a[12:15]
    s_bfe_u32 s60, s2, 0x10002
    s_lshr_b32 s61, s2, 5
    s_bfe_u32 s7, s2, 0x10001
    s_lshl_b32 s62, s60, 3
    s_add_u32 s62, s62, s61
    s_lshl_b32 s62, s62, 1
    s_add_u32 s62, s62, s7
    s_mul_i32 s62, s62, 589824
    s_add_u32 s8, s48, s62
    s_addc_u32 s9, s49, 0
    s_mov_b32 s10, 589824
    s_mov_b32 s11, 0x20000
    s_lshl_b32 s62, s34, 8
    s_mul_i32 s63, s61, 589824
    s_add_u32 s62, s62, s63
    s_lshl_b32 s63, s60, 11
    s_add_u32 s62, s62, s63
    s_add_u32 s16, s50, s62
    s_addc_u32 s17, s51, 0
    s_sub_u32 s18, 4718592, s62
    s_mov_b32 s19, 0x20000
    s_add_u32 s52, s48, 33554432
    s_addc_u32 s53, s49, 0
    s_mov_b32 s54, 9437184
    s_mov_b32 s55, 0x20000
    s_add_u32 s20, s48, 67108864
    s_addc_u32 s21, s49, 0
    s_mov_b32 s22, 65536
    s_mov_b32 s23, 0x20000
    s_mul_i32 s46, s34, 2
    s_mul_i32 s47, s61, 1
    s_add_u32 s46, s46, s47
    s_lshl_b32 s47, s34, 2
    s_add_u32 s47, s47, 0
    s_and_b32 s47, s47, 12
    s_add_u32 s47, s47, 4
    s_and_b32 s7, 1, s2
    s_lshl_b32 s7, s7, 4
    s_cmp_eq_u32 s4, 0
    s_cselect_b32 s50, -1, 0
    s_cselect_b32 s51, 0, -1
    s_mul_i32 s60, s5, 9216
    s_lshl_b32 s61, s4, 12
    s_add_u32 s61, s61, s60
    s_xor_b32 s62, s33, 0
    s_lshl_b32 s62, s62, 10
    s_add_u32 s62, s62, s61
    v_add_u32 v2, s62, v7
    s_xor_b32 s62, s33, 1
    s_lshl_b32 s62, s62, 10
    s_add_u32 s62, s62, s61
    v_add_u32 v3, s62, v7
    v_mfma_f32_16x16x32_bf16 a[16:19], a[176:179], v[204:207], a[16:19]
    s_xor_b32 s62, s33, 2
    s_lshl_b32 s62, s62, 10
    s_add_u32 s62, s62, s61
    v_add_u32 v4, s62, v7
    s_xor_b32 s62, s33, 3
    s_lshl_b32 s62, s62, 10
    s_add_u32 s62, s62, s61
    v_add_u32 v5, s62, v7
    v_mfma_f32_16x16x32_bf16 a[20:23], a[180:183], v[204:207], a[20:23]
    s_add_u32 s60, s60, 8192
    v_add_u32 v6, s60, v7
    s_lshl_b32 s35, s5, 10
    s_add_u32 s35, s35, 57344
    v_add_u32 v8, s35, v7
    v_mfma_f32_16x16x32_bf16 a[24:27], a[184:187], v[204:207], a[24:27]
    v_and_b32 v40, 0xfff, v18
    s_lshl_b32 s60, s5, 13
    s_lshl_b32 s61, s4, 9
    s_add_u32 s60, s60, s61
    s_add_u32 s60, s60, 98304
    v_add_u32 v14, s60, v40
    v_mfma_f32_16x16x32_bf16 a[28:31], a[188:191], v[204:207], a[28:31]
    v_xor_b32 v15, 512, v14
    v_xor_b32 v16, 32, v14
    v_mfma_f32_16x16x32_bf16 a[240:243], a[244:247], v[200:203], a[240:243]
    v_xor_b32 v17, 544, v14
    s_mul_i32 s60, s3, 12288
    v_add_u32 v11, s60, v7
    v_mfma_f32_16x16x32_bf16 a[128:131], a[192:195], v[200:203], a[128:131]
    s_xor_b32 s61, s3, 2
    s_mul_i32 s61, s61, 12288
    v_add_u32 v12, s61, v7
    s_mul_i32 s60, s4, 12288
    s_add_u32 s60, s60, 8192
    s_lshl_b32 s61, s33, 10
    s_add_u32 s61, s61, s60
    v_add_u32 v13, s61, v7
    v_mfma_f32_16x16x32_bf16 a[132:135], a[196:199], v[200:203], a[132:135]
    s_xor_b32 s61, s33, 1
    s_lshl_b32 s61, s61, 10
    s_add_u32 s61, s61, s60
    v_add_u32 v18, s61, v7
    s_andn2_b32 s60, s2, 0x19
    v_and_b32 v19, 1, v0
    v_mfma_f32_16x16x32_bf16 a[136:139], a[200:203], v[200:203], a[136:139]
    v_bfe_u32 v40, v0, 1, 2
    v_lshl_or_b32 v19, v40, 3, v19
    v_mfma_f32_16x16x32_bf16 a[140:143], a[204:207], v[200:203], a[140:143]
    v_or_b32 v19, s60, v19
    v_cmp_eq_u32 vcc, s2, v19
    v_mfma_f32_16x16x32_bf16 a[144:147], a[208:211], v[200:203], a[144:147]
    v_lshlrev_b32 v19, 8, v19
    v_mov_b32 v40, 2146435072
    v_mfma_f32_16x16x32_bf16 a[148:151], a[212:215], v[200:203], a[148:151]
    s_nop 0
    v_cndmask_b32 v19, v19, v40, vcc
    v_xor_b32 v40, s2, v0
    v_mfma_f32_16x16x32_bf16 a[152:155], a[216:219], v[200:203], a[152:155]
    v_and_b32 v40, 1, v40
    v_lshl_add_u32 v19, v40, 2, v19
    v_mfma_f32_16x16x32_bf16 a[156:159], a[220:223], v[200:203], a[156:159]
    s_lshl_b32 s60, s2, 8
    s_add_u32 s60, s60, 4
    v_mov_b32 v20, s60
    v_mfma_f32_16x16x32_bf16 a[228:231], a[244:247], v[188:191], a[228:231]
    v_accvgpr_read_b32 v26, a224
    v_mfma_f32_16x16x32_bf16 a[32:35], a[192:195], v[188:191], a[32:35]
    v_rcp_f32 v26, v26
    v_mfma_f32_16x16x32_bf16 a[36:39], a[196:199], v[188:191], a[36:39]
    v_accvgpr_read_b32 v32, a0
    v_accvgpr_read_b32 v33, a1
    v_mfma_f32_16x16x32_bf16 a[40:43], a[200:203], v[188:191], a[40:43]
    v_accvgpr_read_b32 v34, a2
    v_accvgpr_read_b32 v35, a3
    v_mfma_f32_16x16x32_bf16 a[44:47], a[204:207], v[188:191], a[44:47]
    v_accvgpr_read_b32 v36, a4
    v_accvgpr_read_b32 v37, a5
    v_mfma_f32_16x16x32_bf16 a[48:51], a[208:211], v[188:191], a[48:51]
    v_accvgpr_read_b32 v38, a6
    v_accvgpr_read_b32 v39, a7
    v_mfma_f32_16x16x32_bf16 a[52:55], a[212:215], v[188:191], a[52:55]
    v_mul_f32 v32, v32, v26
    v_mul_f32 v33, v33, v26
    v_mfma_f32_16x16x32_bf16 a[56:59], a[216:219], v[188:191], a[56:59]
    v_mul_f32 v34, v34, v26
    v_mul_f32 v35, v35, v26
    v_mfma_f32_16x16x32_bf16 a[60:63], a[220:223], v[188:191], a[60:63]
    v_mul_f32 v36, v36, v26
    v_mul_f32 v37, v37, v26
    s_cmp_lg_u64 s[30:31], 0
    s_cbranch_scc1 L_tslow1
L_tback1:
    v_mfma_f32_16x16x32_bf16 a[228:231], a[244:247], v[208:211], a[228:231]
    v_mul_f32 v38, v38, v26
    v_mul_f32 v39, v39, v26
    v_mfma_f32_16x16x32_bf16 a[32:35], a[160:163], v[208:211], a[32:35]
    s_add_u32 s44, s36, 0
    v_cvt_pk_bf16_f32 v48, v32, v33
    v_cvt_pk_bf16_f32 v49, v34, v35
    v_mfma_f32_16x16x32_bf16 a[36:39], a[164:167], v[208:211], a[36:39]
    v_cvt_pk_bf16_f32 v50, v36, v37
    v_cvt_pk_bf16_f32 v51, v38, v39
    v_mfma_f32_16x16x32_bf16 a[40:43], a[168:171], v[208:211], a[40:43]
    buffer_store_dwordx4 v[48:51], v7, s[24:27], s44 offen sc0 sc1
    v_mfma_f32_16x16x32_bf16 a[44:47], a[172:175], v[208:211], a[44:47]
    ds_write_b128 v24, a[128:131] offset:0
    v_mfma_f32_16x16x32_bf16 a[48:51], a[176:179], v[208:211], a[48:51]
    ds_write_b128 v24, a[132:135] offset:1024
    v_mfma_f32_16x16x32_bf16 a[52:55], a[180:183], v[208:211], a[52:55]
    ds_write_b128 v24, a[136:139] offset:2048
    v_mfma_f32_16x16x32_bf16 a[56:59], a[184:187], v[208:211], a[56:59]
    ds_write_b128 v24, a[140:143] offset:3072
    v_mfma_f32_16x16x32_bf16 a[60:63], a[188:191], v[208:211], a[60:63]
    ds_write_b128 v24, a[144:147] offset:4096
    v_accvgpr_read_b32 v32, a8
    v_accvgpr_read_b32 v33, a9
    v_accvgpr_read_b32 v34, a10
    v_accvgpr_read_b32 v35, a11
    v_accvgpr_read_b32 v36, a12
    v_accvgpr_read_b32 v37, a13
    v_accvgpr_read_b32 v38, a14
    v_accvgpr_read_b32 v39, a15
    v_mul_f32 v32, v32, v26
    v_mul_f32 v33, v33, v26
    v_mul_f32 v34, v34, v26
    v_mul_f32 v35, v35, v26
    v_mul_f32 v36, v36, v26
    v_mul_f32 v37, v37, v26
    v_mul_f32 v38, v38, v26
    v_mul_f32 v39, v39, v26
    s_add_u32 s44, s36, 9216
    v_cvt_pk_bf16_f32 v64, v32, v33
    v_cvt_pk_bf16_f32 v65, v34, v35
    v_cvt_pk_bf16_f32 v66, v36, v37
    v_cvt_pk_bf16_f32 v67, v38, v39
    buffer_store_dwordx4 v[64:67], v7, s[24:27], s44 offen sc0 sc1
    ds_write_b128 v24, a[148:151] offset:5120
    ds_write_b128 v24, a[152:155] offset:6144
    ds_write_b128 v24, a[156:159] offset:7168
    v_accvgpr_read_b32 v237, a240
    ds_write_b128 v24, v[236:239] offset:8192
    v_exp_f32 v240, v160
    v_exp_f32 v241, v161
    v_exp_f32 v242, v162
    v_exp_f32 v243, v163
    v_cvt_pk_bf16_f32 v212, v240, v241
    v_exp_f32 v244, v176
    v_exp_f32 v245, v177
    v_cvt_pk_bf16_f32 v213, v242, v243
    v_accvgpr_read_b32 v32, a16
    v_accvgpr_read_b32 v33, a17
    v_accvgpr_read_b32 v34, a18
    v_accvgpr_read_b32 v35, a19
    v_accvgpr_read_b32 v36, a20
    v_accvgpr_read_b32 v37, a21
    v_accvgpr_read_b32 v38, a22
    v_accvgpr_read_b32 v39, a23
    v_mul_f32 v32, v32, v26
    v_mul_f32 v33, v33, v26
    v_mul_f32 v34, v34, v26
    v_mul_f32 v35, v35, v26
    v_mul_f32 v36, v36, v26
    v_mul_f32 v37, v37, v26
    v_mul_f32 v38, v38, v26
    v_mul_f32 v39, v39, v26
    s_add_u32 s44, s36, 18432
    v_cvt_pk_bf16_f32 v80, v32, v33
    v_cvt_pk_bf16_f32 v81, v34, v35
    v_cvt_pk_bf16_f32 v82, v36, v37
    v_cvt_pk_bf16_f32 v83, v38, v39
    buffer_store_dwordx4 v[80:83], v7, s[24:27], s44 offen sc0 sc1
    v_exp_f32 v246, v178
    v_exp_f32 v247, v179
    v_cvt_pk_bf16_f32 v214, v244, v245
    v_or3_b32 v22, v212, v213, v214
    v_cvt_pk_bf16_f32 v215, v246, v247
    v_or_b32 v22, v215, v22
    v_and_b32 v23, 0x40004000, v22
    v_cmp_ne_u32 s[28:29], 0, v23
    v_accvgpr_read_b32 v32, a24
    v_accvgpr_read_b32 v33, a25
    v_accvgpr_read_b32 v34, a26
    v_accvgpr_read_b32 v35, a27
    v_accvgpr_read_b32 v36, a28
    v_accvgpr_read_b32 v37, a29
    v_accvgpr_read_b32 v38, a30
    v_accvgpr_read_b32 v39, a31
    v_mul_f32 v32, v32, v26
    v_mul_f32 v33, v33, v26
    v_mul_f32 v34, v34, v26
    v_mul_f32 v35, v35, v26
    v_mul_f32 v36, v36, v26
    v_mul_f32 v37, v37, v26
    v_mul_f32 v38, v38, v26
    v_mul_f32 v39, v39, v26
    s_add_u32 s44, s36, 27648
    v_cvt_pk_bf16_f32 v96, v32, v33
    v_cvt_pk_bf16_f32 v97, v34, v35
    v_cvt_pk_bf16_f32 v98, v36, v37
    v_cvt_pk_bf16_f32 v99, v38, v39
    buffer_store_dwordx4 v[96:99], v7, s[24:27], s44 offen sc0 sc1
    v_mfma_f32_16x16x32_bf16 a[232:235], a[244:247], v[192:195], a[232:235]
    v_accvgpr_read_b32 v27, a228
    v_mfma_f32_16x16x32_bf16 a[64:67], a[192:195], v[192:195], a[64:67]
    v_rcp_f32 v27, v27
    v_mfma_f32_16x16x32_bf16 a[68:71], a[196:199], v[192:195], a[68:71]
    v_accvgpr_read_b32 v32, a32
    v_accvgpr_read_b32 v33, a33
    v_mfma_f32_16x16x32_bf16 a[72:75], a[200:203], v[192:195], a[72:75]
    v_accvgpr_read_b32 v34, a34
    v_accvgpr_read_b32 v35, a35
    v_mfma_f32_16x16x32_bf16 a[76:79], a[204:207], v[192:195], a[76:79]
    v_accvgpr_read_b32 v36, a36
    v_accvgpr_read_b32 v37, a37
    v_mfma_f32_16x16x32_bf16 a[80:83], a[208:211], v[192:195], a[80:83]
    v_accvgpr_read_b32 v38, a38
    v_accvgpr_read_b32 v39, a39
    v_mfma_f32_16x16x32_bf16 a[84:87], a[212:215], v[192:195], a[84:87]
    v_mul_f32 v32, v32, v27
    v_mul_f32 v33, v33, v27
    v_mfma_f32_16x16x32_bf16 a[88:91], a[216:219], v[192:195], a[88:91]
    v_mul_f32 v34, v34, v27
    v_mul_f32 v35, v35, v27
    v_mfma_f32_16x16x32_bf16 a[92:95], a[220:223], v[192:195], a[92:95]
    v_mul_f32 v36, v36, v27
    v_mul_f32 v37, v37, v27
    s_cmp_lg_u64 s[28:29], 0
    s_cbranch_scc1 L_tslow2
L_tback2:
    v_mfma_f32_16x16x32_bf16 a[232:235], a[244:247], v[212:215], a[232:235]
    v_mul_f32 v38, v38, v27
    v_mul_f32 v39, v39, v27
    v_mfma_f32_16x16x32_bf16 a[64:67], a[160:163], v[212:215], a[64:67]
    s_add_u32 s44, s37, 0
    v_cvt_pk_bf16_f32 v52, v32, v33
    v_cvt_pk_bf16_f32 v53, v34, v35
    v_mfma_f32_16x16x32_bf16 a[68:71], a[164:167], v[212:215], a[68:71]
    v_cvt_pk_bf16_f32 v54, v36, v37
    v_cvt_pk_bf16_f32 v55, v38, v39
    v_mfma_f32_16x16x32_bf16 a[72:75], a[168:171], v[212:215], a[72:75]
    buffer_store_dwordx4 v[52:55], v7, s[24:27], s44 offen sc0 sc1
    v_mfma_f32_16x16x32_bf16 a[76:79], a[172:175], v[212:215], a[76:79]
    v_accvgpr_read_b32 v32, a40
    v_accvgpr_read_b32 v33, a41
    v_mfma_f32_16x16x32_bf16 a[80:83], a[176:179], v[212:215], a[80:83]
    v_accvgpr_read_b32 v34, a42
    v_accvgpr_read_b32 v35, a43
    v_mfma_f32_16x16x32_bf16 a[84:87], a[180:183], v[212:215], a[84:87]
    v_accvgpr_read_b32 v36, a44
    v_accvgpr_read_b32 v37, a45
    v_mfma_f32_16x16x32_bf16 a[88:91], a[184:187], v[212:215], a[88:91]
    v_accvgpr_read_b32 v38, a46
    v_accvgpr_read_b32 v39, a47
    v_mfma_f32_16x16x32_bf16 a[92:95], a[188:191], v[212:215], a[92:95]
    v_mul_f32 v32, v32, v27
    v_mul_f32 v33, v33, v27
    v_mul_f32 v34, v34, v27
    v_mul_f32 v35, v35, v27
    v_mul_f32 v36, v36, v27
    v_mul_f32 v37, v37, v27
    v_mul_f32 v38, v38, v27
    v_mul_f32 v39, v39, v27
    s_add_u32 s44, s37, 9216
    v_cvt_pk_bf16_f32 v68, v32, v33
    v_cvt_pk_bf16_f32 v69, v34, v35
    v_cvt_pk_bf16_f32 v70, v36, v37
    v_cvt_pk_bf16_f32 v71, v38, v39
    buffer_store_dwordx4 v[68:71], v7, s[24:27], s44 offen sc0 sc1
    v_exp_f32 v248, v164
    v_exp_f32 v249, v165
    v_exp_f32 v250, v166
    v_exp_f32 v251, v167
    v_cvt_pk_bf16_f32 v216, v248, v249
    v_exp_f32 v252, v180
    v_exp_f32 v253, v181
    v_cvt_pk_bf16_f32 v217, v250, v251
    v_accvgpr_read_b32 v32, a48
    v_accvgpr_read_b32 v33, a49
    v_accvgpr_read_b32 v34, a50
    v_accvgpr_read_b32 v35, a51
    v_accvgpr_read_b32 v36, a52
    v_accvgpr_read_b32 v37, a53
    v_accvgpr_read_b32 v38, a54
    v_accvgpr_read_b32 v39, a55
    v_mul_f32 v32, v32, v27
    v_mul_f32 v33, v33, v27
    v_mul_f32 v34, v34, v27
    v_mul_f32 v35, v35, v27
    v_mul_f32 v36, v36, v27
    v_mul_f32 v37, v37, v27
    v_mul_f32 v38, v38, v27
    v_mul_f32 v39, v39, v27
    s_add_u32 s44, s37, 18432
    v_cvt_pk_bf16_f32 v84, v32, v33
    v_cvt_pk_bf16_f32 v85, v34, v35
    v_cvt_pk_bf16_f32 v86, v36, v37
    v_cvt_pk_bf16_f32 v87, v38, v39
    buffer_store_dwordx4 v[84:87], v7, s[24:27], s44 offen sc0 sc1
    v_exp_f32 v254, v182
    v_exp_f32 v255, v183
    v_cvt_pk_bf16_f32 v218, v252, v253
    v_or3_b32 v22, v216, v217, v218
    v_cvt_pk_bf16_f32 v219, v254, v255
    v_or_b32 v22, v219, v22
    v_and_b32 v23, 0x40004000, v22
    v_cmp_ne_u32 s[30:31], 0, v23
    s_waitcnt vmcnt(8) lgkmcnt(0)
    s_barrier
    ds_read_b128 v[112:115], v30 offset:0
    ds_read_b128 v[116:119], v30 offset:1024
    ds_read_b128 v[120:123], v30 offset:2048
    ds_read_b128 v[124:127], v30 offset:3072
    ds_read_b64 v[144:145], v31 offset:8192
    ds_read_b128 v[128:131], v30 offset:14336
    ds_read_b128 v[132:135], v30 offset:15360
    ds_read_b128 v[136:139], v30 offset:16384
    ds_read_b128 v[140:143], v30 offset:17408
    ds_read_b64 v[146:147], v31 offset:22528
    v_accvgpr_read_b32 v32, a56
    v_accvgpr_read_b32 v33, a57
    v_accvgpr_read_b32 v34, a58
    v_accvgpr_read_b32 v35, a59
    v_accvgpr_read_b32 v36, a60
    v_accvgpr_read_b32 v37, a61
    v_accvgpr_read_b32 v38, a62
    v_accvgpr_read_b32 v39, a63
    v_mul_f32 v32, v32, v27
    v_mul_f32 v33, v33, v27
    v_mul_f32 v34, v34, v27
    v_mul_f32 v35, v35, v27
    v_mul_f32 v36, v36, v27
    v_mul_f32 v37, v37, v27
    v_mul_f32 v38, v38, v27
    v_mul_f32 v39, v39, v27
    s_add_u32 s44, s37, 27648
    v_cvt_pk_bf16_f32 v100, v32, v33
    v_cvt_pk_bf16_f32 v101, v34, v35
    v_cvt_pk_bf16_f32 v102, v36, v37
    v_cvt_pk_bf16_f32 v103, v38, v39
    buffer_store_dwordx4 v[100:103], v7, s[24:27], s44 offen sc0 sc1
    s_waitcnt lgkmcnt(0)
    v_min_f32 v148, v144, v146
    v_sub_f32 v144, v148, v144
    v_sub_f32 v146, v148, v146
    v_exp_f32 v144, v144
    v_exp_f32 v146, v146
    s_nop 0
    v_mul_f32 v149, v145, v144
    v_fmac_f32 v149, v147, v146
    v_rcp_f32 v149, v149
    s_nop 0
    v_mul_f32 v144, v144, v149
    v_mul_f32 v146, v146, v149
    v_mul_f32 v112, v112, v144
    v_fmac_f32 v112, v128, v146
    v_mul_f32 v113, v113, v144
    v_fmac_f32 v113, v129, v146
    v_mul_f32 v114, v114, v144
    v_fmac_f32 v114, v130, v146
    v_mul_f32 v115, v115, v144
    v_fmac_f32 v115, v131, v146
    v_mul_f32 v116, v116, v144
    v_fmac_f32 v116, v132, v146
    v_mul_f32 v117, v117, v144
    v_fmac_f32 v117, v133, v146
    v_mul_f32 v118, v118, v144
    v_fmac_f32 v118, v134, v146
    v_mul_f32 v119, v119, v144
    v_fmac_f32 v119, v135, v146
    v_mul_f32 v120, v120, v144
    v_fmac_f32 v120, v136, v146
    v_mul_f32 v121, v121, v144
    v_fmac_f32 v121, v137, v146
    v_mul_f32 v122, v122, v144
    v_fmac_f32 v122, v138, v146
    v_mul_f32 v123, v123, v144
    v_fmac_f32 v123, v139, v146
    v_mul_f32 v124, v124, v144
    v_fmac_f32 v124, v140, v146
    v_mul_f32 v125, v125, v144
    v_fmac_f32 v125, v141, v146
    v_mul_f32 v126, v126, v144
    v_fmac_f32 v126, v142, v146
    v_mul_f32 v127, v127, v144
    v_fmac_f32 v127, v143, v146
    v_cvt_pk_bf16_f32 v40, v112, v113
    v_cvt_pk_bf16_f32 v41, v114, v115
    v_cvt_pk_bf16_f32 v42, v116, v117
    v_cvt_pk_bf16_f32 v43, v118, v119
    v_cvt_pk_bf16_f32 v44, v120, v121
    v_cvt_pk_bf16_f32 v45, v122, v123
    v_cvt_pk_bf16_f32 v46, v124, v125
    v_cvt_pk_bf16_f32 v47, v126, v127
    s_mul_i32 s42, s5, 36864
    s_mul_i32 s43, s4, 18432
    s_add_u32 s42, s42, s43
    s_add_u32 s42, s42, 8192
    s_add_u32 s43, s42, 9216
    s_lshl_b32 s41, s4, 12
    v_add_u32 v25, s41, v8
    ds_write_b128 v25, v[40:43]
    ds_write_b128 v25, v[44:47] offset:2048
    buffer_store_dwordx4 v[40:43], v7, s[24:27], s42 offen sc0 sc1
    v_mfma_f32_16x16x32_bf16 a[236:239], a[244:247], v[196:199], a[236:239]
    v_accvgpr_read_b32 v28, a232
    v_mfma_f32_16x16x32_bf16 a[96:99], a[192:195], v[196:199], a[96:99]
    v_rcp_f32 v28, v28
    v_mfma_f32_16x16x32_bf16 a[100:103], a[196:199], v[196:199], a[100:103]
    v_accvgpr_read_b32 v32, a64
    v_accvgpr_read_b32 v33, a65
    v_mfma_f32_16x16x32_bf16 a[104:107], a[200:203], v[196:199], a[104:107]
    v_accvgpr_read_b32 v34, a66
    v_accvgpr_read_b32 v35, a67
    v_mfma_f32_16x16x32_bf16 a[108:111], a[204:207], v[196:199], a[108:111]
    v_accvgpr_read_b32 v36, a68
    v_accvgpr_read_b32 v37, a69
    v_mfma_f32_16x16x32_bf16 a[112:115], a[208:211], v[196:199], a[112:115]
    v_accvgpr_read_b32 v38, a70
    v_accvgpr_read_b32 v39, a71
    v_mfma_f32_16x16x32_bf16 a[116:119], a[212:215], v[196:199], a[116:119]
    v_mul_f32 v32, v32, v28
    v_mul_f32 v33, v33, v28
    v_mfma_f32_16x16x32_bf16 a[120:123], a[216:219], v[196:199], a[120:123]
    v_mul_f32 v34, v34, v28
    v_mul_f32 v35, v35, v28
    v_mfma_f32_16x16x32_bf16 a[124:127], a[220:223], v[196:199], a[124:127]
    v_mul_f32 v36, v36, v28
    v_mul_f32 v37, v37, v28
    s_cmp_lg_u64 s[30:31], 0
    s_cbranch_scc1 L_tslow3
L_tback3:
    v_mfma_f32_16x16x32_bf16 a[236:239], a[244:247], v[216:219], a[236:239]
    v_mul_f32 v38, v38, v28
    v_mul_f32 v39, v39, v28
    v_mfma_f32_16x16x32_bf16 a[96:99], a[160:163], v[216:219], a[96:99]
    s_add_u32 s44, s38, 0
    v_cvt_pk_bf16_f32 v56, v32, v33
    v_cvt_pk_bf16_f32 v57, v34, v35
    v_mfma_f32_16x16x32_bf16 a[100:103], a[164:167], v[216:219], a[100:103]
    v_cvt_pk_bf16_f32 v58, v36, v37
    v_cvt_pk_bf16_f32 v59, v38, v39
    v_mfma_f32_16x16x32_bf16 a[104:107], a[168:171], v[216:219], a[104:107]
    buffer_store_dwordx4 v[56:59], v7, s[24:27], s44 offen sc0 sc1
    v_mfma_f32_16x16x32_bf16 a[108:111], a[172:175], v[216:219], a[108:111]
    v_accvgpr_read_b32 v32, a72
    v_accvgpr_read_b32 v33, a73
    v_mfma_f32_16x16x32_bf16 a[112:115], a[176:179], v[216:219], a[112:115]
    v_accvgpr_read_b32 v34, a74
    v_accvgpr_read_b32 v35, a75
    v_mfma_f32_16x16x32_bf16 a[116:119], a[180:183], v[216:219], a[116:119]
    v_accvgpr_read_b32 v36, a76
    v_accvgpr_read_b32 v37, a77
    v_mfma_f32_16x16x32_bf16 a[120:123], a[184:187], v[216:219], a[120:123]
    v_accvgpr_read_b32 v38, a78
    v_accvgpr_read_b32 v39, a79
    v_mfma_f32_16x16x32_bf16 a[124:127], a[188:191], v[216:219], a[124:127]
    v_mul_f32 v32, v32, v28
    v_mul_f32 v33, v33, v28
    v_mul_f32 v34, v34, v28
    v_mul_f32 v35, v35, v28
    v_mul_f32 v36, v36, v28
    v_mul_f32 v37, v37, v28
    v_mul_f32 v38, v38, v28
    v_mul_f32 v39, v39, v28
    s_add_u32 s44, s38, 9216
    v_cvt_pk_bf16_f32 v72, v32, v33
    v_cvt_pk_bf16_f32 v73, v34, v35
    v_cvt_pk_bf16_f32 v74, v36, v37
    v_cvt_pk_bf16_f32 v75, v38, v39
    buffer_store_dwordx4 v[72:75], v7, s[24:27], s44 offen sc0 sc1
    v_accvgpr_read_b32 v32, a80
    v_accvgpr_read_b32 v33, a81
    v_accvgpr_read_b32 v34, a82
    v_accvgpr_read_b32 v35, a83
    v_accvgpr_read_b32 v36, a84
    v_accvgpr_read_b32 v37, a85
    v_accvgpr_read_b32 v38, a86
    v_accvgpr_read_b32 v39, a87
    v_mul_f32 v32, v32, v28
    v_mul_f32 v33, v33, v28
    v_mul_f32 v34, v34, v28
    v_mul_f32 v35, v35, v28
    v_mul_f32 v36, v36, v28
    v_mul_f32 v37, v37, v28
    v_mul_f32 v38, v38, v28
    v_mul_f32 v39, v39, v28
    s_add_u32 s44, s38, 18432
    v_cvt_pk_bf16_f32 v88, v32, v33
    v_cvt_pk_bf16_f32 v89, v34, v35
    v_cvt_pk_bf16_f32 v90, v36, v37
    v_cvt_pk_bf16_f32 v91, v38, v39
    buffer_store_dwordx4 v[88:91], v7, s[24:27], s44 offen sc0 sc1
    v_accvgpr_read_b32 v32, a88
    v_accvgpr_read_b32 v33, a89
    v_accvgpr_read_b32 v34, a90
    v_accvgpr_read_b32 v35, a91
    v_accvgpr_read_b32 v36, a92
    v_accvgpr_read_b32 v37, a93
    v_accvgpr_read_b32 v38, a94
    v_accvgpr_read_b32 v39, a95
    v_mul_f32 v32, v32, v28
    v_mul_f32 v33, v33, v28
    v_mul_f32 v34, v34, v28
    v_mul_f32 v35, v35, v28
    v_mul_f32 v36, v36, v28
    v_mul_f32 v37, v37, v28
    v_mul_f32 v38, v38, v28
    v_mul_f32 v39, v39, v28
    s_add_u32 s44, s38, 27648
    v_cvt_pk_bf16_f32 v104, v32, v33
    v_cvt_pk_bf16_f32 v105, v34, v35
    v_cvt_pk_bf16_f32 v106, v36, v37
    v_cvt_pk_bf16_f32 v107, v38, v39
    buffer_store_dwordx4 v[104:107], v7, s[24:27], s44 offen sc0 sc1
    s_waitcnt lgkmcnt(0)
    s_barrier
    v_accvgpr_read_b32 v29, a236
    v_rcp_f32 v29, v29
    v_accvgpr_read_b32 v32, a96
    v_accvgpr_read_b32 v33, a97
    v_accvgpr_read_b32 v34, a98
    v_accvgpr_read_b32 v35, a99
    v_accvgpr_read_b32 v36, a100
    v_accvgpr_read_b32 v37, a101
    v_accvgpr_read_b32 v38, a102
    v_accvgpr_read_b32 v39, a103
    v_pk_mul_f32 v[32:33], v[32:33], v[28:29] op_sel:[0,1] op_sel_hi:[1,1]
    v_pk_mul_f32 v[34:35], v[34:35], v[28:29] op_sel:[0,1] op_sel_hi:[1,1]
    v_pk_mul_f32 v[36:37], v[36:37], v[28:29] op_sel:[0,1] op_sel_hi:[1,1]
    v_pk_mul_f32 v[38:39], v[38:39], v[28:29] op_sel:[0,1] op_sel_hi:[1,1]
    s_add_u32 s44, s39, 0
    v_cvt_pk_bf16_f32 v60, v32, v33
    v_cvt_pk_bf16_f32 v61, v34, v35
    v_cvt_pk_bf16_f32 v62, v36, v37
    v_cvt_pk_bf16_f32 v63, v38, v39
    buffer_store_dwordx4 v[60:63], v7, s[24:27], s44 offen sc0 sc1
    ds_read_b128 a[32:35], v8 offset:0
    ds_read_b64_tr_b16 a[0:1], v14 offset:0
    ds_read_b64_tr_b16 a[2:3], v14 offset:4096
    ds_read_b64_tr_b16 a[4:5], v16 offset:0
    ds_read_b64_tr_b16 a[6:7], v16 offset:4096
    ds_read_b64_tr_b16 a[8:9], v14 offset:256
    v_accvgpr_read_b32 v32, a104
    v_accvgpr_read_b32 v33, a105
    v_accvgpr_read_b32 v34, a106
    v_accvgpr_read_b32 v35, a107
    v_accvgpr_read_b32 v36, a108
    v_accvgpr_read_b32 v37, a109
    v_accvgpr_read_b32 v38, a110
    v_accvgpr_read_b32 v39, a111
    v_pk_mul_f32 v[32:33], v[32:33], v[28:29] op_sel:[0,1] op_sel_hi:[1,1]
    v_pk_mul_f32 v[34:35], v[34:35], v[28:29] op_sel:[0,1] op_sel_hi:[1,1]
    v_pk_mul_f32 v[36:37], v[36:37], v[28:29] op_sel:[0,1] op_sel_hi:[1,1]
    v_pk_mul_f32 v[38:39], v[38:39], v[28:29] op_sel:[0,1] op_sel_hi:[1,1]
    s_add_u32 s44, s39, 9216
    v_cvt_pk_bf16_f32 v76, v32, v33
    v_cvt_pk_bf16_f32 v77, v34, v35
    v_cvt_pk_bf16_f32 v78, v36, v37
    v_cvt_pk_bf16_f32 v79, v38, v39
    buffer_store_dwordx4 v[76:79], v7, s[24:27], s44 offen sc0 sc1
    buffer_store_dwordx4 v[44:47], v7, s[24:27], s43 offen sc0 sc1
    ds_read_b64_tr_b16 a[10:11], v14 offset:4352
    ds_read_b64_tr_b16 a[12:13], v16 offset:256
    ds_read_b64_tr_b16 a[14:15], v16 offset:4352
    ds_read_b64_tr_b16 a[16:17], v15 offset:0
    ds_read_b64_tr_b16 a[18:19], v15 offset:4096
    ds_read_b64_tr_b16 a[20:21], v17 offset:0
    v_accvgpr_read_b32 v32, a112
    v_accvgpr_read_b32 v33, a113
    v_accvgpr_read_b32 v34, a114
    v_accvgpr_read_b32 v35, a115
    v_accvgpr_read_b32 v36, a116
    v_accvgpr_read_b32 v37, a117
    v_accvgpr_read_b32 v38, a118
    v_accvgpr_read_b32 v39, a119
    v_pk_mul_f32 v[32:33], v[32:33], v[28:29] op_sel:[0,1] op_sel_hi:[1,1]
    v_pk_mul_f32 v[34:35], v[34:35], v[28:29] op_sel:[0,1] op_sel_hi:[1,1]
    v_pk_mul_f32 v[36:37], v[36:37], v[28:29] op_sel:[0,1] op_sel_hi:[1,1]
    v_pk_mul_f32 v[38:39], v[38:39], v[28:29] op_sel:[0,1] op_sel_hi:[1,1]
    s_add_u32 s44, s39, 18432
    v_cvt_pk_bf16_f32 v92, v32, v33
    v_cvt_pk_bf16_f32 v93, v34, v35
    v_cvt_pk_bf16_f32 v94, v36, v37
    v_cvt_pk_bf16_f32 v95, v38, v39
    buffer_store_dwordx4 v[92:95], v7, s[24:27], s44 offen sc0 sc1
    ds_read_b64_tr_b16 a[22:23], v17 offset:4096
    ds_read_b64_tr_b16 a[24:25], v15 offset:256
    ds_read_b64_tr_b16 a[26:27], v15 offset:4352
    ds_read_b64_tr_b16 a[28:29], v17 offset:256
    ds_read_b64_tr_b16 a[30:31], v17 offset:4352
    v_accvgpr_read_b32 v32, a120
    v_accvgpr_read_b32 v33, a121
    v_accvgpr_read_b32 v34, a122
    v_accvgpr_read_b32 v35, a123
    v_accvgpr_read_b32 v36, a124
    v_accvgpr_read_b32 v37, a125
    v_accvgpr_read_b32 v38, a126
    v_accvgpr_read_b32 v39, a127
    v_pk_mul_f32 v[32:33], v[32:33], v[28:29] op_sel:[0,1] op_sel_hi:[1,1]
    v_pk_mul_f32 v[34:35], v[34:35], v[28:29] op_sel:[0,1] op_sel_hi:[1,1]
    v_pk_mul_f32 v[36:37], v[36:37], v[28:29] op_sel:[0,1] op_sel_hi:[1,1]
    v_pk_mul_f32 v[38:39], v[38:39], v[28:29] op_sel:[0,1] op_sel_hi:[1,1]
    s_add_u32 s44, s39, 27648
    v_cvt_pk_bf16_f32 v108, v32, v33
    v_cvt_pk_bf16_f32 v109, v34, v35
    v_cvt_pk_bf16_f32 v110, v36, v37
    v_cvt_pk_bf16_f32 v111, v38, v39
    buffer_store_dwordx4 v[108:111], v7, s[24:27], s44 offen sc0 sc1
    v_subrev_u32 v22, 4, v20
    s_mov_b32 s42, 3
    s_waitcnt lgkmcnt(0)
    v_mfma_f32_16x16x32_bf16 v[112:115], a[0:3], v[48:51], 0
    s_add_u32 s42, s42, 1
    ds_read_b128 a[68:71], v8 offset:2048
    v_mfma_f32_16x16x32_bf16 v[116:119], a[0:3], v[52:55], 0
    s_add_u32 s45, s42, s46
    ds_read_b64_tr_b16 a[36:37], v14 offset:16384
    v_mfma_f32_16x16x32_bf16 v[120:123], a[0:3], v[56:59], 0
    s_cmp_lt_u32 s42, 8
    ds_read_b64_tr_b16 a[38:39], v14 offset:20480
    v_mfma_f32_16x16x32_bf16 v[124:127], a[0:3], v[60:63], 0
    s_cselect_b32 s41, 3, 7
    ds_read_b64_tr_b16 a[40:41], v16 offset:16384
    v_mfma_f32_16x16x32_bf16 v[240:243], a[0:3], a[32:35], 0
    s_and_b32 s45, s45, s41
    ds_read_b64_tr_b16 a[42:43], v16 offset:20480
    v_mfma_f32_16x16x32_bf16 v[244:247], a[4:7], a[32:35], 0
    s_andn2_b32 s41, s42, s41
    ds_read_b64_tr_b16 a[44:45], v14 offset:16640
    v_mfma_f32_16x16x32_bf16 v[140:143], a[4:7], v[60:63], 0
    s_add_u32 s45, s45, s41
    ds_read_b64_tr_b16 a[46:47], v14 offset:20736
    v_mfma_f32_16x16x32_bf16 v[136:139], a[4:7], v[56:59], 0
    s_cmp_lt_u32 s45, s47
    ds_read_b64_tr_b16 a[48:49], v16 offset:16640
    v_mfma_f32_16x16x32_bf16 v[132:135], a[4:7], v[52:55], 0
    s_cselect_b32 s41, 4, 0
    ds_read_b64_tr_b16 a[50:51], v16 offset:20736
    v_mfma_f32_16x16x32_bf16 v[128:131], a[4:7], v[48:51], 0
    s_sub_u32 s45, s45, s41
    ds_read_b64_tr_b16 a[52:53], v15 offset:16384
    v_mfma_f32_16x16x32_bf16 v[144:147], a[8:11], v[48:51], 0
    s_xor_b32 s45, s45, s7
    ds_read_b64_tr_b16 a[54:55], v15 offset:20480
    v_mfma_f32_16x16x32_bf16 v[148:151], a[8:11], v[52:55], 0
    s_cmp_ge_u32 s42, 32
    ds_read_b64_tr_b16 a[56:57], v17 offset:16384
    v_mfma_f32_16x16x32_bf16 v[152:155], a[8:11], v[56:59], 0
    s_cselect_b32 s36, 64, s45
    ds_read_b64_tr_b16 a[58:59], v17 offset:20480
    v_mfma_f32_16x16x32_bf16 v[156:159], a[8:11], v[60:63], 0
    s_lshl_b32 s28, s36, 17
    ds_read_b64_tr_b16 a[60:61], v15 offset:16640
    v_mfma_f32_16x16x32_bf16 v[248:251], a[8:11], a[32:35], 0
    s_mul_i32 s36, s36, 18432
    ds_read_b64_tr_b16 a[62:63], v15 offset:20736
    v_mfma_f32_16x16x32_bf16 v[252:255], a[12:15], a[32:35], 0
    s_add_u32 s42, s42, 1
    ds_read_b64_tr_b16 a[64:65], v17 offset:16640
    v_mfma_f32_16x16x32_bf16 v[172:175], a[12:15], v[60:63], 0
    s_add_u32 s45, s42, s46
    ds_read_b64_tr_b16 a[66:67], v17 offset:20736
    v_mfma_f32_16x16x32_bf16 v[168:171], a[12:15], v[56:59], 0
    s_cmp_lt_u32 s42, 8
    s_cselect_b32 s41, 3, 7
    s_and_b32 s45, s45, s41
    v_mfma_f32_16x16x32_bf16 v[164:167], a[12:15], v[52:55], 0
    s_andn2_b32 s41, s42, s41
    s_add_u32 s45, s45, s41
    s_cmp_lt_u32 s45, s47
    v_mfma_f32_16x16x32_bf16 v[160:163], a[12:15], v[48:51], 0
    s_cselect_b32 s41, 4, 0
    s_sub_u32 s45, s45, s41
    s_xor_b32 s45, s45, s7
    v_mfma_f32_16x16x32_bf16 v[176:179], a[16:19], v[48:51], 0
    s_cmp_ge_u32 s42, 32
    s_cselect_b32 s37, 64, s45
    s_lshl_b32 s29, s37, 17
    v_mfma_f32_16x16x32_bf16 v[180:183], a[16:19], v[52:55], 0
    s_mul_i32 s37, s37, 18432
    v_mfma_f32_16x16x32_bf16 v[184:187], a[16:19], v[56:59], 0
    v_mfma_f32_16x16x32_bf16 v[188:191], a[16:19], v[60:63], 0
    v_mfma_f32_16x16x32_bf16 v[204:207], a[20:23], v[60:63], 0
    v_mfma_f32_16x16x32_bf16 v[200:203], a[20:23], v[56:59], 0
    v_mfma_f32_16x16x32_bf16 v[196:199], a[20:23], v[52:55], 0
    v_mfma_f32_16x16x32_bf16 v[192:195], a[20:23], v[48:51], 0
    v_mfma_f32_16x16x32_bf16 v[208:211], a[24:27], v[48:51], 0
    v_mfma_f32_16x16x32_bf16 v[212:215], a[24:27], v[52:55], 0
    v_mfma_f32_16x16x32_bf16 v[216:219], a[24:27], v[56:59], 0
    v_mfma_f32_16x16x32_bf16 v[220:223], a[24:27], v[60:63], 0
    v_mfma_f32_16x16x32_bf16 v[236:239], a[28:31], v[60:63], 0
    v_mfma_f32_16x16x32_bf16 v[232:235], a[28:31], v[56:59], 0
    v_mfma_f32_16x16x32_bf16 v[228:231], a[28:31], v[52:55], 0
    v_mfma_f32_16x16x32_bf16 v[224:227], a[28:31], v[48:51], 0
    s_waitcnt lgkmcnt(0)
    v_mfma_f32_16x16x32_bf16 v[112:115], a[36:39], v[64:67], v[112:115]
    s_add_u32 s42, s42, 1
    ds_read_b128 a[32:35], v8 offset:4096
    v_mfma_f32_16x16x32_bf16 v[116:119], a[36:39], v[68:71], v[116:119]
    s_add_u32 s45, s42, s46
    ds_read_b64_tr_b16 a[0:1], v14 offset:32768
    v_mfma_f32_16x16x32_bf16 v[120:123], a[36:39], v[72:75], v[120:123]
    s_cmp_lt_u32 s42, 8
    ds_read_b64_tr_b16 a[2:3], v14 offset:36864
    v_mfma_f32_16x16x32_bf16 v[124:127], a[36:39], v[76:79], v[124:127]
    s_cselect_b32 s41, 3, 7
    ds_read_b64_tr_b16 a[4:5], v16 offset:32768
    v_mfma_f32_16x16x32_bf16 v[240:243], a[36:39], a[68:71], v[240:243]
    s_and_b32 s45, s45, s41
    ds_read_b64_tr_b16 a[6:7], v16 offset:36864
    v_mfma_f32_16x16x32_bf16 v[244:247], a[40:43], a[68:71], v[244:247]
    s_andn2_b32 s41, s42, s41
    ds_read_b64_tr_b16 a[8:9], v14 offset:33024
    v_mfma_f32_16x16x32_bf16 v[140:143], a[40:43], v[76:79], v[140:143]
    s_add_u32 s45, s45, s41
    ds_read_b64_tr_b16 a[10:11], v14 offset:37120
    v_mfma_f32_16x16x32_bf16 v[136:139], a[40:43], v[72:75], v[136:139]
    s_cmp_lt_u32 s45, s47
    ds_read_b64_tr_b16 a[12:13], v16 offset:33024
    v_mfma_f32_16x16x32_bf16 v[132:135], a[40:43], v[68:71], v[132:135]
    s_cselect_b32 s41, 4, 0
    ds_read_b64_tr_b16 a[14:15], v16 offset:37120
    v_mfma_f32_16x16x32_bf16 v[128:131], a[40:43], v[64:67], v[128:131]
    s_sub_u32 s45, s45, s41
    ds_read_b64_tr_b16 a[16:17], v15 offset:32768
    v_mfma_f32_16x16x32_bf16 v[144:147], a[44:47], v[64:67], v[144:147]
    s_xor_b32 s45, s45, s7
    ds_read_b64_tr_b16 a[18:19], v15 offset:36864
    v_mfma_f32_16x16x32_bf16 v[148:151], a[44:47], v[68:71], v[148:151]
    s_cmp_ge_u32 s42, 32
    ds_read_b64_tr_b16 a[20:21], v17 offset:32768
    v_mfma_f32_16x16x32_bf16 v[152:155], a[44:47], v[72:75], v[152:155]
    s_cselect_b32 s38, 64, s45
    ds_read_b64_tr_b16 a[22:23], v17 offset:36864
    v_mfma_f32_16x16x32_bf16 v[156:159], a[44:47], v[76:79], v[156:159]
    s_lshl_b32 s30, s38, 17
    ds_read_b64_tr_b16 a[24:25], v15 offset:33024
    v_mfma_f32_16x16x32_bf16 v[248:251], a[44:47], a[68:71], v[248:251]
    s_mul_i32 s38, s38, 18432
    ds_read_b64_tr_b16 a[26:27], v15 offset:37120
    v_mfma_f32_16x16x32_bf16 v[252:255], a[48:51], a[68:71], v[252:255]
    s_add_u32 s42, s42, 1
    ds_read_b64_tr_b16 a[28:29], v17 offset:33024
    v_mfma_f32_16x16x32_bf16 v[172:175], a[48:51], v[76:79], v[172:175]
    s_add_u32 s45, s42, s46
    ds_read_b64_tr_b16 a[30:31], v17 offset:37120
    v_mfma_f32_16x16x32_bf16 v[168:171], a[48:51], v[72:75], v[168:171]
    s_cmp_lt_u32 s42, 8
    s_cselect_b32 s41, 3, 7
    s_and_b32 s45, s45, s41
    v_mfma_f32_16x16x32_bf16 v[164:167], a[48:51], v[68:71], v[164:167]
    s_andn2_b32 s41, s42, s41
    s_add_u32 s45, s45, s41
    s_cmp_lt_u32 s45, s47
    v_mfma_f32_16x16x32_bf16 v[160:163], a[48:51], v[64:67], v[160:163]
    s_cselect_b32 s41, 4, 0
    s_sub_u32 s45, s45, s41
    s_xor_b32 s45, s45, s7
    v_mfma_f32_16x16x32_bf16 v[176:179], a[52:55], v[64:67], v[176:179]
    s_cmp_ge_u32 s42, 32
    s_cselect_b32 s39, 64, s45
    s_lshl_b32 s31, s39, 17
    v_mfma_f32_16x16x32_bf16 v[180:183], a[52:55], v[68:71], v[180:183]
    s_mul_i32 s39, s39, 18432
    v_mfma_f32_16x16x32_bf16 v[184:187], a[52:55], v[72:75], v[184:187]
    v_mfma_f32_16x16x32_bf16 v[188:191], a[52:55], v[76:79], v[188:191]
    v_mfma_f32_16x16x32_bf16 v[204:207], a[56:59], v[76:79], v[204:207]
    v_mfma_f32_16x16x32_bf16 v[200:203], a[56:59], v[72:75], v[200:203]
    v_mfma_f32_16x16x32_bf16 v[196:199], a[56:59], v[68:71], v[196:199]
    v_mfma_f32_16x16x32_bf16 v[192:195], a[56:59], v[64:67], v[192:195]
    v_mfma_f32_16x16x32_bf16 v[208:211], a[60:63], v[64:67], v[208:211]
    v_mfma_f32_16x16x32_bf16 v[212:215], a[60:63], v[68:71], v[212:215]
    v_mfma_f32_16x16x32_bf16 v[216:219], a[60:63], v[72:75], v[216:219]
    v_mfma_f32_16x16x32_bf16 v[220:223], a[60:63], v[76:79], v[220:223]
    v_mfma_f32_16x16x32_bf16 v[236:239], a[64:67], v[76:79], v[236:239]
    v_mfma_f32_16x16x32_bf16 v[232:235], a[64:67], v[72:75], v[232:235]
    v_mfma_f32_16x16x32_bf16 v[228:231], a[64:67], v[68:71], v[228:231]
    v_mfma_f32_16x16x32_bf16 v[224:227], a[64:67], v[64:67], v[224:227]
    s_waitcnt vmcnt(0) lgkmcnt(0)
    s_barrier
    s_cmp_lg_u32 s3, 0
    s_cbranch_scc1 L_nosig
    s_cmp_ge_u32 s100, 16
    s_cbranch_scc1 L_inited
    s_bfe_u32 s60, s2, 0x10002
    s_lshl_b32 s60, s60, 3
    s_lshr_b32 s61, s2, 5
    s_add_u32 s60, s60, s61
    s_lshl_b32 s60, s60, 4
    v_mov_b32 v28, 0
    s_mov_b64 exec, 1
    s_mov_b32 s62, 0x100000
L_p0:
    buffer_load_dword v23, v28, s[56:59], s60 offen sc1
    s_waitcnt vmcnt(0)
    v_readfirstlane_b32 s63, v23
    s_sub_u32 s62, s62, 1
    s_cmp_eq_u32 s62, 0
    s_cbranch_scc1 L_p0_x
    s_cmp_ge_u32 s63, 16
    s_cbranch_scc1 L_p0_x
    s_branch L_p0
L_p0_x:
    s_mov_b64 exec, -1
L_inited:
    v_mov_b32 v23, 1
    s_mov_b64 exec, 0xff
    buffer_atomic_add v23, v19, s[20:23], 0 offen sc1
    s_mov_b64 exec, -1
L_nosig:
    s_add_u32 m0, s6, 98304
    s_nop 0
    buffer_load_dwordx4 v9, s[12:15], s28 offen offset:0 lds
    s_add_u32 s95, s28, 7168
    buffer_load_dwordx4 v10, s[12:15], s95 offen offset:1024 lds
    s_add_u32 s96, s28, 14336
    buffer_load_dwordx4 v9, s[12:15], s96 offen offset:2048 lds
    s_add_u32 s97, s28, 21504
    buffer_load_dwordx4 v10, s[12:15], s97 offen offset:3072 lds
    s_add_u32 m0, s6, 114688
    s_nop 0
    buffer_load_dwordx4 v9, s[12:15], s29 offen offset:0 lds
    s_add_u32 s90, s29, 7168
    buffer_load_dwordx4 v10, s[12:15], s90 offen offset:1024 lds
    s_add_u32 s91, s29, 14336
    buffer_load_dwordx4 v9, s[12:15], s91 offen offset:2048 lds
    s_add_u32 s92, s29, 21504
    buffer_load_dwordx4 v10, s[12:15], s92 offen offset:3072 lds
    s_add_u32 m0, s6, 131072
    s_nop 0
    buffer_load_dwordx4 v9, s[12:15], s30 offen offset:0 lds
    s_add_u32 s93, s30, 7168
    buffer_load_dwordx4 v10, s[12:15], s93 offen offset:1024 lds
    s_add_u32 s94, s30, 14336
    buffer_load_dwordx4 v9, s[12:15], s94 offen offset:2048 lds
    s_add_u32 s95, s30, 21504
    buffer_load_dwordx4 v10, s[12:15], s95 offen offset:3072 lds
    s_cmp_lg_u32 s3, 1
    s_cbranch_scc1 L_w1
    s_lshl_b32 s60, s2, 8
    v_mov_b32 v28, 0
    s_mov_b64 exec, 1
    s_mov_b32 s62, 0x100000
L_p1:
    buffer_load_dword v23, v28, s[20:23], s60 offen sc1
    s_waitcnt vmcnt(0)
    v_readfirstlane_b32 s63, v23
    s_sub_u32 s62, s62, 1
    s_cmp_eq_u32 s62, 0
    s_cbranch_scc1 L_p1_x
    s_cmp_ge_u32 s63, 3
    s_cbranch_scc1 L_p1_x
    s_branch L_p1
L_p1_x:
    s_mov_b64 exec, -1
L_w1:
    s_barrier
    v_mfma_f32_16x16x32_bf16 v[112:115], a[0:3], v[80:83], v[112:115]
    s_add_u32 m0, s35, 0
    ds_read_b128 a[68:71], v8 offset:6144
    v_mfma_f32_16x16x32_bf16 v[116:119], a[0:3], v[84:87], v[116:119]
    s_mov_b64 exec, s[50:51]
    buffer_load_dwordx4 v6, s[8:11], s36 offen sc1 lds
    s_mov_b64 exec, -1
    v_mfma_f32_16x16x32_bf16 v[120:123], a[0:3], v[88:91], v[120:123]
    s_add_u32 m0, s35, 2048
    ds_read_b64_tr_b16 a[36:37], v14 offset:49152
    v_mfma_f32_16x16x32_bf16 v[124:127], a[0:3], v[92:95], v[124:127]
    s_mov_b64 exec, s[50:51]
    buffer_load_dwordx4 v6, s[8:11], s37 offen sc1 lds
    s_mov_b64 exec, -1
    v_mfma_f32_16x16x32_bf16 v[240:243], a[0:3], a[32:35], v[240:243]
    s_add_u32 m0, s35, 4096
    ds_read_b64_tr_b16 a[38:39], v14 offset:53248
    v_mfma_f32_16x16x32_bf16 v[244:247], a[4:7], a[32:35], v[244:247]
    s_mov_b64 exec, s[50:51]
    buffer_load_dwordx4 v6, s[8:11], s38 offen sc1 lds
    s_mov_b64 exec, -1
    v_mfma_f32_16x16x32_bf16 v[140:143], a[4:7], v[92:95], v[140:143]
    ds_read_b64_tr_b16 a[40:41], v16 offset:49152
    v_mfma_f32_16x16x32_bf16 v[136:139], a[4:7], v[88:91], v[136:139]
    buffer_load_dwordx4 v[48:51], v2, s[8:11], s36 offen sc1
    v_mfma_f32_16x16x32_bf16 v[132:135], a[4:7], v[84:87], v[132:135]
    ds_read_b64_tr_b16 a[42:43], v16 offset:53248
    v_mfma_f32_16x16x32_bf16 v[128:131], a[4:7], v[80:83], v[128:131]
    ds_read_b64_tr_b16 a[44:45], v14 offset:49408
    v_mfma_f32_16x16x32_bf16 v[144:147], a[8:11], v[80:83], v[144:147]
    buffer_load_dwordx4 v[52:55], v3, s[8:11], s36 offen sc1
    v_mfma_f32_16x16x32_bf16 v[148:151], a[8:11], v[84:87], v[148:151]
    ds_read_b64_tr_b16 a[46:47], v14 offset:53504
    v_mfma_f32_16x16x32_bf16 v[152:155], a[8:11], v[88:91], v[152:155]
    ds_read_b64_tr_b16 a[48:49], v16 offset:49408
    v_mfma_f32_16x16x32_bf16 v[156:159], a[8:11], v[92:95], v[156:159]
    buffer_load_dwordx4 v[56:59], v4, s[8:11], s36 offen sc1
    v_mfma_f32_16x16x32_bf16 v[248:251], a[8:11], a[32:35], v[248:251]
    ds_read_b64_tr_b16 a[50:51], v16 offset:53504
    v_mfma_f32_16x16x32_bf16 v[252:255], a[12:15], a[32:35], v[252:255]
    ds_read_b64_tr_b16 a[52:53], v15 offset:49152
    v_mfma_f32_16x16x32_bf16 v[172:175], a[12:15], v[92:95], v[172:175]
    buffer_load_dwordx4 v[60:63], v5, s[8:11], s36 offen sc1
    v_mfma_f32_16x16x32_bf16 v[168:171], a[12:15], v[88:91], v[168:171]
    ds_read_b64_tr_b16 a[54:55], v15 offset:53248
    v_mfma_f32_16x16x32_bf16 v[164:167], a[12:15], v[84:87], v[164:167]
    ds_read_b64_tr_b16 a[56:57], v17 offset:49152
    v_mfma_f32_16x16x32_bf16 v[160:163], a[12:15], v[80:83], v[160:163]
    buffer_load_dwordx4 v[64:67], v2, s[8:11], s37 offen sc1
    v_mfma_f32_16x16x32_bf16 v[176:179], a[16:19], v[80:83], v[176:179]
    ds_read_b64_tr_b16 a[58:59], v17 offset:53248
    v_mfma_f32_16x16x32_bf16 v[180:183], a[16:19], v[84:87], v[180:183]
    ds_read_b64_tr_b16 a[60:61], v15 offset:49408
    v_mfma_f32_16x16x32_bf16 v[184:187], a[16:19], v[88:91], v[184:187]
    buffer_load_dwordx4 v[68:71], v3, s[8:11], s37 offen sc1
    v_mfma_f32_16x16x32_bf16 v[188:191], a[16:19], v[92:95], v[188:191]
    ds_read_b64_tr_b16 a[62:63], v15 offset:53504
    v_mfma_f32_16x16x32_bf16 v[204:207], a[20:23], v[92:95], v[204:207]
    ds_read_b64_tr_b16 a[64:65], v17 offset:49408
    v_mfma_f32_16x16x32_bf16 v[200:203], a[20:23], v[88:91], v[200:203]
    buffer_load_dwordx4 v[72:75], v4, s[8:11], s37 offen sc1
    v_mfma_f32_16x16x32_bf16 v[196:199], a[20:23], v[84:87], v[196:199]
    ds_read_b64_tr_b16 a[66:67], v17 offset:53504
    v_mfma_f32_16x16x32_bf16 v[192:195], a[20:23], v[80:83], v[192:195]
    v_mfma_f32_16x16x32_bf16 v[208:211], a[24:27], v[80:83], v[208:211]
    buffer_load_dwordx4 v[76:79], v5, s[8:11], s37 offen sc1
    v_mfma_f32_16x16x32_bf16 v[212:215], a[24:27], v[84:87], v[212:215]
    v_mfma_f32_16x16x32_bf16 v[216:219], a[24:27], v[88:91], v[216:219]
    v_mfma_f32_16x16x32_bf16 v[220:223], a[24:27], v[92:95], v[220:223]
    v_mfma_f32_16x16x32_bf16 v[236:239], a[28:31], v[92:95], v[236:239]
    v_mfma_f32_16x16x32_bf16 v[232:235], a[28:31], v[88:91], v[232:235]
    v_mfma_f32_16x16x32_bf16 v[228:231], a[28:31], v[84:87], v[228:231]
    v_mfma_f32_16x16x32_bf16 v[224:227], a[28:31], v[80:83], v[224:227]
    s_waitcnt vmcnt(8) lgkmcnt(0)
    s_barrier
    v_mfma_f32_16x16x32_bf16 v[112:115], a[36:39], v[96:99], v[112:115]
    s_add_u32 s42, s42, 1
    ds_read_b128 a[32:35], v8 offset:0
    v_mfma_f32_16x16x32_bf16 v[116:119], a[36:39], v[100:103], v[116:119]
    buffer_load_dwordx4 v[80:83], v2, s[8:11], s38 offen sc1
    v_mfma_f32_16x16x32_bf16 v[120:123], a[36:39], v[104:107], v[120:123]
    s_add_u32 s45, s42, s46
    ds_read_b64_tr_b16 a[0:1], v14 offset:0
    v_mfma_f32_16x16x32_bf16 v[124:127], a[36:39], v[108:111], v[124:127]
    s_cmp_lt_u32 s42, 8
    ds_read_b64_tr_b16 a[2:3], v14 offset:4096
    v_mfma_f32_16x16x32_bf16 v[240:243], a[36:39], a[68:71], v[240:243]
    s_cselect_b32 s41, 3, 7
    ds_read_b64_tr_b16 a[4:5], v16 offset:0
    v_mfma_f32_16x16x32_bf16 v[244:247], a[40:43], a[68:71], v[244:247]
    buffer_load_dwordx4 v[84:87], v3, s[8:11], s38 offen sc1
    v_mfma_f32_16x16x32_bf16 v[140:143], a[40:43], v[108:111], v[140:143]
    s_and_b32 s45, s45, s41
    ds_read_b64_tr_b16 a[6:7], v16 offset:4096
    v_mfma_f32_16x16x32_bf16 v[136:139], a[40:43], v[104:107], v[136:139]
    s_andn2_b32 s41, s42, s41
    ds_read_b64_tr_b16 a[8:9], v14 offset:256
    v_mfma_f32_16x16x32_bf16 v[132:135], a[40:43], v[100:103], v[132:135]
    s_add_u32 s45, s45, s41
    ds_read_b64_tr_b16 a[10:11], v14 offset:4352
    v_mfma_f32_16x16x32_bf16 v[128:131], a[40:43], v[96:99], v[128:131]
    buffer_load_dwordx4 v[88:91], v4, s[8:11], s38 offen sc1
    v_mfma_f32_16x16x32_bf16 v[144:147], a[44:47], v[96:99], v[144:147]
    s_cmp_lt_u32 s45, s47
    ds_read_b64_tr_b16 a[12:13], v16 offset:256
    v_mfma_f32_16x16x32_bf16 v[148:151], a[44:47], v[100:103], v[148:151]
    s_cselect_b32 s41, 4, 0
    ds_read_b64_tr_b16 a[14:15], v16 offset:4352
    v_mfma_f32_16x16x32_bf16 v[152:155], a[44:47], v[104:107], v[152:155]
    s_sub_u32 s45, s45, s41
    ds_read_b64_tr_b16 a[16:17], v15 offset:0
    v_mfma_f32_16x16x32_bf16 v[156:159], a[44:47], v[108:111], v[156:159]
    buffer_load_dwordx4 v[92:95], v5, s[8:11], s38 offen sc1
    v_mfma_f32_16x16x32_bf16 v[248:251], a[44:47], a[68:71], v[248:251]
    s_xor_b32 s45, s45, s7
    ds_read_b64_tr_b16 a[18:19], v15 offset:4096
    v_mfma_f32_16x16x32_bf16 v[252:255], a[48:51], a[68:71], v[252:255]
    ds_read_b64_tr_b16 a[20:21], v17 offset:0
    v_mfma_f32_16x16x32_bf16 v[172:175], a[48:51], v[108:111], v[172:175]
    s_add_u32 m0, s6, 147456
    ds_read_b64_tr_b16 a[22:23], v17 offset:4096
    v_mfma_f32_16x16x32_bf16 v[168:171], a[48:51], v[104:107], v[168:171]
    buffer_load_dwordx4 v9, s[12:15], s31 offen offset:0 lds
    v_mfma_f32_16x16x32_bf16 v[164:167], a[48:51], v[100:103], v[164:167]
    s_cmp_ge_u32 s42, 32
    ds_read_b64_tr_b16 a[24:25], v15 offset:256
    v_mfma_f32_16x16x32_bf16 v[160:163], a[48:51], v[96:99], v[160:163]
    s_cselect_b32 s45, 64, s45
    ds_read_b64_tr_b16 a[26:27], v15 offset:4352
    v_mfma_f32_16x16x32_bf16 v[176:179], a[52:55], v[96:99], v[176:179]
    s_add_u32 s96, s31, 7168
    ds_read_b64_tr_b16 a[28:29], v17 offset:256
    v_mfma_f32_16x16x32_bf16 v[180:183], a[52:55], v[100:103], v[180:183]
    buffer_load_dwordx4 v10, s[12:15], s96 offen offset:1024 lds
    v_mfma_f32_16x16x32_bf16 v[184:187], a[52:55], v[104:107], v[184:187]
    s_lshl_b32 s32, s45, 17
    ds_read_b64_tr_b16 a[30:31], v17 offset:4352
    v_mfma_f32_16x16x32_bf16 v[188:191], a[52:55], v[108:111], v[188:191]
    s_mul_i32 s44, s45, 18432
    s_mov_b32 s43, s39
    v_mfma_f32_16x16x32_bf16 v[204:207], a[56:59], v[108:111], v[204:207]
    s_add_u32 s97, s31, 14336
    v_mfma_f32_16x16x32_bf16 v[200:203], a[56:59], v[104:107], v[200:203]
    buffer_load_dwordx4 v9, s[12:15], s97 offen offset:2048 lds
    v_mfma_f32_16x16x32_bf16 v[196:199], a[56:59], v[100:103], v[196:199]
    v_mfma_f32_16x16x32_bf16 v[192:195], a[56:59], v[96:99], v[192:195]
    v_mfma_f32_16x16x32_bf16 v[208:211], a[60:63], v[96:99], v[208:211]
    s_add_u32 s90, s31, 21504
    v_mfma_f32_16x16x32_bf16 v[212:215], a[60:63], v[100:103], v[212:215]
    buffer_load_dwordx4 v10, s[12:15], s90 offen offset:3072 lds
    v_mfma_f32_16x16x32_bf16 v[216:219], a[60:63], v[104:107], v[216:219]
    v_mfma_f32_16x16x32_bf16 v[220:223], a[60:63], v[108:111], v[220:223]
    v_mfma_f32_16x16x32_bf16 v[236:239], a[64:67], v[108:111], v[236:239]
    s_add_u32 m0, s35, 6144
    v_mfma_f32_16x16x32_bf16 v[232:235], a[64:67], v[104:107], v[232:235]
    s_mov_b64 exec, s[50:51]
    buffer_load_dwordx4 v6, s[8:11], s39 offen sc1 lds
    s_mov_b64 exec, -1
    v_mfma_f32_16x16x32_bf16 v[228:231], a[64:67], v[100:103], v[228:231]
    v_mfma_f32_16x16x32_bf16 v[224:227], a[64:67], v[96:99], v[224:227]
    s_waitcnt vmcnt(13) lgkmcnt(0)
    s_barrier
    s_mov_b32 s40, 6
.p2align 6
L_ploop:
    v_mfma_f32_16x16x32_bf16 v[112:115], a[0:3], v[48:51], v[112:115]
    s_add_u32 s42, s42, 1
    ds_read_b128 a[68:71], v8 offset:2048
    v_mfma_f32_16x16x32_bf16 v[116:119], a[0:3], v[52:55], v[116:119]
    buffer_load_dwordx4 v[96:99], v2, s[8:11], s43 offen sc1
    v_mfma_f32_16x16x32_bf16 v[120:123], a[0:3], v[56:59], v[120:123]
    s_add_u32 s45, s42, s46
    ds_read_b64_tr_b16 a[36:37], v14 offset:16384
    v_mfma_f32_16x16x32_bf16 v[124:127], a[0:3], v[60:63], v[124:127]
    s_cmp_lt_u32 s42, 8
    ds_read_b64_tr_b16 a[38:39], v14 offset:20480
    v_mfma_f32_16x16x32_bf16 v[240:243], a[0:3], a[32:35], v[240:243]
    s_cselect_b32 s41, 3, 7
    ds_read_b64_tr_b16 a[40:41], v16 offset:16384
    v_mfma_f32_16x16x32_bf16 v[244:247], a[4:7], a[32:35], v[244:247]
    buffer_load_dwordx4 v[100:103], v3, s[8:11], s43 offen sc1
    v_mfma_f32_16x16x32_bf16 v[140:143], a[4:7], v[60:63], v[140:143]
    s_and_b32 s45, s45, s41
    ds_read_b64_tr_b16 a[42:43], v16 offset:20480
    v_mfma_f32_16x16x32_bf16 v[136:139], a[4:7], v[56:59], v[136:139]
    s_andn2_b32 s41, s42, s41
    ds_read_b64_tr_b16 a[44:45], v14 offset:16640
    v_mfma_f32_16x16x32_bf16 v[132:135], a[4:7], v[52:55], v[132:135]
    s_add_u32 s45, s45, s41
    ds_read_b64_tr_b16 a[46:47], v14 offset:20736
    v_mfma_f32_16x16x32_bf16 v[128:131], a[4:7], v[48:51], v[128:131]
    buffer_load_dwordx4 v[104:107], v4, s[8:11], s43 offen sc1
    v_mfma_f32_16x16x32_bf16 v[144:147], a[8:11], v[48:51], v[144:147]
    s_cmp_lt_u32 s45, s47
    ds_read_b64_tr_b16 a[48:49], v16 offset:16640
    v_mfma_f32_16x16x32_bf16 v[148:151], a[8:11], v[52:55], v[148:151]
    s_cselect_b32 s41, 4, 0
    ds_read_b64_tr_b16 a[50:51], v16 offset:20736
    v_mfma_f32_16x16x32_bf16 v[152:155], a[8:11], v[56:59], v[152:155]
    s_sub_u32 s45, s45, s41
    ds_read_b64_tr_b16 a[52:53], v15 offset:16384
    v_mfma_f32_16x16x32_bf16 v[156:159], a[8:11], v[60:63], v[156:159]
    buffer_load_dwordx4 v[108:111], v5, s[8:11], s43 offen sc1
    v_mfma_f32_16x16x32_bf16 v[248:251], a[8:11], a[32:35], v[248:251]
    s_xor_b32 s45, s45, s7
    ds_read_b64_tr_b16 a[54:55], v15 offset:20480
    v_mfma_f32_16x16x32_bf16 v[252:255], a[12:15], a[32:35], v[252:255]
    s_mov_b32 s43, s44
    ds_read_b64_tr_b16 a[56:57], v17 offset:16384
    v_mfma_f32_16x16x32_bf16 v[172:175], a[12:15], v[60:63], v[172:175]
    s_add_u32 m0, s6, 98304
    ds_read_b64_tr_b16 a[58:59], v17 offset:20480
    v_mfma_f32_16x16x32_bf16 v[168:171], a[12:15], v[56:59], v[168:171]
    buffer_load_dwordx4 v9, s[12:15], s32 offen offset:0 lds
    v_mfma_f32_16x16x32_bf16 v[164:167], a[12:15], v[52:55], v[164:167]
    s_cmp_ge_u32 s42, 32
    ds_read_b64_tr_b16 a[60:61], v15 offset:16640
    v_mfma_f32_16x16x32_bf16 v[160:163], a[12:15], v[48:51], v[160:163]
    s_cselect_b32 s45, 64, s45
    ds_read_b64_tr_b16 a[62:63], v15 offset:20736
    v_mfma_f32_16x16x32_bf16 v[176:179], a[16:19], v[48:51], v[176:179]
    s_add_u32 s91, s32, 7168
    ds_read_b64_tr_b16 a[64:65], v17 offset:16640
    v_mfma_f32_16x16x32_bf16 v[180:183], a[16:19], v[52:55], v[180:183]
    buffer_load_dwordx4 v10, s[12:15], s91 offen offset:1024 lds
    v_mfma_f32_16x16x32_bf16 v[184:187], a[16:19], v[56:59], v[184:187]
    ds_read_b64_tr_b16 a[66:67], v17 offset:20736
    v_mfma_f32_16x16x32_bf16 v[188:191], a[16:19], v[60:63], v[188:191]
    v_mfma_f32_16x16x32_bf16 v[204:207], a[20:23], v[60:63], v[204:207]
    s_add_u32 s92, s32, 14336
    v_mfma_f32_16x16x32_bf16 v[200:203], a[20:23], v[56:59], v[200:203]
    buffer_load_dwordx4 v9, s[12:15], s92 offen offset:2048 lds
    v_mfma_f32_16x16x32_bf16 v[196:199], a[20:23], v[52:55], v[196:199]
    v_mfma_f32_16x16x32_bf16 v[192:195], a[20:23], v[48:51], v[192:195]
    v_mfma_f32_16x16x32_bf16 v[208:211], a[24:27], v[48:51], v[208:211]
    s_add_u32 s93, s32, 21504
    v_mfma_f32_16x16x32_bf16 v[212:215], a[24:27], v[52:55], v[212:215]
    buffer_load_dwordx4 v10, s[12:15], s93 offen offset:3072 lds
    v_mfma_f32_16x16x32_bf16 v[216:219], a[24:27], v[56:59], v[216:219]
    v_mfma_f32_16x16x32_bf16 v[220:223], a[24:27], v[60:63], v[220:223]
    v_mfma_f32_16x16x32_bf16 v[236:239], a[28:31], v[60:63], v[236:239]
    s_add_u32 m0, s35, 0
    v_mfma_f32_16x16x32_bf16 v[232:235], a[28:31], v[56:59], v[232:235]
    s_mov_b64 exec, s[50:51]
    buffer_load_dwordx4 v6, s[8:11], s44 offen sc1 lds
    s_mov_b64 exec, -1
    v_mfma_f32_16x16x32_bf16 v[228:231], a[28:31], v[52:55], v[228:231]
    s_lshl_b32 s32, s45, 17
    s_mul_i32 s44, s45, 18432
    v_mfma_f32_16x16x32_bf16 v[224:227], a[28:31], v[48:51], v[224:227]
    s_waitcnt vmcnt(18) lgkmcnt(0)
    s_barrier
    v_mfma_f32_16x16x32_bf16 v[112:115], a[36:39], v[64:67], v[112:115]
    s_add_u32 s42, s42, 1
    ds_read_b128 a[32:35], v8 offset:4096
    v_mfma_f32_16x16x32_bf16 v[116:119], a[36:39], v[68:71], v[116:119]
    buffer_load_dwordx4 v[48:51], v2, s[8:11], s43 offen sc1
    v_mfma_f32_16x16x32_bf16 v[120:123], a[36:39], v[72:75], v[120:123]
    s_add_u32 s45, s42, s46
    ds_read_b64_tr_b16 a[0:1], v14 offset:32768
    v_mfma_f32_16x16x32_bf16 v[124:127], a[36:39], v[76:79], v[124:127]
    s_cmp_lt_u32 s42, 8
    ds_read_b64_tr_b16 a[2:3], v14 offset:36864
    v_mfma_f32_16x16x32_bf16 v[240:243], a[36:39], a[68:71], v[240:243]
    s_cselect_b32 s41, 3, 7
    ds_read_b64_tr_b16 a[4:5], v16 offset:32768
    v_mfma_f32_16x16x32_bf16 v[244:247], a[40:43], a[68:71], v[244:247]
    buffer_load_dwordx4 v[52:55], v3, s[8:11], s43 offen sc1
    v_mfma_f32_16x16x32_bf16 v[140:143], a[40:43], v[76:79], v[140:143]
    s_and_b32 s45, s45, s41
    ds_read_b64_tr_b16 a[6:7], v16 offset:36864
    v_mfma_f32_16x16x32_bf16 v[136:139], a[40:43], v[72:75], v[136:139]
    s_andn2_b32 s41, s42, s41
    ds_read_b64_tr_b16 a[8:9], v14 offset:33024
    v_mfma_f32_16x16x32_bf16 v[132:135], a[40:43], v[68:71], v[132:135]
    s_add_u32 s45, s45, s41
    ds_read_b64_tr_b16 a[10:11], v14 offset:37120
    v_mfma_f32_16x16x32_bf16 v[128:131], a[40:43], v[64:67], v[128:131]
    buffer_load_dwordx4 v[56:59], v4, s[8:11], s43 offen sc1
    v_mfma_f32_16x16x32_bf16 v[144:147], a[44:47], v[64:67], v[144:147]
    s_cmp_lt_u32 s45, s47
    ds_read_b64_tr_b16 a[12:13], v16 offset:33024
    v_mfma_f32_16x16x32_bf16 v[148:151], a[44:47], v[68:71], v[148:151]
    s_cselect_b32 s41, 4, 0
    ds_read_b64_tr_b16 a[14:15], v16 offset:37120
    v_mfma_f32_16x16x32_bf16 v[152:155], a[44:47], v[72:75], v[152:155]
    s_sub_u32 s45, s45, s41
    ds_read_b64_tr_b16 a[16:17], v15 offset:32768
    v_mfma_f32_16x16x32_bf16 v[156:159], a[44:47], v[76:79], v[156:159]
    buffer_load_dwordx4 v[60:63], v5, s[8:11], s43 offen sc1
    v_mfma_f32_16x16x32_bf16 v[248:251], a[44:47], a[68:71], v[248:251]
    s_xor_b32 s45, s45, s7
    ds_read_b64_tr_b16 a[18:19], v15 offset:36864
    v_mfma_f32_16x16x32_bf16 v[252:255], a[48:51], a[68:71], v[252:255]
    s_mov_b32 s43, s44
    ds_read_b64_tr_b16 a[20:21], v17 offset:32768
    v_mfma_f32_16x16x32_bf16 v[172:175], a[48:51], v[76:79], v[172:175]
    s_add_u32 m0, s6, 114688
    ds_read_b64_tr_b16 a[22:23], v17 offset:36864
    v_mfma_f32_16x16x32_bf16 v[168:171], a[48:51], v[72:75], v[168:171]
    buffer_load_dwordx4 v9, s[12:15], s32 offen offset:0 lds
    v_mfma_f32_16x16x32_bf16 v[164:167], a[48:51], v[68:71], v[164:167]
    s_cmp_ge_u32 s42, 32
    ds_read_b64_tr_b16 a[24:25], v15 offset:33024
    v_mfma_f32_16x16x32_bf16 v[160:163], a[48:51], v[64:67], v[160:163]
    s_cselect_b32 s45, 64, s45
    ds_read_b64_tr_b16 a[26:27], v15 offset:37120
    v_mfma_f32_16x16x32_bf16 v[176:179], a[52:55], v[64:67], v[176:179]
    s_add_u32 s94, s32, 7168
    ds_read_b64_tr_b16 a[28:29], v17 offset:33024
    v_mfma_f32_16x16x32_bf16 v[180:183], a[52:55], v[68:71], v[180:183]
    buffer_load_dwordx4 v10, s[12:15], s94 offen offset:1024 lds
    v_mfma_f32_16x16x32_bf16 v[184:187], a[52:55], v[72:75], v[184:187]
    ds_read_b64_tr_b16 a[30:31], v17 offset:37120
    v_mfma_f32_16x16x32_bf16 v[188:191], a[52:55], v[76:79], v[188:191]
    v_mfma_f32_16x16x32_bf16 v[204:207], a[56:59], v[76:79], v[204:207]
    s_add_u32 s95, s32, 14336
    v_mfma_f32_16x16x32_bf16 v[200:203], a[56:59], v[72:75], v[200:203]
    buffer_load_dwordx4 v9, s[12:15], s95 offen offset:2048 lds
    v_mfma_f32_16x16x32_bf16 v[196:199], a[56:59], v[68:71], v[196:199]
    v_mfma_f32_16x16x32_bf16 v[192:195], a[56:59], v[64:67], v[192:195]
    v_mfma_f32_16x16x32_bf16 v[208:211], a[60:63], v[64:67], v[208:211]
    s_add_u32 s96, s32, 21504
    v_mfma_f32_16x16x32_bf16 v[212:215], a[60:63], v[68:71], v[212:215]
    buffer_load_dwordx4 v10, s[12:15], s96 offen offset:3072 lds
    v_mfma_f32_16x16x32_bf16 v[216:219], a[60:63], v[72:75], v[216:219]
    v_mfma_f32_16x16x32_bf16 v[220:223], a[60:63], v[76:79], v[220:223]
    s_mov_b64 exec, 1
    buffer_load_dword v21, v20, s[20:23], 0 offen sc1
    s_mov_b64 exec, -1
    v_mfma_f32_16x16x32_bf16 v[236:239], a[64:67], v[76:79], v[236:239]
    s_add_u32 m0, s35, 2048
    v_mfma_f32_16x16x32_bf16 v[232:235], a[64:67], v[72:75], v[232:235]
    s_mov_b64 exec, s[50:51]
    buffer_load_dwordx4 v6, s[8:11], s44 offen sc1 lds
    s_mov_b64 exec, -1
    v_mfma_f32_16x16x32_bf16 v[228:231], a[64:67], v[68:71], v[228:231]
    s_lshl_b32 s32, s45, 17
    s_mul_i32 s44, s45, 18432
    v_mfma_f32_16x16x32_bf16 v[224:227], a[64:67], v[64:67], v[224:227]
    s_waitcnt vmcnt(18) lgkmcnt(0)
    s_barrier
    v_mfma_f32_16x16x32_bf16 v[112:115], a[0:3], v[80:83], v[112:115]
    s_add_u32 s42, s42, 1
    ds_read_b128 a[68:71], v8 offset:6144
    v_mfma_f32_16x16x32_bf16 v[116:119], a[0:3], v[84:87], v[116:119]
    buffer_load_dwordx4 v[64:67], v2, s[8:11], s43 offen sc1
    v_mfma_f32_16x16x32_bf16 v[120:123], a[0:3], v[88:91], v[120:123]
    s_add_u32 s45, s42, s46
    ds_read_b64_tr_b16 a[36:37], v14 offset:49152
    v_mfma_f32_16x16x32_bf16 v[124:127], a[0:3], v[92:95], v[124:127]
    s_cmp_lt_u32 s42, 8
    ds_read_b64_tr_b16 a[38:39], v14 offset:53248
    v_mfma_f32_16x16x32_bf16 v[240:243], a[0:3], a[32:35], v[240:243]
    s_cselect_b32 s41, 3, 7
    ds_read_b64_tr_b16 a[40:41], v16 offset:49152
    v_mfma_f32_16x16x32_bf16 v[244:247], a[4:7], a[32:35], v[244:247]
    buffer_load_dwordx4 v[68:71], v3, s[8:11], s43 offen sc1
    v_mfma_f32_16x16x32_bf16 v[140:143], a[4:7], v[92:95], v[140:143]
    s_and_b32 s45, s45, s41
    ds_read_b64_tr_b16 a[42:43], v16 offset:53248
    v_mfma_f32_16x16x32_bf16 v[136:139], a[4:7], v[88:91], v[136:139]
    s_andn2_b32 s41, s42, s41
    ds_read_b64_tr_b16 a[44:45], v14 offset:49408
    v_mfma_f32_16x16x32_bf16 v[132:135], a[4:7], v[84:87], v[132:135]
    s_add_u32 s45, s45, s41
    ds_read_b64_tr_b16 a[46:47], v14 offset:53504
    v_mfma_f32_16x16x32_bf16 v[128:131], a[4:7], v[80:83], v[128:131]
    buffer_load_dwordx4 v[72:75], v4, s[8:11], s43 offen sc1
    v_mfma_f32_16x16x32_bf16 v[144:147], a[8:11], v[80:83], v[144:147]
    s_cmp_lt_u32 s45, s47
    ds_read_b64_tr_b16 a[48:49], v16 offset:49408
    v_mfma_f32_16x16x32_bf16 v[148:151], a[8:11], v[84:87], v[148:151]
    s_cselect_b32 s41, 4, 0
    ds_read_b64_tr_b16 a[50:51], v16 offset:53504
    v_mfma_f32_16x16x32_bf16 v[152:155], a[8:11], v[88:91], v[152:155]
    s_sub_u32 s45, s45, s41
    ds_read_b64_tr_b16 a[52:53], v15 offset:49152
    v_mfma_f32_16x16x32_bf16 v[156:159], a[8:11], v[92:95], v[156:159]
    buffer_load_dwordx4 v[76:79], v5, s[8:11], s43 offen sc1
    v_mfma_f32_16x16x32_bf16 v[248:251], a[8:11], a[32:35], v[248:251]
    s_xor_b32 s45, s45, s7
    ds_read_b64_tr_b16 a[54:55], v15 offset:53248
    v_mfma_f32_16x16x32_bf16 v[252:255], a[12:15], a[32:35], v[252:255]
    s_mov_b32 s43, s44
    ds_read_b64_tr_b16 a[56:57], v17 offset:49152
    v_mfma_f32_16x16x32_bf16 v[172:175], a[12:15], v[92:95], v[172:175]
    s_add_u32 m0, s6, 131072
    ds_read_b64_tr_b16 a[58:59], v17 offset:53248
    v_mfma_f32_16x16x32_bf16 v[168:171], a[12:15], v[88:91], v[168:171]
    buffer_load_dwordx4 v9, s[12:15], s32 offen offset:0 lds
    v_mfma_f32_16x16x32_bf16 v[164:167], a[12:15], v[84:87], v[164:167]
    s_cmp_ge_u32 s42, 32
    ds_read_b64_tr_b16 a[60:61], v15 offset:49408
    v_mfma_f32_16x16x32_bf16 v[160:163], a[12:15], v[80:83], v[160:163]
    s_cselect_b32 s45, 64, s45
    ds_read_b64_tr_b16 a[62:63], v15 offset:53504
    v_mfma_f32_16x16x32_bf16 v[176:179], a[16:19], v[80:83], v[176:179]
    s_add_u32 s97, s32, 7168
    ds_read_b64_tr_b16 a[64:65], v17 offset:49408
    v_mfma_f32_16x16x32_bf16 v[180:183], a[16:19], v[84:87], v[180:183]
    buffer_load_dwordx4 v10, s[12:15], s97 offen offset:1024 lds
    v_mfma_f32_16x16x32_bf16 v[184:187], a[16:19], v[88:91], v[184:187]
    ds_read_b64_tr_b16 a[66:67], v17 offset:53504
    v_mfma_f32_16x16x32_bf16 v[188:191], a[16:19], v[92:95], v[188:191]
    v_mfma_f32_16x16x32_bf16 v[204:207], a[20:23], v[92:95], v[204:207]
    s_add_u32 s90, s32, 14336
    v_mfma_f32_16x16x32_bf16 v[200:203], a[20:23], v[88:91], v[200:203]
    buffer_load_dwordx4 v9, s[12:15], s90 offen offset:2048 lds
    v_mfma_f32_16x16x32_bf16 v[196:199], a[20:23], v[84:87], v[196:199]
    v_mfma_f32_16x16x32_bf16 v[192:195], a[20:23], v[80:83], v[192:195]
    v_mfma_f32_16x16x32_bf16 v[208:211], a[24:27], v[80:83], v[208:211]
    s_add_u32 s91, s32, 21504
    v_mfma_f32_16x16x32_bf16 v[212:215], a[24:27], v[84:87], v[212:215]
    buffer_load_dwordx4 v10, s[12:15], s91 offen offset:3072 lds
    v_mfma_f32_16x16x32_bf16 v[216:219], a[24:27], v[88:91], v[216:219]
    v_mfma_f32_16x16x32_bf16 v[220:223], a[24:27], v[92:95], v[220:223]
    v_mfma_f32_16x16x32_bf16 v[236:239], a[28:31], v[92:95], v[236:239]
    s_add_u32 m0, s35, 4096
    v_mfma_f32_16x16x32_bf16 v[232:235], a[28:31], v[88:91], v[232:235]
    s_mov_b64 exec, s[50:51]
    buffer_load_dwordx4 v6, s[8:11], s44 offen sc1 lds
    s_mov_b64 exec, -1
    v_mfma_f32_16x16x32_bf16 v[228:231], a[28:31], v[84:87], v[228:231]
    s_lshl_b32 s32, s45, 17
    s_mul_i32 s44, s45, 18432
    v_mfma_f32_16x16x32_bf16 v[224:227], a[28:31], v[80:83], v[224:227]
    s_waitcnt vmcnt(18) lgkmcnt(0)
    s_barrier
    v_mfma_f32_16x16x32_bf16 v[112:115], a[36:39], v[96:99], v[112:115]
    s_add_u32 s42, s42, 1
    ds_read_b128 a[32:35], v8 offset:0
    v_mfma_f32_16x16x32_bf16 v[116:119], a[36:39], v[100:103], v[116:119]
    buffer_load_dwordx4 v[80:83], v2, s[8:11], s43 offen sc1
    v_mfma_f32_16x16x32_bf16 v[120:123], a[36:39], v[104:107], v[120:123]
    s_add_u32 s45, s42, s46
    ds_read_b64_tr_b16 a[0:1], v14 offset:0
    v_mfma_f32_16x16x32_bf16 v[124:127], a[36:39], v[108:111], v[124:127]
    s_cmp_lt_u32 s42, 8
    ds_read_b64_tr_b16 a[2:3], v14 offset:4096
    v_mfma_f32_16x16x32_bf16 v[240:243], a[36:39], a[68:71], v[240:243]
    s_cselect_b32 s41, 3, 7
    ds_read_b64_tr_b16 a[4:5], v16 offset:0
    v_mfma_f32_16x16x32_bf16 v[244:247], a[40:43], a[68:71], v[244:247]
    buffer_load_dwordx4 v[84:87], v3, s[8:11], s43 offen sc1
    v_mfma_f32_16x16x32_bf16 v[140:143], a[40:43], v[108:111], v[140:143]
    s_and_b32 s45, s45, s41
    ds_read_b64_tr_b16 a[6:7], v16 offset:4096
    v_mfma_f32_16x16x32_bf16 v[136:139], a[40:43], v[104:107], v[136:139]
    s_andn2_b32 s41, s42, s41
    ds_read_b64_tr_b16 a[8:9], v14 offset:256
    v_mfma_f32_16x16x32_bf16 v[132:135], a[40:43], v[100:103], v[132:135]
    s_add_u32 s45, s45, s41
    ds_read_b64_tr_b16 a[10:11], v14 offset:4352
    v_mfma_f32_16x16x32_bf16 v[128:131], a[40:43], v[96:99], v[128:131]
    buffer_load_dwordx4 v[88:91], v4, s[8:11], s43 offen sc1
    v_mfma_f32_16x16x32_bf16 v[144:147], a[44:47], v[96:99], v[144:147]
    s_cmp_lt_u32 s45, s47
    ds_read_b64_tr_b16 a[12:13], v16 offset:256
    v_mfma_f32_16x16x32_bf16 v[148:151], a[44:47], v[100:103], v[148:151]
    s_cselect_b32 s41, 4, 0
    ds_read_b64_tr_b16 a[14:15], v16 offset:4352
    v_mfma_f32_16x16x32_bf16 v[152:155], a[44:47], v[104:107], v[152:155]
    s_sub_u32 s45, s45, s41
    ds_read_b64_tr_b16 a[16:17], v15 offset:0
    v_mfma_f32_16x16x32_bf16 v[156:159], a[44:47], v[108:111], v[156:159]
    buffer_load_dwordx4 v[92:95], v5, s[8:11], s43 offen sc1
    v_mfma_f32_16x16x32_bf16 v[248:251], a[44:47], a[68:71], v[248:251]
    s_xor_b32 s45, s45, s7
    ds_read_b64_tr_b16 a[18:19], v15 offset:4096
    v_mfma_f32_16x16x32_bf16 v[252:255], a[48:51], a[68:71], v[252:255]
    s_mov_b32 s43, s44
    ds_read_b64_tr_b16 a[20:21], v17 offset:0
    v_mfma_f32_16x16x32_bf16 v[172:175], a[48:51], v[108:111], v[172:175]
    s_add_u32 m0, s6, 147456
    ds_read_b64_tr_b16 a[22:23], v17 offset:4096
    v_mfma_f32_16x16x32_bf16 v[168:171], a[48:51], v[104:107], v[168:171]
    buffer_load_dwordx4 v9, s[12:15], s32 offen offset:0 lds
    v_mfma_f32_16x16x32_bf16 v[164:167], a[48:51], v[100:103], v[164:167]
    s_cmp_ge_u32 s42, 32
    ds_read_b64_tr_b16 a[24:25], v15 offset:256
    v_mfma_f32_16x16x32_bf16 v[160:163], a[48:51], v[96:99], v[160:163]
    s_cselect_b32 s45, 64, s45
    ds_read_b64_tr_b16 a[26:27], v15 offset:4352
    v_mfma_f32_16x16x32_bf16 v[176:179], a[52:55], v[96:99], v[176:179]
    s_add_u32 s92, s32, 7168
    ds_read_b64_tr_b16 a[28:29], v17 offset:256
    v_mfma_f32_16x16x32_bf16 v[180:183], a[52:55], v[100:103], v[180:183]
    buffer_load_dwordx4 v10, s[12:15], s92 offen offset:1024 lds
    v_mfma_f32_16x16x32_bf16 v[184:187], a[52:55], v[104:107], v[184:187]
    ds_read_b64_tr_b16 a[30:31], v17 offset:4352
    v_mfma_f32_16x16x32_bf16 v[188:191], a[52:55], v[108:111], v[188:191]
    v_mfma_f32_16x16x32_bf16 v[204:207], a[56:59], v[108:111], v[204:207]
    s_add_u32 s93, s32, 14336
    v_mfma_f32_16x16x32_bf16 v[200:203], a[56:59], v[104:107], v[200:203]
    buffer_load_dwordx4 v9, s[12:15], s93 offen offset:2048 lds
    v_mfma_f32_16x16x32_bf16 v[196:199], a[56:59], v[100:103], v[196:199]
    v_mfma_f32_16x16x32_bf16 v[192:195], a[56:59], v[96:99], v[192:195]
    v_mfma_f32_16x16x32_bf16 v[208:211], a[60:63], v[96:99], v[208:211]
    s_add_u32 s94, s32, 21504
    v_mfma_f32_16x16x32_bf16 v[212:215], a[60:63], v[100:103], v[212:215]
    buffer_load_dwordx4 v10, s[12:15], s94 offen offset:3072 lds
    v_mfma_f32_16x16x32_bf16 v[216:219], a[60:63], v[104:107], v[216:219]
    v_mfma_f32_16x16x32_bf16 v[220:223], a[60:63], v[108:111], v[220:223]
    v_mfma_f32_16x16x32_bf16 v[236:239], a[64:67], v[108:111], v[236:239]
    s_add_u32 m0, s35, 6144
    v_mfma_f32_16x16x32_bf16 v[232:235], a[64:67], v[104:107], v[232:235]
    s_mov_b64 exec, s[50:51]
    buffer_load_dwordx4 v6, s[8:11], s44 offen sc1 lds
    s_mov_b64 exec, -1
    v_mfma_f32_16x16x32_bf16 v[228:231], a[64:67], v[100:103], v[228:231]
    s_lshl_b32 s32, s45, 17
    s_mul_i32 s44, s45, 18432
    v_mfma_f32_16x16x32_bf16 v[224:227], a[64:67], v[96:99], v[224:227]
    s_waitcnt vmcnt(18) lgkmcnt(0)
    s_barrier
    s_cmp_lg_u32 s40, 5
    s_cbranch_scc1 L_nochk2
    s_waitcnt vmcnt(19)
    v_readfirstlane_b32 s63, v21
    s_cmp_ge_u32 s63, 4
    s_cbranch_scc1 L_nochk2
    s_lshl_b32 s60, s2, 8
    s_add_u32 s60, s60, 4
    v_mov_b32 v28, 0
    s_mov_b64 exec, 1
    s_mov_b32 s62, 0x100000
L_p2:
    buffer_load_dword v23, v28, s[20:23], s60 offen sc1
    s_waitcnt vmcnt(0)
    v_readfirstlane_b32 s63, v23
    s_sub_u32 s62, s62, 1
    s_cmp_eq_u32 s62, 0
    s_cbranch_scc1 L_p2_x
    s_cmp_ge_u32 s63, 4
    s_cbranch_scc1 L_p2_x
    s_branch L_p2
L_p2_x:
    s_mov_b64 exec, -1
L_nochk2:
    s_sub_u32 s40, s40, 1
    s_cmp_lg_u32 s40, 0
    s_cbranch_scc1 L_ploop
    v_mfma_f32_16x16x32_bf16 v[116:119], a[0:3], v[52:55], v[116:119]
    buffer_load_dwordx4 v[96:99], v2, s[8:11], s43 offen sc1
    v_mfma_f32_16x16x32_bf16 v[124:127], a[0:3], v[60:63], v[124:127]
    ds_read_b128 a[68:71], v8 offset:2048
    v_mfma_f32_16x16x32_bf16 v[240:243], a[0:3], a[32:35], v[240:243]
    ds_read_b64_tr_b16 a[36:37], v14 offset:16384
    v_mfma_f32_16x16x32_bf16 v[244:247], a[4:7], a[32:35], v[244:247]
    ds_read_b64_tr_b16 a[38:39], v14 offset:20480
    v_mfma_f32_16x16x32_bf16 v[140:143], a[4:7], v[60:63], v[140:143]
    ds_read_b64_tr_b16 a[40:41], v16 offset:16384
    v_mfma_f32_16x16x32_bf16 v[132:135], a[4:7], v[52:55], v[132:135]
    buffer_load_dwordx4 v[100:103], v3, s[8:11], s43 offen sc1
    v_mfma_f32_16x16x32_bf16 v[148:151], a[8:11], v[52:55], v[148:151]
    ds_read_b64_tr_b16 a[42:43], v16 offset:20480
    v_mfma_f32_16x16x32_bf16 v[156:159], a[8:11], v[60:63], v[156:159]
    ds_read_b64_tr_b16 a[44:45], v14 offset:16640
    v_mfma_f32_16x16x32_bf16 v[248:251], a[8:11], a[32:35], v[248:251]
    ds_read_b64_tr_b16 a[46:47], v14 offset:20736
    v_mfma_f32_16x16x32_bf16 v[252:255], a[12:15], a[32:35], v[252:255]
    ds_read_b64_tr_b16 a[48:49], v16 offset:16640
    v_mfma_f32_16x16x32_bf16 v[172:175], a[12:15], v[60:63], v[172:175]
    buffer_load_dwordx4 v[104:107], v4, s[8:11], s43 offen sc1
    v_mfma_f32_16x16x32_bf16 v[164:167], a[12:15], v[52:55], v[164:167]
    ds_read_b64_tr_b16 a[50:51], v16 offset:20736
    v_mfma_f32_16x16x32_bf16 v[180:183], a[16:19], v[52:55], v[180:183]
    ds_read_b64_tr_b16 a[52:53], v15 offset:16384
    v_mfma_f32_16x16x32_bf16 v[188:191], a[16:19], v[60:63], v[188:191]
    ds_read_b64_tr_b16 a[54:55], v15 offset:20480
    v_mfma_f32_16x16x32_bf16 v[204:207], a[20:23], v[60:63], v[204:207]
    ds_read_b64_tr_b16 a[56:57], v17 offset:16384
    v_mfma_f32_16x16x32_bf16 v[196:199], a[20:23], v[52:55], v[196:199]
    buffer_load_dwordx4 v[108:111], v5, s[8:11], s43 offen sc1
    v_mfma_f32_16x16x32_bf16 v[212:215], a[24:27], v[52:55], v[212:215]
    ds_read_b64_tr_b16 a[58:59], v17 offset:20480
    v_mfma_f32_16x16x32_bf16 v[220:223], a[24:27], v[60:63], v[220:223]
    ds_read_b64_tr_b16 a[60:61], v15 offset:16640
    v_mfma_f32_16x16x32_bf16 v[236:239], a[28:31], v[60:63], v[236:239]
    ds_read_b64_tr_b16 a[62:63], v15 offset:20736
    v_mfma_f32_16x16x32_bf16 v[228:231], a[28:31], v[52:55], v[228:231]
    ds_read_b64_tr_b16 a[64:65], v17 offset:16640
    ds_read_b64_tr_b16 a[66:67], v17 offset:20736
    s_waitcnt vmcnt(13) lgkmcnt(8)
    s_barrier
    v_mfma_f32_16x16x32_bf16 v[116:119], a[36:39], v[68:71], v[116:119]
    s_mul_i32 s60, s2, 36864
    s_mul_i32 s61, s3, 9216
    s_add_u32 s60, s60, s61
    s_xor_b32 s44, s2, 2
    s_mul_i32 s44, s44, 36864
    s_add_u32 s44, s44, s61
    s_add_u32 s62, s60, 4096
    s_add_u32 s63, s60, 8192
    ds_read_b128 a[32:35], v8 offset:4096
    v_mfma_f32_16x16x32_bf16 v[124:127], a[36:39], v[76:79], v[124:127]
    ds_read_b64_tr_b16 a[0:1], v14 offset:32768
    v_mfma_f32_16x16x32_bf16 v[240:243], a[36:39], a[68:71], v[240:243]
    ds_read_b64_tr_b16 a[2:3], v14 offset:36864
    v_mfma_f32_16x16x32_bf16 v[244:247], a[40:43], a[68:71], v[244:247]
    ds_read_b64_tr_b16 a[4:5], v16 offset:32768
    v_mfma_f32_16x16x32_bf16 v[140:143], a[40:43], v[76:79], v[140:143]
    ds_read_b64_tr_b16 a[6:7], v16 offset:36864
    v_mfma_f32_16x16x32_bf16 v[132:135], a[40:43], v[68:71], v[132:135]
    ds_read_b64_tr_b16 a[8:9], v14 offset:33024
    v_mfma_f32_16x16x32_bf16 v[148:151], a[44:47], v[68:71], v[148:151]
    ds_read_b64_tr_b16 a[10:11], v14 offset:37120
    v_mfma_f32_16x16x32_bf16 v[156:159], a[44:47], v[76:79], v[156:159]
    ds_read_b64_tr_b16 a[12:13], v16 offset:33024
    v_mfma_f32_16x16x32_bf16 v[248:251], a[44:47], a[68:71], v[248:251]
    ds_read_b64_tr_b16 a[14:15], v16 offset:37120
    v_mfma_f32_16x16x32_bf16 v[252:255], a[48:51], a[68:71], v[252:255]
    ds_read_b64_tr_b16 a[16:17], v15 offset:32768
    v_mfma_f32_16x16x32_bf16 v[172:175], a[48:51], v[76:79], v[172:175]
    ds_read_b64_tr_b16 a[18:19], v15 offset:36864
    v_mfma_f32_16x16x32_bf16 v[164:167], a[48:51], v[68:71], v[164:167]
    ds_read_b64_tr_b16 a[20:21], v17 offset:32768
    s_waitcnt lgkmcnt(12)
    v_mfma_f32_16x16x32_bf16 v[180:183], a[52:55], v[68:71], v[180:183]
    ds_read_b64_tr_b16 a[22:23], v17 offset:36864
    v_mfma_f32_16x16x32_bf16 v[188:191], a[52:55], v[76:79], v[188:191]
    ds_read_b64_tr_b16 a[24:25], v15 offset:33024
    v_mfma_f32_16x16x32_bf16 v[204:207], a[56:59], v[76:79], v[204:207]
    ds_read_b64_tr_b16 a[26:27], v15 offset:37120
    v_mfma_f32_16x16x32_bf16 v[196:199], a[56:59], v[68:71], v[196:199]
    ds_read_b64_tr_b16 a[28:29], v17 offset:33024
    v_mfma_f32_16x16x32_bf16 v[212:215], a[60:63], v[68:71], v[212:215]
    ds_read_b64_tr_b16 a[30:31], v17 offset:37120
    v_mfma_f32_16x16x32_bf16 v[220:223], a[60:63], v[76:79], v[220:223]
    v_mfma_f32_16x16x32_bf16 v[236:239], a[64:67], v[76:79], v[236:239]
    v_mfma_f32_16x16x32_bf16 v[228:231], a[64:67], v[68:71], v[228:231]
    s_waitcnt vmcnt(4) lgkmcnt(8)
    s_barrier
    v_mfma_f32_16x16x32_bf16 v[116:119], a[0:3], v[84:87], v[116:119]
    ds_read_b128 a[68:71], v8 offset:6144
    v_mfma_f32_16x16x32_bf16 v[124:127], a[0:3], v[92:95], v[124:127]
    ds_read_b64_tr_b16 a[36:37], v14 offset:49152
    v_mfma_f32_16x16x32_bf16 v[240:243], a[0:3], a[32:35], v[240:243]
    ds_read_b64_tr_b16 a[38:39], v14 offset:53248
    v_mfma_f32_16x16x32_bf16 v[244:247], a[4:7], a[32:35], v[244:247]
    ds_read_b64_tr_b16 a[40:41], v16 offset:49152
    v_mfma_f32_16x16x32_bf16 v[140:143], a[4:7], v[92:95], v[140:143]
    ds_read_b64_tr_b16 a[42:43], v16 offset:53248
    v_mfma_f32_16x16x32_bf16 v[132:135], a[4:7], v[84:87], v[132:135]
    ds_read_b64_tr_b16 a[44:45], v14 offset:49408
    v_mfma_f32_16x16x32_bf16 v[148:151], a[8:11], v[84:87], v[148:151]
    ds_read_b64_tr_b16 a[46:47], v14 offset:53504
    v_mfma_f32_16x16x32_bf16 v[156:159], a[8:11], v[92:95], v[156:159]
    ds_read_b64_tr_b16 a[48:49], v16 offset:49408
    v_mfma_f32_16x16x32_bf16 v[248:251], a[8:11], a[32:35], v[248:251]
    ds_read_b64_tr_b16 a[50:51], v16 offset:53504
    v_mfma_f32_16x16x32_bf16 v[252:255], a[12:15], a[32:35], v[252:255]
    ds_read_b64_tr_b16 a[52:53], v15 offset:49152
    v_mfma_f32_16x16x32_bf16 v[172:175], a[12:15], v[92:95], v[172:175]
    ds_read_b64_tr_b16 a[54:55], v15 offset:53248
    v_mfma_f32_16x16x32_bf16 v[164:167], a[12:15], v[84:87], v[164:167]
    ds_read_b64_tr_b16 a[56:57], v17 offset:49152
    s_waitcnt lgkmcnt(12)
    v_mfma_f32_16x16x32_bf16 v[180:183], a[16:19], v[84:87], v[180:183]
    ds_read_b64_tr_b16 a[58:59], v17 offset:53248
    v_mfma_f32_16x16x32_bf16 v[188:191], a[16:19], v[92:95], v[188:191]
    ds_read_b64_tr_b16 a[60:61], v15 offset:49408
    v_mfma_f32_16x16x32_bf16 v[204:207], a[20:23], v[92:95], v[204:207]
    ds_read_b64_tr_b16 a[62:63], v15 offset:53504
    v_mfma_f32_16x16x32_bf16 v[196:199], a[20:23], v[84:87], v[196:199]
    ds_read_b64_tr_b16 a[64:65], v17 offset:49408
    v_mfma_f32_16x16x32_bf16 v[212:215], a[24:27], v[84:87], v[212:215]
    ds_read_b64_tr_b16 a[66:67], v17 offset:53504
    v_mfma_f32_16x16x32_bf16 v[220:223], a[24:27], v[92:95], v[220:223]
    v_mfma_f32_16x16x32_bf16 v[236:239], a[28:31], v[92:95], v[236:239]
    v_mfma_f32_16x16x32_bf16 v[228:231], a[28:31], v[84:87], v[228:231]
    s_waitcnt vmcnt(0) lgkmcnt(8)
    v_mfma_f32_16x16x32_bf16 v[116:119], a[36:39], v[100:103], v[116:119]
    ds_read_b64_tr_b16 a[0:1], v14 offset:0
    v_mfma_f32_16x16x32_bf16 v[124:127], a[36:39], v[108:111], v[124:127]
    ds_read_b64_tr_b16 a[2:3], v14 offset:4096
    v_mfma_f32_16x16x32_bf16 v[240:243], a[36:39], a[68:71], v[240:243]
    ds_read_b64_tr_b16 a[4:5], v16 offset:0
    v_mfma_f32_16x16x32_bf16 v[244:247], a[40:43], a[68:71], v[244:247]
    ds_read_b64_tr_b16 a[6:7], v16 offset:4096
    v_mfma_f32_16x16x32_bf16 v[140:143], a[40:43], v[108:111], v[140:143]
    ds_read_b64_tr_b16 a[8:9], v14 offset:256
    v_mfma_f32_16x16x32_bf16 v[132:135], a[40:43], v[100:103], v[132:135]
    ds_read_b64_tr_b16 a[10:11], v14 offset:4352
    v_mfma_f32_16x16x32_bf16 v[148:151], a[44:47], v[100:103], v[148:151]
    ds_read_b64_tr_b16 a[12:13], v16 offset:256
    v_mfma_f32_16x16x32_bf16 v[156:159], a[44:47], v[108:111], v[156:159]
    ds_read_b64_tr_b16 a[14:15], v16 offset:4352
    v_mfma_f32_16x16x32_bf16 v[248:251], a[44:47], a[68:71], v[248:251]
    ds_read_b64_tr_b16 a[16:17], v15 offset:0
    v_mfma_f32_16x16x32_bf16 v[252:255], a[48:51], a[68:71], v[252:255]
    ds_read_b64_tr_b16 a[18:19], v15 offset:4096
    v_mfma_f32_16x16x32_bf16 v[172:175], a[48:51], v[108:111], v[172:175]
    ds_read_b64_tr_b16 a[20:21], v17 offset:0
    v_mfma_f32_16x16x32_bf16 v[164:167], a[48:51], v[100:103], v[164:167]
    ds_read_b64_tr_b16 a[22:23], v17 offset:4096
    s_waitcnt lgkmcnt(12)
    v_mfma_f32_16x16x32_bf16 v[180:183], a[52:55], v[100:103], v[180:183]
    ds_read_b64_tr_b16 a[24:25], v15 offset:256
    v_mfma_f32_16x16x32_bf16 v[188:191], a[52:55], v[108:111], v[188:191]
    ds_read_b64_tr_b16 a[26:27], v15 offset:4352
    v_mfma_f32_16x16x32_bf16 v[204:207], a[56:59], v[108:111], v[204:207]
    ds_read_b64_tr_b16 a[28:29], v17 offset:256
    v_mfma_f32_16x16x32_bf16 v[196:199], a[56:59], v[100:103], v[196:199]
    ds_read_b64_tr_b16 a[30:31], v17 offset:4352
    v_mfma_f32_16x16x32_bf16 v[212:215], a[60:63], v[100:103], v[212:215]
    v_mfma_f32_16x16x32_bf16 v[220:223], a[60:63], v[108:111], v[220:223]
    v_mfma_f32_16x16x32_bf16 v[236:239], a[64:67], v[108:111], v[236:239]
    v_mfma_f32_16x16x32_bf16 v[228:231], a[64:67], v[100:103], v[228:231]
    s_waitcnt lgkmcnt(8)
    v_mfma_f32_16x16x32_bf16 v[112:115], a[0:3], v[48:51], v[112:115]
    ds_write_b128 v11, v[240:243] offset:8192
    v_mfma_f32_16x16x32_bf16 v[120:123], a[0:3], v[56:59], v[120:123]
    ds_write_b128 v11, v[244:247] offset:9216
    v_mfma_f32_16x16x32_bf16 v[136:139], a[4:7], v[56:59], v[136:139]
    ds_write_b128 v11, v[248:251] offset:10240
    v_mfma_f32_16x16x32_bf16 v[128:131], a[4:7], v[48:51], v[128:131]
    ds_write_b128 v11, v[252:255] offset:11264
    v_mfma_f32_16x16x32_bf16 v[144:147], a[8:11], v[48:51], v[144:147]
    ds_write_b128 v11, v[124:127] offset:0
    v_mfma_f32_16x16x32_bf16 v[152:155], a[8:11], v[56:59], v[152:155]
    ds_write_b128 v11, v[140:143] offset:1024
    v_mfma_f32_16x16x32_bf16 v[168:171], a[12:15], v[56:59], v[168:171]
    ds_write_b128 v11, v[156:159] offset:2048
    v_mfma_f32_16x16x32_bf16 v[160:163], a[12:15], v[48:51], v[160:163]
    ds_write_b128 v11, v[172:175] offset:3072
    s_waitcnt lgkmcnt(8)
    v_mfma_f32_16x16x32_bf16 v[176:179], a[16:19], v[48:51], v[176:179]
    ds_write_b128 v11, v[188:191] offset:4096
    v_mfma_f32_16x16x32_bf16 v[184:187], a[16:19], v[56:59], v[184:187]
    ds_write_b128 v11, v[204:207] offset:5120
    v_mfma_f32_16x16x32_bf16 v[200:203], a[20:23], v[56:59], v[200:203]
    ds_write_b128 v11, v[220:223] offset:6144
    v_mfma_f32_16x16x32_bf16 v[192:195], a[20:23], v[48:51], v[192:195]
    ds_write_b128 v11, v[236:239] offset:7168
    v_mfma_f32_16x16x32_bf16 v[208:211], a[24:27], v[48:51], v[208:211]
    s_waitcnt lgkmcnt(0)
    s_barrier
    ds_read_b128 v[32:35], v18
    v_mfma_f32_16x16x32_bf16 v[216:219], a[24:27], v[56:59], v[216:219]
    ds_read_b128 v[36:39], v18 offset:24576
    v_mfma_f32_16x16x32_bf16 v[232:235], a[28:31], v[56:59], v[232:235]
    ds_read_b128 v[52:55], v12 offset:0
    v_mfma_f32_16x16x32_bf16 v[224:227], a[28:31], v[48:51], v[224:227]
    ds_read_b128 v[60:63], v12 offset:1024
    ds_read_b128 v[68:71], v12 offset:2048
    ds_read_b128 v[76:79], v12 offset:3072
    ds_read_b128 v[84:87], v12 offset:4096
    ds_read_b128 v[92:95], v12 offset:5120
    ds_read_b128 v[100:103], v12 offset:6144
    ds_read_b128 v[108:111], v12 offset:7168
    ds_read_b64_tr_b16 a[36:37], v14 offset:16384
    ds_read_b64_tr_b16 a[38:39], v14 offset:20480
    ds_read_b64_tr_b16 a[40:41], v16 offset:16384
    ds_read_b64_tr_b16 a[42:43], v16 offset:20480
    ds_read_b64_tr_b16 a[44:45], v14 offset:16640
    ds_read_b64_tr_b16 a[46:47], v14 offset:20736
    ds_read_b64_tr_b16 a[48:49], v16 offset:16640
    ds_read_b64_tr_b16 a[50:51], v16 offset:20736
    ds_read_b64_tr_b16 a[52:53], v15 offset:16384
    ds_read_b64_tr_b16 a[54:55], v15 offset:20480
    ds_read_b64_tr_b16 a[56:57], v17 offset:16384
    ds_read_b64_tr_b16 a[58:59], v17 offset:20480
    ds_read_b64_tr_b16 a[60:61], v15 offset:16640
    ds_read_b64_tr_b16 a[62:63], v15 offset:20736
    ds_read_b64_tr_b16 a[64:65], v17 offset:16640
    ds_read_b64_tr_b16 a[66:67], v17 offset:20736
    s_waitcnt lgkmcnt(8)
    v_mfma_f32_16x16x32_bf16 v[112:115], a[36:39], v[64:67], v[112:115]
    s_waitcnt lgkmcnt(15)
    v_add_f32 v32, v32, v36
    v_add_f32 v33, v33, v37
    v_mfma_f32_16x16x32_bf16 v[120:123], a[36:39], v[72:75], v[120:123]
    v_add_f32 v34, v34, v38
    v_add_f32 v35, v35, v39
    v_mfma_f32_16x16x32_bf16 v[136:139], a[40:43], v[72:75], v[136:139]
    buffer_store_dwordx4 v[32:35], v7, s[52:55], s63 offen sc1
    v_mfma_f32_16x16x32_bf16 v[128:131], a[40:43], v[64:67], v[128:131]
    ds_read_b64_tr_b16 a[0:1], v14 offset:32768
    v_mfma_f32_16x16x32_bf16 v[144:147], a[44:47], v[64:67], v[144:147]
    ds_read_b64_tr_b16 a[2:3], v14 offset:36864
    v_mfma_f32_16x16x32_bf16 v[152:155], a[44:47], v[72:75], v[152:155]
    ds_read_b64_tr_b16 a[4:5], v16 offset:32768
    v_mfma_f32_16x16x32_bf16 v[168:171], a[48:51], v[72:75], v[168:171]
    ds_read_b64_tr_b16 a[6:7], v16 offset:36864
    v_mfma_f32_16x16x32_bf16 v[160:163], a[48:51], v[64:67], v[160:163]
    ds_read_b64_tr_b16 a[8:9], v14 offset:33024
    s_waitcnt lgkmcnt(5)
    v_mfma_f32_16x16x32_bf16 v[176:179], a[52:55], v[64:67], v[176:179]
    s_waitcnt lgkmcnt(15)
    v_add_f32 v116, v116, v52
    v_add_f32 v117, v117, v53
    v_mfma_f32_16x16x32_bf16 v[184:187], a[52:55], v[72:75], v[184:187]
    v_add_f32 v118, v118, v54
    v_add_f32 v119, v119, v55
    v_mfma_f32_16x16x32_bf16 v[200:203], a[56:59], v[72:75], v[200:203]
    buffer_store_dwordx4 v[116:119], v7, s[52:55], s60 offen offset:0 sc1
    v_mfma_f32_16x16x32_bf16 v[192:195], a[56:59], v[64:67], v[192:195]
    ds_read_b64_tr_b16 a[10:11], v14 offset:37120
    v_mfma_f32_16x16x32_bf16 v[208:211], a[60:63], v[64:67], v[208:211]
    ds_read_b64_tr_b16 a[12:13], v16 offset:33024
    v_mfma_f32_16x16x32_bf16 v[216:219], a[60:63], v[72:75], v[216:219]
    ds_read_b64_tr_b16 a[14:15], v16 offset:37120
    v_mfma_f32_16x16x32_bf16 v[232:235], a[64:67], v[72:75], v[232:235]
    ds_read_b64_tr_b16 a[16:17], v15 offset:32768
    v_mfma_f32_16x16x32_bf16 v[224:227], a[64:67], v[64:67], v[224:227]
    ds_read_b64_tr_b16 a[18:19], v15 offset:36864
    s_waitcnt lgkmcnt(15)
    v_add_f32 v132, v132, v60
    v_add_f32 v133, v133, v61
    v_add_f32 v134, v134, v62
    v_add_f32 v135, v135, v63
    buffer_store_dwordx4 v[132:135], v7, s[52:55], s60 offen offset:1024 sc1
    ds_read_b64_tr_b16 a[20:21], v17 offset:32768
    ds_read_b64_tr_b16 a[22:23], v17 offset:36864
    ds_read_b64_tr_b16 a[24:25], v15 offset:33024
    ds_read_b64_tr_b16 a[26:27], v15 offset:37120
    ds_read_b64_tr_b16 a[28:29], v17 offset:33024
    ds_read_b64_tr_b16 a[30:31], v17 offset:37120
    s_waitcnt lgkmcnt(8)
    v_mfma_f32_16x16x32_bf16 v[112:115], a[0:3], v[80:83], v[112:115]
    s_waitcnt lgkmcnt(15)
    v_add_f32 v148, v148, v68
    v_add_f32 v149, v149, v69
    v_mfma_f32_16x16x32_bf16 v[120:123], a[0:3], v[88:91], v[120:123]
    v_add_f32 v150, v150, v70
    v_add_f32 v151, v151, v71
    v_mfma_f32_16x16x32_bf16 v[136:139], a[4:7], v[88:91], v[136:139]
    buffer_store_dwordx4 v[148:151], v7, s[52:55], s60 offen offset:2048 sc1
    v_mfma_f32_16x16x32_bf16 v[128:131], a[4:7], v[80:83], v[128:131]
    ds_read_b64_tr_b16 a[36:37], v14 offset:49152
    v_mfma_f32_16x16x32_bf16 v[144:147], a[8:11], v[80:83], v[144:147]
    ds_read_b64_tr_b16 a[38:39], v14 offset:53248
    v_mfma_f32_16x16x32_bf16 v[152:155], a[8:11], v[88:91], v[152:155]
    ds_read_b64_tr_b16 a[40:41], v16 offset:49152
    v_mfma_f32_16x16x32_bf16 v[168:171], a[12:15], v[88:91], v[168:171]
    ds_read_b64_tr_b16 a[42:43], v16 offset:53248
    v_mfma_f32_16x16x32_bf16 v[160:163], a[12:15], v[80:83], v[160:163]
    ds_read_b64_tr_b16 a[44:45], v14 offset:49408
    s_waitcnt lgkmcnt(5)
    v_mfma_f32_16x16x32_bf16 v[176:179], a[16:19], v[80:83], v[176:179]
    s_waitcnt lgkmcnt(15)
    v_add_f32 v164, v164, v76
    v_add_f32 v165, v165, v77
    v_mfma_f32_16x16x32_bf16 v[184:187], a[16:19], v[88:91], v[184:187]
    v_add_f32 v166, v166, v78
    v_add_f32 v167, v167, v79
    v_mfma_f32_16x16x32_bf16 v[200:203], a[20:23], v[88:91], v[200:203]
    buffer_store_dwordx4 v[164:167], v7, s[52:55], s60 offen offset:3072 sc1
    v_mfma_f32_16x16x32_bf16 v[192:195], a[20:23], v[80:83], v[192:195]
    ds_read_b64_tr_b16 a[46:47], v14 offset:53504
    v_mfma_f32_16x16x32_bf16 v[208:211], a[24:27], v[80:83], v[208:211]
    ds_read_b64_tr_b16 a[48:49], v16 offset:49408
    v_mfma_f32_16x16x32_bf16 v[216:219], a[24:27], v[88:91], v[216:219]
    ds_read_b64_tr_b16 a[50:51], v16 offset:53504
    v_mfma_f32_16x16x32_bf16 v[232:235], a[28:31], v[88:91], v[232:235]
    ds_read_b64_tr_b16 a[52:53], v15 offset:49152
    v_mfma_f32_16x16x32_bf16 v[224:227], a[28:31], v[80:83], v[224:227]
    ds_read_b64_tr_b16 a[54:55], v15 offset:53248
    s_waitcnt lgkmcnt(15)
    v_add_f32 v180, v180, v84
    v_add_f32 v181, v181, v85
    v_add_f32 v182, v182, v86
    v_add_f32 v183, v183, v87
    buffer_store_dwordx4 v[180:183], v7, s[52:55], s62 offen offset:0 sc1
    ds_read_b64_tr_b16 a[56:57], v17 offset:49152
    ds_read_b64_tr_b16 a[58:59], v17 offset:53248
    ds_read_b64_tr_b16 a[60:61], v15 offset:49408
    ds_read_b64_tr_b16 a[62:63], v15 offset:53504
    ds_read_b64_tr_b16 a[64:65], v17 offset:49408
    ds_read_b64_tr_b16 a[66:67], v17 offset:53504
    s_waitcnt lgkmcnt(8)
    v_mfma_f32_16x16x32_bf16 v[112:115], a[36:39], v[96:99], v[112:115]
    s_waitcnt lgkmcnt(15)
    v_add_f32 v196, v196, v92
    v_add_f32 v197, v197, v93
    v_mfma_f32_16x16x32_bf16 v[120:123], a[36:39], v[104:107], v[120:123]
    v_add_f32 v198, v198, v94
    v_add_f32 v199, v199, v95
    v_mfma_f32_16x16x32_bf16 v[136:139], a[40:43], v[104:107], v[136:139]
    buffer_store_dwordx4 v[196:199], v7, s[52:55], s62 offen offset:1024 sc1
    v_mfma_f32_16x16x32_bf16 v[128:131], a[40:43], v[96:99], v[128:131]
    s_waitcnt lgkmcnt(15)
    v_add_f32 v212, v212, v100
    v_add_f32 v213, v213, v101
    v_mfma_f32_16x16x32_bf16 v[144:147], a[44:47], v[96:99], v[144:147]
    v_add_f32 v214, v214, v102
    v_add_f32 v215, v215, v103
    v_mfma_f32_16x16x32_bf16 v[152:155], a[44:47], v[104:107], v[152:155]
    buffer_store_dwordx4 v[212:215], v7, s[52:55], s62 offen offset:2048 sc1
    v_mfma_f32_16x16x32_bf16 v[168:171], a[48:51], v[104:107], v[168:171]
    s_waitcnt lgkmcnt(15)
    v_add_f32 v228, v228, v108
    v_add_f32 v229, v229, v109
    v_mfma_f32_16x16x32_bf16 v[160:163], a[48:51], v[96:99], v[160:163]
    v_add_f32 v230, v230, v110
    v_add_f32 v231, v231, v111
    s_waitcnt lgkmcnt(0)
    v_mfma_f32_16x16x32_bf16 v[176:179], a[52:55], v[96:99], v[176:179]
    buffer_store_dwordx4 v[228:231], v7, s[52:55], s62 offen offset:3072 sc1
    v_mfma_f32_16x16x32_bf16 v[184:187], a[52:55], v[104:107], v[184:187]
    v_mfma_f32_16x16x32_bf16 v[200:203], a[56:59], v[104:107], v[200:203]
    v_mfma_f32_16x16x32_bf16 v[192:195], a[56:59], v[96:99], v[192:195]
    v_mfma_f32_16x16x32_bf16 v[208:211], a[60:63], v[96:99], v[208:211]
    v_mfma_f32_16x16x32_bf16 v[216:219], a[60:63], v[104:107], v[216:219]
    v_mfma_f32_16x16x32_bf16 v[232:235], a[64:67], v[104:107], v[232:235]
    v_mfma_f32_16x16x32_bf16 v[224:227], a[64:67], v[96:99], v[224:227]
    s_nop 7
    s_lshl_b32 s61, s3, 13
    s_add_u32 s61, s61, 65536
    v_add_u32 v16, s61, v7
    v_xor_b32 v17, 16384, v16
    ds_write_b128 v16, v[120:123] offset:0
    ds_write_b128 v16, v[136:139] offset:1024
    ds_write_b128 v16, v[152:155] offset:2048
    ds_write_b128 v16, v[168:171] offset:3072
    ds_write_b128 v16, v[184:187] offset:4096
    ds_write_b128 v16, v[200:203] offset:5120
    ds_write_b128 v16, v[216:219] offset:6144
    ds_write_b128 v16, v[232:235] offset:7168
    ds_read_b128 v[40:43], v13
    ds_read_b128 v[44:47], v13 offset:24576
    s_waitcnt lgkmcnt(0)
    s_barrier
    ds_read_b128 v[80:83], v17 offset:0
    ds_read_b128 v[84:87], v17 offset:1024
    ds_read_b128 v[88:91], v17 offset:2048
    ds_read_b128 v[92:95], v17 offset:3072
    ds_read_b128 v[96:99], v17 offset:4096
    ds_read_b128 v[100:103], v17 offset:5120
    ds_read_b128 v[104:107], v17 offset:6144
    ds_read_b128 v[108:111], v17 offset:7168
    v_pk_add_f32 v[40:41], v[40:41], v[44:45]
    v_pk_add_f32 v[42:43], v[42:43], v[46:47]
    v_lshrrev_b32 v26, 4, v0
    v_and_b32 v20, 15, v0
    s_lshl_b32 s61, s4, 2
    s_add_u32 s61, s61, s33
    s_lshl_b32 s60, s61, 4
    v_add_u32 v21, s60, v20
    v_lshlrev_b32 v21, 12, v21
    v_and_b32 v30, 1, v26
    v_lshlrev_b32 v30, 1, v30
    v_lshrrev_b32 v31, 1, v26
    v_or_b32 v30, v30, v31
    v_lshl_add_u32 v21, v30, 4, v21
    s_lshl_b32 s60, s4, 7
    v_add_u32 v30, s60, v21
    v_xor_b32 v31, 128, v30
    v_add_u32 v20, 128, v20
    v_lshlrev_b32 v20, 12, v20
    v_lshl_add_u32 v20, v26, 3, v20
    s_lshl_b32 s61, s61, 5
    v_add_u32 v20, s61, v20
    s_waitcnt lgkmcnt(0)
    v_pk_add_f32 v[112:113], v[112:113], v[80:81]
    v_pk_add_f32 v[114:115], v[114:115], v[82:83]
    v_pk_add_f32 v[128:129], v[128:129], v[84:85]
    v_pk_add_f32 v[130:131], v[130:131], v[86:87]
    v_pk_add_f32 v[144:145], v[144:145], v[88:89]
    v_pk_add_f32 v[146:147], v[146:147], v[90:91]
    v_pk_add_f32 v[160:161], v[160:161], v[92:93]
    v_pk_add_f32 v[162:163], v[162:163], v[94:95]
    v_pk_add_f32 v[176:177], v[176:177], v[96:97]
    v_pk_add_f32 v[178:179], v[178:179], v[98:99]
    v_pk_add_f32 v[192:193], v[192:193], v[100:101]
    v_pk_add_f32 v[194:195], v[194:195], v[102:103]
    v_pk_add_f32 v[208:209], v[208:209], v[104:105]
    v_pk_add_f32 v[210:211], v[210:211], v[106:107]
    v_pk_add_f32 v[224:225], v[224:225], v[108:109]
    v_pk_add_f32 v[226:227], v[226:227], v[110:111]
    s_waitcnt vmcnt(0)
    s_barrier
    s_cmp_eq_u32 s3, 1
    s_cbranch_scc1 L_chk
    s_cmp_lg_u32 s3, 0
    s_cbranch_scc1 L_w2
    s_lshl_b32 s60, s2, 8
    s_xor_b32 s60, s60, 0x280
    v_mov_b32 v28, 0
    v_mov_b32 v23, 1
    s_mov_b64 exec, 1
    buffer_store_dword v23, v28, s[20:23], s60 offen sc0 sc1
    s_mov_b64 exec, -1
    s_branch L_w2
L_chk:
    s_lshl_b32 s61, s2, 8
    s_add_u32 s61, s61, 128
    v_mov_b32 v28, 0
    s_mov_b64 exec, 1
    s_mov_b32 s62, 0x100000
L_p3:
    buffer_load_dword v23, v28, s[20:23], s61 offen sc1
    s_waitcnt vmcnt(0)
    v_readfirstlane_b32 s63, v23
    s_sub_u32 s62, s62, 1
    s_cmp_eq_u32 s62, 0
    s_cbranch_scc1 L_p3_x
    s_cmp_ge_u32 s63, 1
    s_cbranch_scc1 L_p3_x
    s_branch L_p3
L_p3_x:
    s_mov_b64 exec, -1
L_w2:
    s_barrier
    s_add_u32 s62, s44, 4096
    s_add_u32 s63, s44, 8192
    buffer_load_dwordx4 v[48:51], v7, s[52:55], s44 offen offset:0 sc1
    buffer_load_dwordx4 v[52:55], v7, s[52:55], s44 offen offset:1024 sc1
    buffer_load_dwordx4 v[56:59], v7, s[52:55], s44 offen offset:2048 sc1
    buffer_load_dwordx4 v[60:63], v7, s[52:55], s44 offen offset:3072 sc1
    buffer_load_dwordx4 v[64:67], v7, s[52:55], s62 offen offset:0 sc1
    buffer_load_dwordx4 v[68:71], v7, s[52:55], s62 offen offset:1024 sc1
    buffer_load_dwordx4 v[72:75], v7, s[52:55], s62 offen offset:2048 sc1
    buffer_load_dwordx4 v[76:79], v7, s[52:55], s62 offen offset:3072 sc1
    buffer_load_dwordx4 v[44:47], v7, s[52:55], s63 offen sc1
    s_waitcnt vmcnt(7)
    v_pk_add_f32 v[112:113], v[112:113], v[48:49]
    v_pk_add_f32 v[114:115], v[114:115], v[50:51]
    v_pk_add_f32 v[128:129], v[128:129], v[52:53]
    v_pk_add_f32 v[130:131], v[130:131], v[54:55]
    v_cvt_pk_bf16_f32 v80, v112, v113
    v_cvt_pk_bf16_f32 v82, v128, v129
    v_cvt_pk_bf16_f32 v81, v114, v115
    v_cvt_pk_bf16_f32 v83, v130, v131
    s_nop 1
    v_permlane16_swap_b32 v80, v82
    v_permlane16_swap_b32 v81, v83
    buffer_store_dwordx4 v[80:83], v30, s[16:19], 0 offen offset:0 sc1
    s_waitcnt vmcnt(6)
    v_pk_add_f32 v[144:145], v[144:145], v[56:57]
    v_pk_add_f32 v[146:147], v[146:147], v[58:59]
    v_pk_add_f32 v[160:161], v[160:161], v[60:61]
    v_pk_add_f32 v[162:163], v[162:163], v[62:63]
    v_cvt_pk_bf16_f32 v84, v144, v145
    v_cvt_pk_bf16_f32 v86, v160, v161
    v_cvt_pk_bf16_f32 v85, v146, v147
    v_cvt_pk_bf16_f32 v87, v162, v163
    s_nop 1
    v_permlane16_swap_b32 v84, v86
    v_permlane16_swap_b32 v85, v87
    buffer_store_dwordx4 v[84:87], v30, s[16:19], 0 offen offset:64 sc1
    s_waitcnt vmcnt(5)
    v_pk_add_f32 v[176:177], v[176:177], v[64:65]
    v_pk_add_f32 v[178:179], v[178:179], v[66:67]
    v_pk_add_f32 v[192:193], v[192:193], v[68:69]
    v_pk_add_f32 v[194:195], v[194:195], v[70:71]
    v_cvt_pk_bf16_f32 v88, v176, v177
    v_cvt_pk_bf16_f32 v90, v192, v193
    v_cvt_pk_bf16_f32 v89, v178, v179
    v_cvt_pk_bf16_f32 v91, v194, v195
    s_nop 1
    v_permlane16_swap_b32 v88, v90
    v_permlane16_swap_b32 v89, v91
    buffer_store_dwordx4 v[88:91], v31, s[16:19], 0 offen offset:0 sc1
    s_waitcnt vmcnt(4)
    v_pk_add_f32 v[208:209], v[208:209], v[72:73]
    v_pk_add_f32 v[210:211], v[210:211], v[74:75]
    v_pk_add_f32 v[224:225], v[224:225], v[76:77]
    v_pk_add_f32 v[226:227], v[226:227], v[78:79]
    v_cvt_pk_bf16_f32 v92, v208, v209
    v_cvt_pk_bf16_f32 v94, v224, v225
    v_cvt_pk_bf16_f32 v93, v210, v211
    v_cvt_pk_bf16_f32 v95, v226, v227
    s_nop 1
    v_permlane16_swap_b32 v92, v94
    v_permlane16_swap_b32 v93, v95
    buffer_store_dwordx4 v[92:95], v31, s[16:19], 0 offen offset:64 sc1
    s_waitcnt vmcnt(4)
    v_pk_add_f32 v[40:41], v[40:41], v[44:45]
    v_pk_add_f32 v[42:43], v[42:43], v[46:47]
    v_cvt_pk_bf16_f32 v40, v40, v41
    v_cvt_pk_bf16_f32 v41, v42, v43
    buffer_store_dwordx2 v[40:41], v20, s[16:19], 0 offen sc1
L_end:
    s_endpgm
L_code_end:
L_tslow0:
    s_nop 15
    v_max3_f32 v220, v152, v153, v154
    v_max3_f32 v221, v155, v168, v169
    v_max3_f32 v220, v170, v171, v220
    v_max_f32 v220, v220, v221
    v_mov_b32 v221, v220
    s_nop 1
    v_permlane32_swap_b32 v220, v221
    s_nop 1
    v_max_f32 v220, v220, v221
    v_mov_b32 v221, v220
    s_nop 1
    v_permlane16_swap_b32 v220, v221
    s_nop 1
    v_max_f32 v220, v220, v221
    v_sub_f32 v220, 0xc0e00000, v220
    v_min_f32 v220, 0, v220
    v_exp_f32 v221, v220
    v_add_f32 v228, v152, v220
    v_add_f32 v229, v153, v220
    v_add_f32 v230, v154, v220
    v_add_f32 v231, v155, v220
    v_add_f32 v232, v168, v220
    v_add_f32 v233, v169, v220
    v_add_f32 v234, v170, v220
    v_add_f32 v235, v171, v220
    v_exp_f32 v228, v228
    v_exp_f32 v229, v229
    v_exp_f32 v230, v230
    v_exp_f32 v231, v231
    v_exp_f32 v232, v232
    v_exp_f32 v233, v233
    v_exp_f32 v234, v234
    v_exp_f32 v235, v235
    v_accvgpr_read_b32 v222, a0
    v_accvgpr_read_b32 v223, a1
    v_accvgpr_read_b32 v224, a2
    v_accvgpr_read_b32 v225, a3
    v_mul_f32 v222, v222, v221
    v_mul_f32 v223, v223, v221
    v_mul_f32 v224, v224, v221
    v_mul_f32 v225, v225, v221
    v_accvgpr_write_b32 a0, v222
    v_accvgpr_write_b32 a1, v223
    v_accvgpr_write_b32 a2, v224
    v_accvgpr_write_b32 a3, v225
    v_accvgpr_read_b32 v222, a4
    v_accvgpr_read_b32 v223, a5
    v_accvgpr_read_b32 v224, a6
    v_accvgpr_read_b32 v225, a7
    v_mul_f32 v222, v222, v221
    v_mul_f32 v223, v223, v221
    v_mul_f32 v224, v224, v221
    v_mul_f32 v225, v225, v221
    v_accvgpr_write_b32 a4, v222
    v_accvgpr_write_b32 a5, v223
    v_accvgpr_write_b32 a6, v224
    v_accvgpr_write_b32 a7, v225
    v_accvgpr_read_b32 v222, a8
    v_accvgpr_read_b32 v223, a9
    v_accvgpr_read_b32 v224, a10
    v_accvgpr_read_b32 v225, a11
    v_mul_f32 v222, v222, v221
    v_mul_f32 v223, v223, v221
    v_mul_f32 v224, v224, v221
    v_mul_f32 v225, v225, v221
    v_accvgpr_write_b32 a8, v222
    v_accvgpr_write_b32 a9, v223
    v_accvgpr_write_b32 a10, v224
    v_accvgpr_write_b32 a11, v225
    v_accvgpr_read_b32 v222, a12
    v_accvgpr_read_b32 v223, a13
    v_accvgpr_read_b32 v224, a14
    v_accvgpr_read_b32 v225, a15
    v_mul_f32 v222, v222, v221
    v_mul_f32 v223, v223, v221
    v_mul_f32 v224, v224, v221
    v_mul_f32 v225, v225, v221
    v_accvgpr_write_b32 a12, v222
    v_accvgpr_write_b32 a13, v223
    v_accvgpr_write_b32 a14, v224
    v_accvgpr_write_b32 a15, v225
    v_accvgpr_read_b32 v222, a16
    v_accvgpr_read_b32 v223, a17
    v_accvgpr_read_b32 v224, a18
    v_accvgpr_read_b32 v225, a19
    v_mul_f32 v222, v222, v221
    v_mul_f32 v223, v223, v221
    v_mul_f32 v224, v224, v221
    v_mul_f32 v225, v225, v221
    v_accvgpr_write_b32 a16, v222
    v_accvgpr_write_b32 a17, v223
    v_accvgpr_write_b32 a18, v224
    v_accvgpr_write_b32 a19, v225
    v_accvgpr_read_b32 v222, a20
    v_accvgpr_read_b32 v223, a21
    v_accvgpr_read_b32 v224, a22
    v_accvgpr_read_b32 v225, a23
    v_mul_f32 v222, v222, v221
    v_mul_f32 v223, v223, v221
    v_mul_f32 v224, v224, v221
    v_mul_f32 v225, v225, v221
    v_accvgpr_write_b32 a20, v222
    v_accvgpr_write_b32 a21, v223
    v_accvgpr_write_b32 a22, v224
    v_accvgpr_write_b32 a23, v225
    v_accvgpr_read_b32 v222, a24
    v_accvgpr_read_b32 v223, a25
    v_accvgpr_read_b32 v224, a26
    v_accvgpr_read_b32 v225, a27
    v_mul_f32 v222, v222, v221
    v_mul_f32 v223, v223, v221
    v_mul_f32 v224, v224, v221
    v_mul_f32 v225, v225, v221
    v_accvgpr_write_b32 a24, v222
    v_accvgpr_write_b32 a25, v223
    v_accvgpr_write_b32 a26, v224
    v_accvgpr_write_b32 a27, v225
    v_accvgpr_read_b32 v222, a28
    v_accvgpr_read_b32 v223, a29
    v_accvgpr_read_b32 v224, a30
    v_accvgpr_read_b32 v225, a31
    v_mul_f32 v222, v222, v221
    v_mul_f32 v223, v223, v221
    v_mul_f32 v224, v224, v221
    v_mul_f32 v225, v225, v221
    v_accvgpr_write_b32 a28, v222
    v_accvgpr_write_b32 a29, v223
    v_accvgpr_write_b32 a30, v224
    v_accvgpr_write_b32 a31, v225
    v_accvgpr_read_b32 v222, a224
    v_accvgpr_read_b32 v223, a225
    v_accvgpr_read_b32 v224, a226
    v_accvgpr_read_b32 v225, a227
    v_mul_f32 v222, v222, v221
    v_mul_f32 v223, v223, v221
    v_mul_f32 v224, v224, v221
    v_mul_f32 v225, v225, v221
    v_accvgpr_write_b32 a224, v222
    v_accvgpr_write_b32 a225, v223
    v_accvgpr_write_b32 a226, v224
    v_accvgpr_write_b32 a227, v225
    v_cvt_pk_bf16_f32 v204, v228, v229
    v_cvt_pk_bf16_f32 v205, v230, v231
    v_cvt_pk_bf16_f32 v206, v232, v233
    v_cvt_pk_bf16_f32 v207, v234, v235
    s_nop 3
    s_branch L_tback0
L_tslow1:
    s_nop 15
    v_max3_f32 v220, v156, v157, v158
    v_max3_f32 v221, v159, v172, v173
    v_max3_f32 v220, v174, v175, v220
    v_max_f32 v220, v220, v221
    v_mov_b32 v221, v220
    s_nop 1
    v_permlane32_swap_b32 v220, v221
    s_nop 1
    v_max_f32 v220, v220, v221
    v_mov_b32 v221, v220
    s_nop 1
    v_permlane16_swap_b32 v220, v221
    s_nop 1
    v_max_f32 v220, v220, v221
    v_sub_f32 v220, 0xc0e00000, v220
    v_min_f32 v220, 0, v220
    v_exp_f32 v221, v220
    v_add_f32 v228, v156, v220
    v_add_f32 v229, v157, v220
    v_add_f32 v230, v158, v220
    v_add_f32 v231, v159, v220
    v_add_f32 v232, v172, v220
    v_add_f32 v233, v173, v220
    v_add_f32 v234, v174, v220
    v_add_f32 v235, v175, v220
    v_exp_f32 v228, v228
    v_exp_f32 v229, v229
    v_exp_f32 v230, v230
    v_exp_f32 v231, v231
    v_exp_f32 v232, v232
    v_exp_f32 v233, v233
    v_exp_f32 v234, v234
    v_exp_f32 v235, v235
    v_accvgpr_read_b32 v222, a32
    v_accvgpr_read_b32 v223, a33
    v_accvgpr_read_b32 v224, a34
    v_accvgpr_read_b32 v225, a35
    v_mul_f32 v222, v222, v221
    v_mul_f32 v223, v223, v221
    v_mul_f32 v224, v224, v221
    v_mul_f32 v225, v225, v221
    v_accvgpr_write_b32 a32, v222
    v_accvgpr_write_b32 a33, v223
    v_accvgpr_write_b32 a34, v224
    v_accvgpr_write_b32 a35, v225
    v_accvgpr_read_b32 v222, a36
    v_accvgpr_read_b32 v223, a37
    v_accvgpr_read_b32 v224, a38
    v_accvgpr_read_b32 v225, a39
    v_mul_f32 v222, v222, v221
    v_mul_f32 v223, v223, v221
    v_mul_f32 v224, v224, v221
    v_mul_f32 v225, v225, v221
    v_accvgpr_write_b32 a36, v222
    v_accvgpr_write_b32 a37, v223
    v_accvgpr_write_b32 a38, v224
    v_accvgpr_write_b32 a39, v225
    v_accvgpr_read_b32 v222, a40
    v_accvgpr_read_b32 v223, a41
    v_accvgpr_read_b32 v224, a42
    v_accvgpr_read_b32 v225, a43
    v_mul_f32 v222, v222, v221
    v_mul_f32 v223, v223, v221
    v_mul_f32 v224, v224, v221
    v_mul_f32 v225, v225, v221
    v_accvgpr_write_b32 a40, v222
    v_accvgpr_write_b32 a41, v223
    v_accvgpr_write_b32 a42, v224
    v_accvgpr_write_b32 a43, v225
    v_accvgpr_read_b32 v222, a44
    v_accvgpr_read_b32 v223, a45
    v_accvgpr_read_b32 v224, a46
    v_accvgpr_read_b32 v225, a47
    v_mul_f32 v222, v222, v221
    v_mul_f32 v223, v223, v221
    v_mul_f32 v224, v224, v221
    v_mul_f32 v225, v225, v221
    v_accvgpr_write_b32 a44, v222
    v_accvgpr_write_b32 a45, v223
    v_accvgpr_write_b32 a46, v224
    v_accvgpr_write_b32 a47, v225
    v_accvgpr_read_b32 v222, a48
    v_accvgpr_read_b32 v223, a49
    v_accvgpr_read_b32 v224, a50
    v_accvgpr_read_b32 v225, a51
    v_mul_f32 v222, v222, v221
    v_mul_f32 v223, v223, v221
    v_mul_f32 v224, v224, v221
    v_mul_f32 v225, v225, v221
    v_accvgpr_write_b32 a48, v222
    v_accvgpr_write_b32 a49, v223
    v_accvgpr_write_b32 a50, v224
    v_accvgpr_write_b32 a51, v225
    v_accvgpr_read_b32 v222, a52
    v_accvgpr_read_b32 v223, a53
    v_accvgpr_read_b32 v224, a54
    v_accvgpr_read_b32 v225, a55
    v_mul_f32 v222, v222, v221
    v_mul_f32 v223, v223, v221
    v_mul_f32 v224, v224, v221
    v_mul_f32 v225, v225, v221
    v_accvgpr_write_b32 a52, v222
    v_accvgpr_write_b32 a53, v223
    v_accvgpr_write_b32 a54, v224
    v_accvgpr_write_b32 a55, v225
    v_accvgpr_read_b32 v222, a56
    v_accvgpr_read_b32 v223, a57
    v_accvgpr_read_b32 v224, a58
    v_accvgpr_read_b32 v225, a59
    v_mul_f32 v222, v222, v221
    v_mul_f32 v223, v223, v221
    v_mul_f32 v224, v224, v221
    v_mul_f32 v225, v225, v221
    v_accvgpr_write_b32 a56, v222
    v_accvgpr_write_b32 a57, v223
    v_accvgpr_write_b32 a58, v224
    v_accvgpr_write_b32 a59, v225
    v_accvgpr_read_b32 v222, a60
    v_accvgpr_read_b32 v223, a61
    v_accvgpr_read_b32 v224, a62
    v_accvgpr_read_b32 v225, a63
    v_mul_f32 v222, v222, v221
    v_mul_f32 v223, v223, v221
    v_mul_f32 v224, v224, v221
    v_mul_f32 v225, v225, v221
    v_accvgpr_write_b32 a60, v222
    v_accvgpr_write_b32 a61, v223
    v_accvgpr_write_b32 a62, v224
    v_accvgpr_write_b32 a63, v225
    v_accvgpr_read_b32 v222, a228
    v_accvgpr_read_b32 v223, a229
    v_accvgpr_read_b32 v224, a230
    v_accvgpr_read_b32 v225, a231
    v_mul_f32 v222, v222, v221
    v_mul_f32 v223, v223, v221
    v_mul_f32 v224, v224, v221
    v_mul_f32 v225, v225, v221
    v_accvgpr_write_b32 a228, v222
    v_accvgpr_write_b32 a229, v223
    v_accvgpr_write_b32 a230, v224
    v_accvgpr_write_b32 a231, v225
    v_cvt_pk_bf16_f32 v208, v228, v229
    v_cvt_pk_bf16_f32 v209, v230, v231
    v_cvt_pk_bf16_f32 v210, v232, v233
    v_cvt_pk_bf16_f32 v211, v234, v235
    s_nop 3
    s_branch L_tback1
L_tslow2:
    s_nop 15
    v_max3_f32 v220, v160, v161, v162
    v_max3_f32 v221, v163, v176, v177
    v_max3_f32 v220, v178, v179, v220
    v_max_f32 v220, v220, v221
    v_mov_b32 v221, v220
    s_nop 1
    v_permlane32_swap_b32 v220, v221
    s_nop 1
    v_max_f32 v220, v220, v221
    v_mov_b32 v221, v220
    s_nop 1
    v_permlane16_swap_b32 v220, v221
    s_nop 1
    v_max_f32 v220, v220, v221
    v_sub_f32 v220, 0xc0e00000, v220
    v_min_f32 v220, 0, v220
    v_exp_f32 v221, v220
    v_add_f32 v228, v160, v220
    v_add_f32 v229, v161, v220
    v_add_f32 v230, v162, v220
    v_add_f32 v231, v163, v220
    v_add_f32 v232, v176, v220
    v_add_f32 v233, v177, v220
    v_add_f32 v234, v178, v220
    v_add_f32 v235, v179, v220
    v_exp_f32 v228, v228
    v_exp_f32 v229, v229
    v_exp_f32 v230, v230
    v_exp_f32 v231, v231
    v_exp_f32 v232, v232
    v_exp_f32 v233, v233
    v_exp_f32 v234, v234
    v_exp_f32 v235, v235
    v_accvgpr_read_b32 v222, a64
    v_accvgpr_read_b32 v223, a65
    v_accvgpr_read_b32 v224, a66
    v_accvgpr_read_b32 v225, a67
    v_mul_f32 v222, v222, v221
    v_mul_f32 v223, v223, v221
    v_mul_f32 v224, v224, v221
    v_mul_f32 v225, v225, v221
    v_accvgpr_write_b32 a64, v222
    v_accvgpr_write_b32 a65, v223
    v_accvgpr_write_b32 a66, v224
    v_accvgpr_write_b32 a67, v225
    v_accvgpr_read_b32 v222, a68
    v_accvgpr_read_b32 v223, a69
    v_accvgpr_read_b32 v224, a70
    v_accvgpr_read_b32 v225, a71
    v_mul_f32 v222, v222, v221
    v_mul_f32 v223, v223, v221
    v_mul_f32 v224, v224, v221
    v_mul_f32 v225, v225, v221
    v_accvgpr_write_b32 a68, v222
    v_accvgpr_write_b32 a69, v223
    v_accvgpr_write_b32 a70, v224
    v_accvgpr_write_b32 a71, v225
    v_accvgpr_read_b32 v222, a72
    v_accvgpr_read_b32 v223, a73
    v_accvgpr_read_b32 v224, a74
    v_accvgpr_read_b32 v225, a75
    v_mul_f32 v222, v222, v221
    v_mul_f32 v223, v223, v221
    v_mul_f32 v224, v224, v221
    v_mul_f32 v225, v225, v221
    v_accvgpr_write_b32 a72, v222
    v_accvgpr_write_b32 a73, v223
    v_accvgpr_write_b32 a74, v224
    v_accvgpr_write_b32 a75, v225
    v_accvgpr_read_b32 v222, a76
    v_accvgpr_read_b32 v223, a77
    v_accvgpr_read_b32 v224, a78
    v_accvgpr_read_b32 v225, a79
    v_mul_f32 v222, v222, v221
    v_mul_f32 v223, v223, v221
    v_mul_f32 v224, v224, v221
    v_mul_f32 v225, v225, v221
    v_accvgpr_write_b32 a76, v222
    v_accvgpr_write_b32 a77, v223
    v_accvgpr_write_b32 a78, v224
    v_accvgpr_write_b32 a79, v225
    v_accvgpr_read_b32 v222, a80
    v_accvgpr_read_b32 v223, a81
    v_accvgpr_read_b32 v224, a82
    v_accvgpr_read_b32 v225, a83
    v_mul_f32 v222, v222, v221
    v_mul_f32 v223, v223, v221
    v_mul_f32 v224, v224, v221
    v_mul_f32 v225, v225, v221
    v_accvgpr_write_b32 a80, v222
    v_accvgpr_write_b32 a81, v223
    v_accvgpr_write_b32 a82, v224
    v_accvgpr_write_b32 a83, v225
    v_accvgpr_read_b32 v222, a84
    v_accvgpr_read_b32 v223, a85
    v_accvgpr_read_b32 v224, a86
    v_accvgpr_read_b32 v225, a87
    v_mul_f32 v222, v222, v221
    v_mul_f32 v223, v223, v221
    v_mul_f32 v224, v224, v221
    v_mul_f32 v225, v225, v221
    v_accvgpr_write_b32 a84, v222
    v_accvgpr_write_b32 a85, v223
    v_accvgpr_write_b32 a86, v224
    v_accvgpr_write_b32 a87, v225
    v_accvgpr_read_b32 v222, a88
    v_accvgpr_read_b32 v223, a89
    v_accvgpr_read_b32 v224, a90
    v_accvgpr_read_b32 v225, a91
    v_mul_f32 v222, v222, v221
    v_mul_f32 v223, v223, v221
    v_mul_f32 v224, v224, v221
    v_mul_f32 v225, v225, v221
    v_accvgpr_write_b32 a88, v222
    v_accvgpr_write_b32 a89, v223
    v_accvgpr_write_b32 a90, v224
    v_accvgpr_write_b32 a91, v225
    v_accvgpr_read_b32 v222, a92
    v_accvgpr_read_b32 v223, a93
    v_accvgpr_read_b32 v224, a94
    v_accvgpr_read_b32 v225, a95
    v_mul_f32 v222, v222, v221
    v_mul_f32 v223, v223, v221
    v_mul_f32 v224, v224, v221
    v_mul_f32 v225, v225, v221
    v_accvgpr_write_b32 a92, v222
    v_accvgpr_write_b32 a93, v223
    v_accvgpr_write_b32 a94, v224
    v_accvgpr_write_b32 a95, v225
    v_accvgpr_read_b32 v222, a232
    v_accvgpr_read_b32 v223, a233
    v_accvgpr_read_b32 v224, a234
    v_accvgpr_read_b32 v225, a235
    v_mul_f32 v222, v222, v221
    v_mul_f32 v223, v223, v221
    v_mul_f32 v224, v224, v221
    v_mul_f32 v225, v225, v221
    v_accvgpr_write_b32 a232, v222
    v_accvgpr_write_b32 a233, v223
    v_accvgpr_write_b32 a234, v224
    v_accvgpr_write_b32 a235, v225
    v_cvt_pk_bf16_f32 v212, v228, v229
    v_cvt_pk_bf16_f32 v213, v230, v231
    v_cvt_pk_bf16_f32 v214, v232, v233
    v_cvt_pk_bf16_f32 v215, v234, v235
    s_nop 3
    s_branch L_tback2
L_tslow3:
    s_nop 15
    v_max3_f32 v220, v164, v165, v166
    v_max3_f32 v221, v167, v180, v181
    v_max3_f32 v220, v182, v183, v220
    v_max_f32 v220, v220, v221
    v_mov_b32 v221, v220
    s_nop 1
    v_permlane32_swap_b32 v220, v221
    s_nop 1
    v_max_f32 v220, v220, v221
    v_mov_b32 v221, v220
    s_nop 1
    v_permlane16_swap_b32 v220, v221
    s_nop 1
    v_max_f32 v220, v220, v221
    v_sub_f32 v220, 0xc0e00000, v220
    v_min_f32 v220, 0, v220
    v_exp_f32 v221, v220
    v_add_f32 v228, v164, v220
    v_add_f32 v229, v165, v220
    v_add_f32 v230, v166, v220
    v_add_f32 v231, v167, v220
    v_add_f32 v232, v180, v220
    v_add_f32 v233, v181, v220
    v_add_f32 v234, v182, v220
    v_add_f32 v235, v183, v220
    v_exp_f32 v228, v228
    v_exp_f32 v229, v229
    v_exp_f32 v230, v230
    v_exp_f32 v231, v231
    v_exp_f32 v232, v232
    v_exp_f32 v233, v233
    v_exp_f32 v234, v234
    v_exp_f32 v235, v235
    v_accvgpr_read_b32 v222, a96
    v_accvgpr_read_b32 v223, a97
    v_accvgpr_read_b32 v224, a98
    v_accvgpr_read_b32 v225, a99
    v_mul_f32 v222, v222, v221
    v_mul_f32 v223, v223, v221
    v_mul_f32 v224, v224, v221
    v_mul_f32 v225, v225, v221
    v_accvgpr_write_b32 a96, v222
    v_accvgpr_write_b32 a97, v223
    v_accvgpr_write_b32 a98, v224
    v_accvgpr_write_b32 a99, v225
    v_accvgpr_read_b32 v222, a100
    v_accvgpr_read_b32 v223, a101
    v_accvgpr_read_b32 v224, a102
    v_accvgpr_read_b32 v225, a103
    v_mul_f32 v222, v222, v221
    v_mul_f32 v223, v223, v221
    v_mul_f32 v224, v224, v221
    v_mul_f32 v225, v225, v221
    v_accvgpr_write_b32 a100, v222
    v_accvgpr_write_b32 a101, v223
    v_accvgpr_write_b32 a102, v224
    v_accvgpr_write_b32 a103, v225
    v_accvgpr_read_b32 v222, a104
    v_accvgpr_read_b32 v223, a105
    v_accvgpr_read_b32 v224, a106
    v_accvgpr_read_b32 v225, a107
    v_mul_f32 v222, v222, v221
    v_mul_f32 v223, v223, v221
    v_mul_f32 v224, v224, v221
    v_mul_f32 v225, v225, v221
    v_accvgpr_write_b32 a104, v222
    v_accvgpr_write_b32 a105, v223
    v_accvgpr_write_b32 a106, v224
    v_accvgpr_write_b32 a107, v225
    v_accvgpr_read_b32 v222, a108
    v_accvgpr_read_b32 v223, a109
    v_accvgpr_read_b32 v224, a110
    v_accvgpr_read_b32 v225, a111
    v_mul_f32 v222, v222, v221
    v_mul_f32 v223, v223, v221
    v_mul_f32 v224, v224, v221
    v_mul_f32 v225, v225, v221
    v_accvgpr_write_b32 a108, v222
    v_accvgpr_write_b32 a109, v223
    v_accvgpr_write_b32 a110, v224
    v_accvgpr_write_b32 a111, v225
    v_accvgpr_read_b32 v222, a112
    v_accvgpr_read_b32 v223, a113
    v_accvgpr_read_b32 v224, a114
    v_accvgpr_read_b32 v225, a115
    v_mul_f32 v222, v222, v221
    v_mul_f32 v223, v223, v221
    v_mul_f32 v224, v224, v221
    v_mul_f32 v225, v225, v221
    v_accvgpr_write_b32 a112, v222
    v_accvgpr_write_b32 a113, v223
    v_accvgpr_write_b32 a114, v224
    v_accvgpr_write_b32 a115, v225
    v_accvgpr_read_b32 v222, a116
    v_accvgpr_read_b32 v223, a117
    v_accvgpr_read_b32 v224, a118
    v_accvgpr_read_b32 v225, a119
    v_mul_f32 v222, v222, v221
    v_mul_f32 v223, v223, v221
    v_mul_f32 v224, v224, v221
    v_mul_f32 v225, v225, v221
    v_accvgpr_write_b32 a116, v222
    v_accvgpr_write_b32 a117, v223
    v_accvgpr_write_b32 a118, v224
    v_accvgpr_write_b32 a119, v225
    v_accvgpr_read_b32 v222, a120
    v_accvgpr_read_b32 v223, a121
    v_accvgpr_read_b32 v224, a122
    v_accvgpr_read_b32 v225, a123
    v_mul_f32 v222, v222, v221
    v_mul_f32 v223, v223, v221
    v_mul_f32 v224, v224, v221
    v_mul_f32 v225, v225, v221
    v_accvgpr_write_b32 a120, v222
    v_accvgpr_write_b32 a121, v223
    v_accvgpr_write_b32 a122, v224
    v_accvgpr_write_b32 a123, v225
    v_accvgpr_read_b32 v222, a124
    v_accvgpr_read_b32 v223, a125
    v_accvgpr_read_b32 v224, a126
    v_accvgpr_read_b32 v225, a127
    v_mul_f32 v222, v222, v221
    v_mul_f32 v223, v223, v221
    v_mul_f32 v224, v224, v221
    v_mul_f32 v225, v225, v221
    v_accvgpr_write_b32 a124, v222
    v_accvgpr_write_b32 a125, v223
    v_accvgpr_write_b32 a126, v224
    v_accvgpr_write_b32 a127, v225
    v_accvgpr_read_b32 v222, a236
    v_accvgpr_read_b32 v223, a237
    v_accvgpr_read_b32 v224, a238
    v_accvgpr_read_b32 v225, a239
    v_mul_f32 v222, v222, v221
    v_mul_f32 v223, v223, v221
    v_mul_f32 v224, v224, v221
    v_mul_f32 v225, v225, v221
    v_accvgpr_write_b32 a236, v222
    v_accvgpr_write_b32 a237, v223
    v_accvgpr_write_b32 a238, v224
    v_accvgpr_write_b32 a239, v225
    v_cvt_pk_bf16_f32 v216, v228, v229
    v_cvt_pk_bf16_f32 v217, v230, v231
    v_cvt_pk_bf16_f32 v218, v232, v233
    v_cvt_pk_bf16_f32 v219, v234, v235
    s_nop 3
    s_branch L_tback3
L_tramp0:
    s_call_b64 s[60:61], L_slow1
    s_branch L_back0
L_tramp1:
    s_call_b64 s[60:61], L_slow0
    s_branch L_back1
L_tramp2:
    s_call_b64 s[60:61], L_slow1
    s_branch L_back2
L_tramp3:
    s_call_b64 s[60:61], L_slow0
    s_branch L_back3
L_tramp4:
    s_call_b64 s[60:61], L_slow1
    s_branch L_back4
L_tramp5:
    s_call_b64 s[60:61], L_slow0
    s_branch L_back5
L_tramp6:
    s_call_b64 s[60:61], L_slow1
    s_branch L_back6
L_tramp7:
    s_call_b64 s[60:61], L_slow0
    s_branch L_back7
L_slow0:
    s_nop 15
    v_max3_f32 v240, v112, v113, v114
    v_max3_f32 v241, v115, v132, v133
    v_max3_f32 v240, v134, v135, v240
    v_max_f32 v240, v240, v241
    v_mov_b32 v241, v240
    s_nop 1
    v_permlane32_swap_b32 v240, v241
    s_nop 1
    v_max_f32 v240, v240, v241
    v_mov_b32 v241, v240
    s_nop 1
    v_permlane16_swap_b32 v240, v241
    s_nop 1
    v_max_f32 v240, v240, v241
    v_sub_f32 v240, 0xc0e00000, v240
    v_min_f32 v240, 0, v240
    v_exp_f32 v241, v240
    v_add_f32 v112, v112, v240
    v_add_f32 v113, v113, v240
    v_add_f32 v114, v114, v240
    v_add_f32 v115, v115, v240
    v_add_f32 v132, v132, v240
    v_add_f32 v133, v133, v240
    v_add_f32 v134, v134, v240
    v_add_f32 v135, v135, v240
    v_add_f32 v152, v152, v240
    v_add_f32 v153, v153, v240
    v_add_f32 v154, v154, v240
    v_add_f32 v155, v155, v240
    v_add_f32 v168, v168, v240
    v_add_f32 v169, v169, v240
    v_add_f32 v170, v170, v240
    v_add_f32 v171, v171, v240
    v_add_f32 v220, v220, v240
    v_add_f32 v221, v221, v240
    v_add_f32 v222, v222, v240
    v_add_f32 v223, v223, v240
    v_accvgpr_read_b32 v242, a0
    v_accvgpr_read_b32 v243, a1
    v_accvgpr_read_b32 v244, a2
    v_accvgpr_read_b32 v245, a3
    v_mul_f32 v242, v242, v241
    v_mul_f32 v243, v243, v241
    v_mul_f32 v244, v244, v241
    v_mul_f32 v245, v245, v241
    v_accvgpr_write_b32 a0, v242
    v_accvgpr_write_b32 a1, v243
    v_accvgpr_write_b32 a2, v244
    v_accvgpr_write_b32 a3, v245
    v_accvgpr_read_b32 v242, a4
    v_accvgpr_read_b32 v243, a5
    v_accvgpr_read_b32 v244, a6
    v_accvgpr_read_b32 v245, a7
    v_mul_f32 v242, v242, v241
    v_mul_f32 v243, v243, v241
    v_mul_f32 v244, v244, v241
    v_mul_f32 v245, v245, v241
    v_accvgpr_write_b32 a4, v242
    v_accvgpr_write_b32 a5, v243
    v_accvgpr_write_b32 a6, v244
    v_accvgpr_write_b32 a7, v245
    v_accvgpr_read_b32 v242, a8
    v_accvgpr_read_b32 v243, a9
    v_accvgpr_read_b32 v244, a10
    v_accvgpr_read_b32 v245, a11
    v_mul_f32 v242, v242, v241
    v_mul_f32 v243, v243, v241
    v_mul_f32 v244, v244, v241
    v_mul_f32 v245, v245, v241
    v_accvgpr_write_b32 a8, v242
    v_accvgpr_write_b32 a9, v243
    v_accvgpr_write_b32 a10, v244
    v_accvgpr_write_b32 a11, v245
    v_accvgpr_read_b32 v242, a12
    v_accvgpr_read_b32 v243, a13
    v_accvgpr_read_b32 v244, a14
    v_accvgpr_read_b32 v245, a15
    v_mul_f32 v242, v242, v241
    v_mul_f32 v243, v243, v241
    v_mul_f32 v244, v244, v241
    v_mul_f32 v245, v245, v241
    v_accvgpr_write_b32 a12, v242
    v_accvgpr_write_b32 a13, v243
    v_accvgpr_write_b32 a14, v244
    v_accvgpr_write_b32 a15, v245
    v_accvgpr_read_b32 v242, a16
    v_accvgpr_read_b32 v243, a17
    v_accvgpr_read_b32 v244, a18
    v_accvgpr_read_b32 v245, a19
    v_mul_f32 v242, v242, v241
    v_mul_f32 v243, v243, v241
    v_mul_f32 v244, v244, v241
    v_mul_f32 v245, v245, v241
    v_accvgpr_write_b32 a16, v242
    v_accvgpr_write_b32 a17, v243
    v_accvgpr_write_b32 a18, v244
    v_accvgpr_write_b32 a19, v245
    v_accvgpr_read_b32 v242, a20
    v_accvgpr_read_b32 v243, a21
    v_accvgpr_read_b32 v244, a22
    v_accvgpr_read_b32 v245, a23
    v_mul_f32 v242, v242, v241
    v_mul_f32 v243, v243, v241
    v_mul_f32 v244, v244, v241
    v_mul_f32 v245, v245, v241
    v_accvgpr_write_b32 a20, v242
    v_accvgpr_write_b32 a21, v243
    v_accvgpr_write_b32 a22, v244
    v_accvgpr_write_b32 a23, v245
    v_accvgpr_read_b32 v242, a24
    v_accvgpr_read_b32 v243, a25
    v_accvgpr_read_b32 v244, a26
    v_accvgpr_read_b32 v245, a27
    v_mul_f32 v242, v242, v241
    v_mul_f32 v243, v243, v241
    v_mul_f32 v244, v244, v241
    v_mul_f32 v245, v245, v241
    v_accvgpr_write_b32 a24, v242
    v_accvgpr_write_b32 a25, v243
    v_accvgpr_write_b32 a26, v244
    v_accvgpr_write_b32 a27, v245
    v_accvgpr_read_b32 v242, a28
    v_accvgpr_read_b32 v243, a29
    v_accvgpr_read_b32 v244, a30
    v_accvgpr_read_b32 v245, a31
    v_mul_f32 v242, v242, v241
    v_mul_f32 v243, v243, v241
    v_mul_f32 v244, v244, v241
    v_mul_f32 v245, v245, v241
    v_accvgpr_write_b32 a28, v242
    v_accvgpr_write_b32 a29, v243
    v_accvgpr_write_b32 a30, v244
    v_accvgpr_write_b32 a31, v245
    v_accvgpr_read_b32 v242, a224
    v_accvgpr_read_b32 v243, a225
    v_accvgpr_read_b32 v244, a226
    v_accvgpr_read_b32 v245, a227
    v_mul_f32 v242, v242, v241
    v_mul_f32 v243, v243, v241
    v_mul_f32 v244, v244, v241
    v_mul_f32 v245, v245, v241
    v_accvgpr_write_b32 a224, v242
    v_accvgpr_write_b32 a225, v243
    v_accvgpr_write_b32 a226, v244
    v_accvgpr_write_b32 a227, v245
    v_max3_f32 v240, v116, v117, v118
    v_max3_f32 v241, v119, v136, v137
    v_max3_f32 v240, v138, v139, v240
    v_max_f32 v240, v240, v241
    v_mov_b32 v241, v240
    s_nop 1
    v_permlane32_swap_b32 v240, v241
    s_nop 1
    v_max_f32 v240, v240, v241
    v_mov_b32 v241, v240
    s_nop 1
    v_permlane16_swap_b32 v240, v241
    s_nop 1
    v_max_f32 v240, v240, v241
    v_sub_f32 v240, 0xc0e00000, v240
    v_min_f32 v240, 0, v240
    v_exp_f32 v241, v240
    v_add_f32 v116, v116, v240
    v_add_f32 v117, v117, v240
    v_add_f32 v118, v118, v240
    v_add_f32 v119, v119, v240
    v_add_f32 v136, v136, v240
    v_add_f32 v137, v137, v240
    v_add_f32 v138, v138, v240
    v_add_f32 v139, v139, v240
    v_add_f32 v156, v156, v240
    v_add_f32 v157, v157, v240
    v_add_f32 v158, v158, v240
    v_add_f32 v159, v159, v240
    v_add_f32 v172, v172, v240
    v_add_f32 v173, v173, v240
    v_add_f32 v174, v174, v240
    v_add_f32 v175, v175, v240
    v_add_f32 v224, v224, v240
    v_add_f32 v225, v225, v240
    v_add_f32 v226, v226, v240
    v_add_f32 v227, v227, v240
    v_accvgpr_read_b32 v242, a32
    v_accvgpr_read_b32 v243, a33
    v_accvgpr_read_b32 v244, a34
    v_accvgpr_read_b32 v245, a35
    v_mul_f32 v242, v242, v241
    v_mul_f32 v243, v243, v241
    v_mul_f32 v244, v244, v241
    v_mul_f32 v245, v245, v241
    v_accvgpr_write_b32 a32, v242
    v_accvgpr_write_b32 a33, v243
    v_accvgpr_write_b32 a34, v244
    v_accvgpr_write_b32 a35, v245
    v_accvgpr_read_b32 v242, a36
    v_accvgpr_read_b32 v243, a37
    v_accvgpr_read_b32 v244, a38
    v_accvgpr_read_b32 v245, a39
    v_mul_f32 v242, v242, v241
    v_mul_f32 v243, v243, v241
    v_mul_f32 v244, v244, v241
    v_mul_f32 v245, v245, v241
    v_accvgpr_write_b32 a36, v242
    v_accvgpr_write_b32 a37, v243
    v_accvgpr_write_b32 a38, v244
    v_accvgpr_write_b32 a39, v245
    v_accvgpr_read_b32 v242, a40
    v_accvgpr_read_b32 v243, a41
    v_accvgpr_read_b32 v244, a42
    v_accvgpr_read_b32 v245, a43
    v_mul_f32 v242, v242, v241
    v_mul_f32 v243, v243, v241
    v_mul_f32 v244, v244, v241
    v_mul_f32 v245, v245, v241
    v_accvgpr_write_b32 a40, v242
    v_accvgpr_write_b32 a41, v243
    v_accvgpr_write_b32 a42, v244
    v_accvgpr_write_b32 a43, v245
    v_accvgpr_read_b32 v242, a44
    v_accvgpr_read_b32 v243, a45
    v_accvgpr_read_b32 v244, a46
    v_accvgpr_read_b32 v245, a47
    v_mul_f32 v242, v242, v241
    v_mul_f32 v243, v243, v241
    v_mul_f32 v244, v244, v241
    v_mul_f32 v245, v245, v241
    v_accvgpr_write_b32 a44, v242
    v_accvgpr_write_b32 a45, v243
    v_accvgpr_write_b32 a46, v244
    v_accvgpr_write_b32 a47, v245
    v_accvgpr_read_b32 v242, a48
    v_accvgpr_read_b32 v243, a49
    v_accvgpr_read_b32 v244, a50
    v_accvgpr_read_b32 v245, a51
    v_mul_f32 v242, v242, v241
    v_mul_f32 v243, v243, v241
    v_mul_f32 v244, v244, v241
    v_mul_f32 v245, v245, v241
    v_accvgpr_write_b32 a48, v242
    v_accvgpr_write_b32 a49, v243
    v_accvgpr_write_b32 a50, v244
    v_accvgpr_write_b32 a51, v245
    v_accvgpr_read_b32 v242, a52
    v_accvgpr_read_b32 v243, a53
    v_accvgpr_read_b32 v244, a54
    v_accvgpr_read_b32 v245, a55
    v_mul_f32 v242, v242, v241
    v_mul_f32 v243, v243, v241
    v_mul_f32 v244, v244, v241
    v_mul_f32 v245, v245, v241
    v_accvgpr_write_b32 a52, v242
    v_accvgpr_write_b32 a53, v243
    v_accvgpr_write_b32 a54, v244
    v_accvgpr_write_b32 a55, v245
    v_accvgpr_read_b32 v242, a56
    v_accvgpr_read_b32 v243, a57
    v_accvgpr_read_b32 v244, a58
    v_accvgpr_read_b32 v245, a59
    v_mul_f32 v242, v242, v241
    v_mul_f32 v243, v243, v241
    v_mul_f32 v244, v244, v241
    v_mul_f32 v245, v245, v241
    v_accvgpr_write_b32 a56, v242
    v_accvgpr_write_b32 a57, v243
    v_accvgpr_write_b32 a58, v244
    v_accvgpr_write_b32 a59, v245
    v_accvgpr_read_b32 v242, a60
    v_accvgpr_read_b32 v243, a61
    v_accvgpr_read_b32 v244, a62
    v_accvgpr_read_b32 v245, a63
    v_mul_f32 v242, v242, v241
    v_mul_f32 v243, v243, v241
    v_mul_f32 v244, v244, v241
    v_mul_f32 v245, v245, v241
    v_accvgpr_write_b32 a60, v242
    v_accvgpr_write_b32 a61, v243
    v_accvgpr_write_b32 a62, v244
    v_accvgpr_write_b32 a63, v245
    v_accvgpr_read_b32 v242, a228
    v_accvgpr_read_b32 v243, a229
    v_accvgpr_read_b32 v244, a230
    v_accvgpr_read_b32 v245, a231
    v_mul_f32 v242, v242, v241
    v_mul_f32 v243, v243, v241
    v_mul_f32 v244, v244, v241
    v_mul_f32 v245, v245, v241
    v_accvgpr_write_b32 a228, v242
    v_accvgpr_write_b32 a229, v243
    v_accvgpr_write_b32 a230, v244
    v_accvgpr_write_b32 a231, v245
    v_max3_f32 v240, v120, v121, v122
    v_max3_f32 v241, v123, v140, v141
    v_max3_f32 v240, v142, v143, v240
    v_max_f32 v240, v240, v241
    v_mov_b32 v241, v240
    s_nop 1
    v_permlane32_swap_b32 v240, v241
    s_nop 1
    v_max_f32 v240, v240, v241
    v_mov_b32 v241, v240
    s_nop 1
    v_permlane16_swap_b32 v240, v241
    s_nop 1
    v_max_f32 v240, v240, v241
    v_sub_f32 v240, 0xc0e00000, v240
    v_min_f32 v240, 0, v240
    v_exp_f32 v241, v240
    v_add_f32 v120, v120, v240
    v_add_f32 v121, v121, v240
    v_add_f32 v122, v122, v240
    v_add_f32 v123, v123, v240
    v_add_f32 v140, v140, v240
    v_add_f32 v141, v141, v240
    v_add_f32 v142, v142, v240
    v_add_f32 v143, v143, v240
    v_add_f32 v160, v160, v240
    v_add_f32 v161, v161, v240
    v_add_f32 v162, v162, v240
    v_add_f32 v163, v163, v240
    v_add_f32 v176, v176, v240
    v_add_f32 v177, v177, v240
    v_add_f32 v178, v178, v240
    v_add_f32 v179, v179, v240
    v_add_f32 v228, v228, v240
    v_add_f32 v229, v229, v240
    v_add_f32 v230, v230, v240
    v_add_f32 v231, v231, v240
    v_accvgpr_read_b32 v242, a64
    v_accvgpr_read_b32 v243, a65
    v_accvgpr_read_b32 v244, a66
    v_accvgpr_read_b32 v245, a67
    v_mul_f32 v242, v242, v241
    v_mul_f32 v243, v243, v241
    v_mul_f32 v244, v244, v241
    v_mul_f32 v245, v245, v241
    v_accvgpr_write_b32 a64, v242
    v_accvgpr_write_b32 a65, v243
    v_accvgpr_write_b32 a66, v244
    v_accvgpr_write_b32 a67, v245
    v_accvgpr_read_b32 v242, a68
    v_accvgpr_read_b32 v243, a69
    v_accvgpr_read_b32 v244, a70
    v_accvgpr_read_b32 v245, a71
    v_mul_f32 v242, v242, v241
    v_mul_f32 v243, v243, v241
    v_mul_f32 v244, v244, v241
    v_mul_f32 v245, v245, v241
    v_accvgpr_write_b32 a68, v242
    v_accvgpr_write_b32 a69, v243
    v_accvgpr_write_b32 a70, v244
    v_accvgpr_write_b32 a71, v245
    v_accvgpr_read_b32 v242, a72
    v_accvgpr_read_b32 v243, a73
    v_accvgpr_read_b32 v244, a74
    v_accvgpr_read_b32 v245, a75
    v_mul_f32 v242, v242, v241
    v_mul_f32 v243, v243, v241
    v_mul_f32 v244, v244, v241
    v_mul_f32 v245, v245, v241
    v_accvgpr_write_b32 a72, v242
    v_accvgpr_write_b32 a73, v243
    v_accvgpr_write_b32 a74, v244
    v_accvgpr_write_b32 a75, v245
    v_accvgpr_read_b32 v242, a76
    v_accvgpr_read_b32 v243, a77
    v_accvgpr_read_b32 v244, a78
    v_accvgpr_read_b32 v245, a79
    v_mul_f32 v242, v242, v241
    v_mul_f32 v243, v243, v241
    v_mul_f32 v244, v244, v241
    v_mul_f32 v245, v245, v241
    v_accvgpr_write_b32 a76, v242
    v_accvgpr_write_b32 a77, v243
    v_accvgpr_write_b32 a78, v244
    v_accvgpr_write_b32 a79, v245
    v_accvgpr_read_b32 v242, a80
    v_accvgpr_read_b32 v243, a81
    v_accvgpr_read_b32 v244, a82
    v_accvgpr_read_b32 v245, a83
    v_mul_f32 v242, v242, v241
    v_mul_f32 v243, v243, v241
    v_mul_f32 v244, v244, v241
    v_mul_f32 v245, v245, v241
    v_accvgpr_write_b32 a80, v242
    v_accvgpr_write_b32 a81, v243
    v_accvgpr_write_b32 a82, v244
    v_accvgpr_write_b32 a83, v245
    v_accvgpr_read_b32 v242, a84
    v_accvgpr_read_b32 v243, a85
    v_accvgpr_read_b32 v244, a86
    v_accvgpr_read_b32 v245, a87
    v_mul_f32 v242, v242, v241
    v_mul_f32 v243, v243, v241
    v_mul_f32 v244, v244, v241
    v_mul_f32 v245, v245, v241
    v_accvgpr_write_b32 a84, v242
    v_accvgpr_write_b32 a85, v243
    v_accvgpr_write_b32 a86, v244
    v_accvgpr_write_b32 a87, v245
    v_accvgpr_read_b32 v242, a88
    v_accvgpr_read_b32 v243, a89
    v_accvgpr_read_b32 v244, a90
    v_accvgpr_read_b32 v245, a91
    v_mul_f32 v242, v242, v241
    v_mul_f32 v243, v243, v241
    v_mul_f32 v244, v244, v241
    v_mul_f32 v245, v245, v241
    v_accvgpr_write_b32 a88, v242
    v_accvgpr_write_b32 a89, v243
    v_accvgpr_write_b32 a90, v244
    v_accvgpr_write_b32 a91, v245
    v_accvgpr_read_b32 v242, a92
    v_accvgpr_read_b32 v243, a93
    v_accvgpr_read_b32 v244, a94
    v_accvgpr_read_b32 v245, a95
    v_mul_f32 v242, v242, v241
    v_mul_f32 v243, v243, v241
    v_mul_f32 v244, v244, v241
    v_mul_f32 v245, v245, v241
    v_accvgpr_write_b32 a92, v242
    v_accvgpr_write_b32 a93, v243
    v_accvgpr_write_b32 a94, v244
    v_accvgpr_write_b32 a95, v245
    v_accvgpr_read_b32 v242, a232
    v_accvgpr_read_b32 v243, a233
    v_accvgpr_read_b32 v244, a234
    v_accvgpr_read_b32 v245, a235
    v_mul_f32 v242, v242, v241
    v_mul_f32 v243, v243, v241
    v_mul_f32 v244, v244, v241
    v_mul_f32 v245, v245, v241
    v_accvgpr_write_b32 a232, v242
    v_accvgpr_write_b32 a233, v243
    v_accvgpr_write_b32 a234, v244
    v_accvgpr_write_b32 a235, v245
    v_max3_f32 v240, v124, v125, v126
    v_max3_f32 v241, v127, v144, v145
    v_max3_f32 v240, v146, v147, v240
    v_max_f32 v240, v240, v241
    v_mov_b32 v241, v240
    s_nop 1
    v_permlane32_swap_b32 v240, v241
    s_nop 1
    v_max_f32 v240, v240, v241
    v_mov_b32 v241, v240
    s_nop 1
    v_permlane16_swap_b32 v240, v241
    s_nop 1
    v_max_f32 v240, v240, v241
    v_sub_f32 v240, 0xc0e00000, v240
    v_min_f32 v240, 0, v240
    v_exp_f32 v241, v240
    v_add_f32 v124, v124, v240
    v_add_f32 v125, v125, v240
    v_add_f32 v126, v126, v240
    v_add_f32 v127, v127, v240
    v_add_f32 v144, v144, v240
    v_add_f32 v145, v145, v240
    v_add_f32 v146, v146, v240
    v_add_f32 v147, v147, v240
    v_add_f32 v164, v164, v240
    v_add_f32 v165, v165, v240
    v_add_f32 v166, v166, v240
    v_add_f32 v167, v167, v240
    v_add_f32 v180, v180, v240
    v_add_f32 v181, v181, v240
    v_add_f32 v182, v182, v240
    v_add_f32 v183, v183, v240
    v_add_f32 v232, v232, v240
    v_add_f32 v233, v233, v240
    v_add_f32 v234, v234, v240
    v_add_f32 v235, v235, v240
    v_accvgpr_read_b32 v242, a96
    v_accvgpr_read_b32 v243, a97
    v_accvgpr_read_b32 v244, a98
    v_accvgpr_read_b32 v245, a99
    v_mul_f32 v242, v242, v241
    v_mul_f32 v243, v243, v241
    v_mul_f32 v244, v244, v241
    v_mul_f32 v245, v245, v241
    v_accvgpr_write_b32 a96, v242
    v_accvgpr_write_b32 a97, v243
    v_accvgpr_write_b32 a98, v244
    v_accvgpr_write_b32 a99, v245
    v_accvgpr_read_b32 v242, a100
    v_accvgpr_read_b32 v243, a101
    v_accvgpr_read_b32 v244, a102
    v_accvgpr_read_b32 v245, a103
    v_mul_f32 v242, v242, v241
    v_mul_f32 v243, v243, v241
    v_mul_f32 v244, v244, v241
    v_mul_f32 v245, v245, v241
    v_accvgpr_write_b32 a100, v242
    v_accvgpr_write_b32 a101, v243
    v_accvgpr_write_b32 a102, v244
    v_accvgpr_write_b32 a103, v245
    v_accvgpr_read_b32 v242, a104
    v_accvgpr_read_b32 v243, a105
    v_accvgpr_read_b32 v244, a106
    v_accvgpr_read_b32 v245, a107
    v_mul_f32 v242, v242, v241
    v_mul_f32 v243, v243, v241
    v_mul_f32 v244, v244, v241
    v_mul_f32 v245, v245, v241
    v_accvgpr_write_b32 a104, v242
    v_accvgpr_write_b32 a105, v243
    v_accvgpr_write_b32 a106, v244
    v_accvgpr_write_b32 a107, v245
    v_accvgpr_read_b32 v242, a108
    v_accvgpr_read_b32 v243, a109
    v_accvgpr_read_b32 v244, a110
    v_accvgpr_read_b32 v245, a111
    v_mul_f32 v242, v242, v241
    v_mul_f32 v243, v243, v241
    v_mul_f32 v244, v244, v241
    v_mul_f32 v245, v245, v241
    v_accvgpr_write_b32 a108, v242
    v_accvgpr_write_b32 a109, v243
    v_accvgpr_write_b32 a110, v244
    v_accvgpr_write_b32 a111, v245
    v_accvgpr_read_b32 v242, a112
    v_accvgpr_read_b32 v243, a113
    v_accvgpr_read_b32 v244, a114
    v_accvgpr_read_b32 v245, a115
    v_mul_f32 v242, v242, v241
    v_mul_f32 v243, v243, v241
    v_mul_f32 v244, v244, v241
    v_mul_f32 v245, v245, v241
    v_accvgpr_write_b32 a112, v242
    v_accvgpr_write_b32 a113, v243
    v_accvgpr_write_b32 a114, v244
    v_accvgpr_write_b32 a115, v245
    v_accvgpr_read_b32 v242, a116
    v_accvgpr_read_b32 v243, a117
    v_accvgpr_read_b32 v244, a118
    v_accvgpr_read_b32 v245, a119
    v_mul_f32 v242, v242, v241
    v_mul_f32 v243, v243, v241
    v_mul_f32 v244, v244, v241
    v_mul_f32 v245, v245, v241
    v_accvgpr_write_b32 a116, v242
    v_accvgpr_write_b32 a117, v243
    v_accvgpr_write_b32 a118, v244
    v_accvgpr_write_b32 a119, v245
    v_accvgpr_read_b32 v242, a120
    v_accvgpr_read_b32 v243, a121
    v_accvgpr_read_b32 v244, a122
    v_accvgpr_read_b32 v245, a123
    v_mul_f32 v242, v242, v241
    v_mul_f32 v243, v243, v241
    v_mul_f32 v244, v244, v241
    v_mul_f32 v245, v245, v241
    v_accvgpr_write_b32 a120, v242
    v_accvgpr_write_b32 a121, v243
    v_accvgpr_write_b32 a122, v244
    v_accvgpr_write_b32 a123, v245
    v_accvgpr_read_b32 v242, a124
    v_accvgpr_read_b32 v243, a125
    v_accvgpr_read_b32 v244, a126
    v_accvgpr_read_b32 v245, a127
    v_mul_f32 v242, v242, v241
    v_mul_f32 v243, v243, v241
    v_mul_f32 v244, v244, v241
    v_mul_f32 v245, v245, v241
    v_accvgpr_write_b32 a124, v242
    v_accvgpr_write_b32 a125, v243
    v_accvgpr_write_b32 a126, v244
    v_accvgpr_write_b32 a127, v245
    v_accvgpr_read_b32 v242, a236
    v_accvgpr_read_b32 v243, a237
    v_accvgpr_read_b32 v244, a238
    v_accvgpr_read_b32 v245, a239
    v_mul_f32 v242, v242, v241
    v_mul_f32 v243, v243, v241
    v_mul_f32 v244, v244, v241
    v_mul_f32 v245, v245, v241
    v_accvgpr_write_b32 a236, v242
    v_accvgpr_write_b32 a237, v243
    v_accvgpr_write_b32 a238, v244
    v_accvgpr_write_b32 a239, v245
    v_max3_f32 v240, v128, v129, v130
    v_max3_f32 v241, v131, v148, v149
    v_max3_f32 v240, v150, v151, v240
    v_max_f32 v240, v240, v241
    v_mov_b32 v241, v240
    s_nop 1
    v_permlane32_swap_b32 v240, v241
    s_nop 1
    v_max_f32 v240, v240, v241
    v_mov_b32 v241, v240
    s_nop 1
    v_permlane16_swap_b32 v240, v241
    s_nop 1
    v_max_f32 v240, v240, v241
    v_sub_f32 v240, 0xc0e00000, v240
    v_min_f32 v240, 0, v240
    v_exp_f32 v241, v240
    v_add_f32 v128, v128, v240
    v_add_f32 v129, v129, v240
    v_add_f32 v130, v130, v240
    v_add_f32 v131, v131, v240
    v_add_f32 v148, v148, v240
    v_add_f32 v149, v149, v240
    v_add_f32 v150, v150, v240
    v_add_f32 v151, v151, v240
    v_add_f32 v236, v236, v240
    v_add_f32 v237, v237, v240
    v_add_f32 v238, v238, v240
    v_add_f32 v239, v239, v240
    v_accvgpr_read_b32 v242, a128
    v_accvgpr_read_b32 v243, a129
    v_accvgpr_read_b32 v244, a130
    v_accvgpr_read_b32 v245, a131
    v_mul_f32 v242, v242, v241
    v_mul_f32 v243, v243, v241
    v_mul_f32 v244, v244, v241
    v_mul_f32 v245, v245, v241
    v_accvgpr_write_b32 a128, v242
    v_accvgpr_write_b32 a129, v243
    v_accvgpr_write_b32 a130, v244
    v_accvgpr_write_b32 a131, v245
    v_accvgpr_read_b32 v242, a132
    v_accvgpr_read_b32 v243, a133
    v_accvgpr_read_b32 v244, a134
    v_accvgpr_read_b32 v245, a135
    v_mul_f32 v242, v242, v241
    v_mul_f32 v243, v243, v241
    v_mul_f32 v244, v244, v241
    v_mul_f32 v245, v245, v241
    v_accvgpr_write_b32 a132, v242
    v_accvgpr_write_b32 a133, v243
    v_accvgpr_write_b32 a134, v244
    v_accvgpr_write_b32 a135, v245
    v_accvgpr_read_b32 v242, a136
    v_accvgpr_read_b32 v243, a137
    v_accvgpr_read_b32 v244, a138
    v_accvgpr_read_b32 v245, a139
    v_mul_f32 v242, v242, v241
    v_mul_f32 v243, v243, v241
    v_mul_f32 v244, v244, v241
    v_mul_f32 v245, v245, v241
    v_accvgpr_write_b32 a136, v242
    v_accvgpr_write_b32 a137, v243
    v_accvgpr_write_b32 a138, v244
    v_accvgpr_write_b32 a139, v245
    v_accvgpr_read_b32 v242, a140
    v_accvgpr_read_b32 v243, a141
    v_accvgpr_read_b32 v244, a142
    v_accvgpr_read_b32 v245, a143
    v_mul_f32 v242, v242, v241
    v_mul_f32 v243, v243, v241
    v_mul_f32 v244, v244, v241
    v_mul_f32 v245, v245, v241
    v_accvgpr_write_b32 a140, v242
    v_accvgpr_write_b32 a141, v243
    v_accvgpr_write_b32 a142, v244
    v_accvgpr_write_b32 a143, v245
    v_accvgpr_read_b32 v242, a144
    v_accvgpr_read_b32 v243, a145
    v_accvgpr_read_b32 v244, a146
    v_accvgpr_read_b32 v245, a147
    v_mul_f32 v242, v242, v241
    v_mul_f32 v243, v243, v241
    v_mul_f32 v244, v244, v241
    v_mul_f32 v245, v245, v241
    v_accvgpr_write_b32 a144, v242
    v_accvgpr_write_b32 a145, v243
    v_accvgpr_write_b32 a146, v244
    v_accvgpr_write_b32 a147, v245
    v_accvgpr_read_b32 v242, a148
    v_accvgpr_read_b32 v243, a149
    v_accvgpr_read_b32 v244, a150
    v_accvgpr_read_b32 v245, a151
    v_mul_f32 v242, v242, v241
    v_mul_f32 v243, v243, v241
    v_mul_f32 v244, v244, v241
    v_mul_f32 v245, v245, v241
    v_accvgpr_write_b32 a148, v242
    v_accvgpr_write_b32 a149, v243
    v_accvgpr_write_b32 a150, v244
    v_accvgpr_write_b32 a151, v245
    v_accvgpr_read_b32 v242, a152
    v_accvgpr_read_b32 v243, a153
    v_accvgpr_read_b32 v244, a154
    v_accvgpr_read_b32 v245, a155
    v_mul_f32 v242, v242, v241
    v_mul_f32 v243, v243, v241
    v_mul_f32 v244, v244, v241
    v_mul_f32 v245, v245, v241
    v_accvgpr_write_b32 a152, v242
    v_accvgpr_write_b32 a153, v243
    v_accvgpr_write_b32 a154, v244
    v_accvgpr_write_b32 a155, v245
    v_accvgpr_read_b32 v242, a156
    v_accvgpr_read_b32 v243, a157
    v_accvgpr_read_b32 v244, a158
    v_accvgpr_read_b32 v245, a159
    v_mul_f32 v242, v242, v241
    v_mul_f32 v243, v243, v241
    v_mul_f32 v244, v244, v241
    v_mul_f32 v245, v245, v241
    v_accvgpr_write_b32 a156, v242
    v_accvgpr_write_b32 a157, v243
    v_accvgpr_write_b32 a158, v244
    v_accvgpr_write_b32 a159, v245
    v_accvgpr_read_b32 v242, a240
    v_accvgpr_read_b32 v243, a241
    v_accvgpr_read_b32 v244, a242
    v_accvgpr_read_b32 v245, a243
    v_mul_f32 v242, v242, v241
    v_mul_f32 v243, v243, v241
    v_mul_f32 v244, v244, v241
    v_mul_f32 v245, v245, v241
    v_accvgpr_write_b32 a240, v242
    v_accvgpr_write_b32 a241, v243
    v_accvgpr_write_b32 a242, v244
    v_accvgpr_write_b32 a243, v245
    v_exp_f32 v240, v112
    v_exp_f32 v241, v113
    v_exp_f32 v242, v114
    v_cvt_pk_bf16_f32 v184, v240, v241
    v_exp_f32 v243, v115
    v_exp_f32 v244, v132
    v_cvt_pk_bf16_f32 v185, v242, v243
    v_exp_f32 v245, v133
    v_exp_f32 v246, v134
    v_cvt_pk_bf16_f32 v186, v244, v245
    v_exp_f32 v247, v135
    v_exp_f32 v248, v116
    v_cvt_pk_bf16_f32 v187, v246, v247
    v_exp_f32 v249, v117
    v_exp_f32 v250, v118
    v_cvt_pk_bf16_f32 v188, v248, v249
    v_exp_f32 v251, v119
    v_exp_f32 v252, v136
    v_cvt_pk_bf16_f32 v189, v250, v251
    v_exp_f32 v253, v137
    v_exp_f32 v254, v138
    v_cvt_pk_bf16_f32 v190, v252, v253
    v_exp_f32 v255, v139
    v_exp_f32 v240, v120
    v_cvt_pk_bf16_f32 v191, v254, v255
    v_exp_f32 v241, v121
    v_exp_f32 v242, v122
    v_cvt_pk_bf16_f32 v192, v240, v241
    v_exp_f32 v243, v123
    v_exp_f32 v244, v140
    v_cvt_pk_bf16_f32 v193, v242, v243
    v_exp_f32 v245, v141
    v_exp_f32 v246, v142
    v_cvt_pk_bf16_f32 v194, v244, v245
    v_exp_f32 v247, v143
    v_exp_f32 v248, v124
    v_cvt_pk_bf16_f32 v195, v246, v247
    v_exp_f32 v249, v125
    v_exp_f32 v250, v126
    v_cvt_pk_bf16_f32 v196, v248, v249
    v_exp_f32 v251, v127
    v_exp_f32 v252, v144
    v_cvt_pk_bf16_f32 v197, v250, v251
    v_exp_f32 v253, v145
    v_exp_f32 v254, v146
    v_cvt_pk_bf16_f32 v198, v252, v253
    v_exp_f32 v255, v147
    v_exp_f32 v240, v128
    v_cvt_pk_bf16_f32 v199, v254, v255
    v_exp_f32 v241, v129
    v_exp_f32 v242, v130
    v_cvt_pk_bf16_f32 v200, v240, v241
    v_exp_f32 v243, v131
    v_exp_f32 v244, v148
    v_cvt_pk_bf16_f32 v201, v242, v243
    v_exp_f32 v245, v149
    v_exp_f32 v246, v150
    v_cvt_pk_bf16_f32 v202, v244, v245
    v_exp_f32 v247, v151
    s_nop 0
    v_cvt_pk_bf16_f32 v203, v246, v247
    s_nop 3
    s_setpc_b64 s[60:61]
L_slow1:
    s_nop 15
    v_max3_f32 v240, v152, v153, v154
    v_max3_f32 v241, v155, v168, v169
    v_max3_f32 v240, v170, v171, v240
    v_max_f32 v240, v240, v241
    v_mov_b32 v241, v240
    s_nop 1
    v_permlane32_swap_b32 v240, v241
    s_nop 1
    v_max_f32 v240, v240, v241
    v_mov_b32 v241, v240
    s_nop 1
    v_permlane16_swap_b32 v240, v241
    s_nop 1
    v_max_f32 v240, v240, v241
    v_sub_f32 v240, 0xc0e00000, v240
    v_min_f32 v240, 0, v240
    v_exp_f32 v241, v240
    v_add_f32 v152, v152, v240
    v_add_f32 v153, v153, v240
    v_add_f32 v154, v154, v240
    v_add_f32 v155, v155, v240
    v_add_f32 v168, v168, v240
    v_add_f32 v169, v169, v240
    v_add_f32 v170, v170, v240
    v_add_f32 v171, v171, v240
    v_add_f32 v112, v112, v240
    v_add_f32 v113, v113, v240
    v_add_f32 v114, v114, v240
    v_add_f32 v115, v115, v240
    v_add_f32 v132, v132, v240
    v_add_f32 v133, v133, v240
    v_add_f32 v134, v134, v240
    v_add_f32 v135, v135, v240
    v_add_f32 v220, v220, v240
    v_add_f32 v221, v221, v240
    v_add_f32 v222, v222, v240
    v_add_f32 v223, v223, v240
    v_accvgpr_read_b32 v242, a0
    v_accvgpr_read_b32 v243, a1
    v_accvgpr_read_b32 v244, a2
    v_accvgpr_read_b32 v245, a3
    v_mul_f32 v242, v242, v241
    v_mul_f32 v243, v243, v241
    v_mul_f32 v244, v244, v241
    v_mul_f32 v245, v245, v241
    v_accvgpr_write_b32 a0, v242
    v_accvgpr_write_b32 a1, v243
    v_accvgpr_write_b32 a2, v244
    v_accvgpr_write_b32 a3, v245
    v_accvgpr_read_b32 v242, a4
    v_accvgpr_read_b32 v243, a5
    v_accvgpr_read_b32 v244, a6
    v_accvgpr_read_b32 v245, a7
    v_mul_f32 v242, v242, v241
    v_mul_f32 v243, v243, v241
    v_mul_f32 v244, v244, v241
    v_mul_f32 v245, v245, v241
    v_accvgpr_write_b32 a4, v242
    v_accvgpr_write_b32 a5, v243
    v_accvgpr_write_b32 a6, v244
    v_accvgpr_write_b32 a7, v245
    v_accvgpr_read_b32 v242, a8
    v_accvgpr_read_b32 v243, a9
    v_accvgpr_read_b32 v244, a10
    v_accvgpr_read_b32 v245, a11
    v_mul_f32 v242, v242, v241
    v_mul_f32 v243, v243, v241
    v_mul_f32 v244, v244, v241
    v_mul_f32 v245, v245, v241
    v_accvgpr_write_b32 a8, v242
    v_accvgpr_write_b32 a9, v243
    v_accvgpr_write_b32 a10, v244
    v_accvgpr_write_b32 a11, v245
    v_accvgpr_read_b32 v242, a12
    v_accvgpr_read_b32 v243, a13
    v_accvgpr_read_b32 v244, a14
    v_accvgpr_read_b32 v245, a15
    v_mul_f32 v242, v242, v241
    v_mul_f32 v243, v243, v241
    v_mul_f32 v244, v244, v241
    v_mul_f32 v245, v245, v241
    v_accvgpr_write_b32 a12, v242
    v_accvgpr_write_b32 a13, v243
    v_accvgpr_write_b32 a14, v244
    v_accvgpr_write_b32 a15, v245
    v_accvgpr_read_b32 v242, a16
    v_accvgpr_read_b32 v243, a17
    v_accvgpr_read_b32 v244, a18
    v_accvgpr_read_b32 v245, a19
    v_mul_f32 v242, v242, v241
    v_mul_f32 v243, v243, v241
    v_mul_f32 v244, v244, v241
    v_mul_f32 v245, v245, v241
    v_accvgpr_write_b32 a16, v242
    v_accvgpr_write_b32 a17, v243
    v_accvgpr_write_b32 a18, v244
    v_accvgpr_write_b32 a19, v245
    v_accvgpr_read_b32 v242, a20
    v_accvgpr_read_b32 v243, a21
    v_accvgpr_read_b32 v244, a22
    v_accvgpr_read_b32 v245, a23
    v_mul_f32 v242, v242, v241
    v_mul_f32 v243, v243, v241
    v_mul_f32 v244, v244, v241
    v_mul_f32 v245, v245, v241
    v_accvgpr_write_b32 a20, v242
    v_accvgpr_write_b32 a21, v243
    v_accvgpr_write_b32 a22, v244
    v_accvgpr_write_b32 a23, v245
    v_accvgpr_read_b32 v242, a24
    v_accvgpr_read_b32 v243, a25
    v_accvgpr_read_b32 v244, a26
    v_accvgpr_read_b32 v245, a27
    v_mul_f32 v242, v242, v241
    v_mul_f32 v243, v243, v241
    v_mul_f32 v244, v244, v241
    v_mul_f32 v245, v245, v241
    v_accvgpr_write_b32 a24, v242
    v_accvgpr_write_b32 a25, v243
    v_accvgpr_write_b32 a26, v244
    v_accvgpr_write_b32 a27, v245
    v_accvgpr_read_b32 v242, a28
    v_accvgpr_read_b32 v243, a29
    v_accvgpr_read_b32 v244, a30
    v_accvgpr_read_b32 v245, a31
    v_mul_f32 v242, v242, v241
    v_mul_f32 v243, v243, v241
    v_mul_f32 v244, v244, v241
    v_mul_f32 v245, v245, v241
    v_accvgpr_write_b32 a28, v242
    v_accvgpr_write_b32 a29, v243
    v_accvgpr_write_b32 a30, v244
    v_accvgpr_write_b32 a31, v245
    v_accvgpr_read_b32 v242, a224
    v_accvgpr_read_b32 v243, a225
    v_accvgpr_read_b32 v244, a226
    v_accvgpr_read_b32 v245, a227
    v_mul_f32 v242, v242, v241
    v_mul_f32 v243, v243, v241
    v_mul_f32 v244, v244, v241
    v_mul_f32 v245, v245, v241
    v_accvgpr_write_b32 a224, v242
    v_accvgpr_write_b32 a225, v243
    v_accvgpr_write_b32 a226, v244
    v_accvgpr_write_b32 a227, v245
    v_max3_f32 v240, v156, v157, v158
    v_max3_f32 v241, v159, v172, v173
    v_max3_f32 v240, v174, v175, v240
    v_max_f32 v240, v240, v241
    v_mov_b32 v241, v240
    s_nop 1
    v_permlane32_swap_b32 v240, v241
    s_nop 1
    v_max_f32 v240, v240, v241
    v_mov_b32 v241, v240
    s_nop 1
    v_permlane16_swap_b32 v240, v241
    s_nop 1
    v_max_f32 v240, v240, v241
    v_sub_f32 v240, 0xc0e00000, v240
    v_min_f32 v240, 0, v240
    v_exp_f32 v241, v240
    v_add_f32 v156, v156, v240
    v_add_f32 v157, v157, v240
    v_add_f32 v158, v158, v240
    v_add_f32 v159, v159, v240
    v_add_f32 v172, v172, v240
    v_add_f32 v173, v173, v240
    v_add_f32 v174, v174, v240
    v_add_f32 v175, v175, v240
    v_add_f32 v116, v116, v240
    v_add_f32 v117, v117, v240
    v_add_f32 v118, v118, v240
    v_add_f32 v119, v119, v240
    v_add_f32 v136, v136, v240
    v_add_f32 v137, v137, v240
    v_add_f32 v138, v138, v240
    v_add_f32 v139, v139, v240
    v_add_f32 v224, v224, v240
    v_add_f32 v225, v225, v240
    v_add_f32 v226, v226, v240
    v_add_f32 v227, v227, v240
    v_accvgpr_read_b32 v242, a32
    v_accvgpr_read_b32 v243, a33
    v_accvgpr_read_b32 v244, a34
    v_accvgpr_read_b32 v245, a35
    v_mul_f32 v242, v242, v241
    v_mul_f32 v243, v243, v241
    v_mul_f32 v244, v244, v241
    v_mul_f32 v245, v245, v241
    v_accvgpr_write_b32 a32, v242
    v_accvgpr_write_b32 a33, v243
    v_accvgpr_write_b32 a34, v244
    v_accvgpr_write_b32 a35, v245
    v_accvgpr_read_b32 v242, a36
    v_accvgpr_read_b32 v243, a37
    v_accvgpr_read_b32 v244, a38
    v_accvgpr_read_b32 v245, a39
    v_mul_f32 v242, v242, v241
    v_mul_f32 v243, v243, v241
    v_mul_f32 v244, v244, v241
    v_mul_f32 v245, v245, v241
    v_accvgpr_write_b32 a36, v242
    v_accvgpr_write_b32 a37, v243
    v_accvgpr_write_b32 a38, v244
    v_accvgpr_write_b32 a39, v245
    v_accvgpr_read_b32 v242, a40
    v_accvgpr_read_b32 v243, a41
    v_accvgpr_read_b32 v244, a42
    v_accvgpr_read_b32 v245, a43
    v_mul_f32 v242, v242, v241
    v_mul_f32 v243, v243, v241
    v_mul_f32 v244, v244, v241
    v_mul_f32 v245, v245, v241
    v_accvgpr_write_b32 a40, v242
    v_accvgpr_write_b32 a41, v243
    v_accvgpr_write_b32 a42, v244
    v_accvgpr_write_b32 a43, v245
    v_accvgpr_read_b32 v242, a44
    v_accvgpr_read_b32 v243, a45
    v_accvgpr_read_b32 v244, a46
    v_accvgpr_read_b32 v245, a47
    v_mul_f32 v242, v242, v241
    v_mul_f32 v243, v243, v241
    v_mul_f32 v244, v244, v241
    v_mul_f32 v245, v245, v241
    v_accvgpr_write_b32 a44, v242
    v_accvgpr_write_b32 a45, v243
    v_accvgpr_write_b32 a46, v244
    v_accvgpr_write_b32 a47, v245
    v_accvgpr_read_b32 v242, a48
    v_accvgpr_read_b32 v243, a49
    v_accvgpr_read_b32 v244, a50
    v_accvgpr_read_b32 v245, a51
    v_mul_f32 v242, v242, v241
    v_mul_f32 v243, v243, v241
    v_mul_f32 v244, v244, v241
    v_mul_f32 v245, v245, v241
    v_accvgpr_write_b32 a48, v242
    v_accvgpr_write_b32 a49, v243
    v_accvgpr_write_b32 a50, v244
    v_accvgpr_write_b32 a51, v245
    v_accvgpr_read_b32 v242, a52
    v_accvgpr_read_b32 v243, a53
    v_accvgpr_read_b32 v244, a54
    v_accvgpr_read_b32 v245, a55
    v_mul_f32 v242, v242, v241
    v_mul_f32 v243, v243, v241
    v_mul_f32 v244, v244, v241
    v_mul_f32 v245, v245, v241
    v_accvgpr_write_b32 a52, v242
    v_accvgpr_write_b32 a53, v243
    v_accvgpr_write_b32 a54, v244
    v_accvgpr_write_b32 a55, v245
    v_accvgpr_read_b32 v242, a56
    v_accvgpr_read_b32 v243, a57
    v_accvgpr_read_b32 v244, a58
    v_accvgpr_read_b32 v245, a59
    v_mul_f32 v242, v242, v241
    v_mul_f32 v243, v243, v241
    v_mul_f32 v244, v244, v241
    v_mul_f32 v245, v245, v241
    v_accvgpr_write_b32 a56, v242
    v_accvgpr_write_b32 a57, v243
    v_accvgpr_write_b32 a58, v244
    v_accvgpr_write_b32 a59, v245
    v_accvgpr_read_b32 v242, a60
    v_accvgpr_read_b32 v243, a61
    v_accvgpr_read_b32 v244, a62
    v_accvgpr_read_b32 v245, a63
    v_mul_f32 v242, v242, v241
    v_mul_f32 v243, v243, v241
    v_mul_f32 v244, v244, v241
    v_mul_f32 v245, v245, v241
    v_accvgpr_write_b32 a60, v242
    v_accvgpr_write_b32 a61, v243
    v_accvgpr_write_b32 a62, v244
    v_accvgpr_write_b32 a63, v245
    v_accvgpr_read_b32 v242, a228
    v_accvgpr_read_b32 v243, a229
    v_accvgpr_read_b32 v244, a230
    v_accvgpr_read_b32 v245, a231
    v_mul_f32 v242, v242, v241
    v_mul_f32 v243, v243, v241
    v_mul_f32 v244, v244, v241
    v_mul_f32 v245, v245, v241
    v_accvgpr_write_b32 a228, v242
    v_accvgpr_write_b32 a229, v243
    v_accvgpr_write_b32 a230, v244
    v_accvgpr_write_b32 a231, v245
    v_max3_f32 v240, v160, v161, v162
    v_max3_f32 v241, v163, v176, v177
    v_max3_f32 v240, v178, v179, v240
    v_max_f32 v240, v240, v241
    v_mov_b32 v241, v240
    s_nop 1
    v_permlane32_swap_b32 v240, v241
    s_nop 1
    v_max_f32 v240, v240, v241
    v_mov_b32 v241, v240
    s_nop 1
    v_permlane16_swap_b32 v240, v241
    s_nop 1
    v_max_f32 v240, v240, v241
    v_sub_f32 v240, 0xc0e00000, v240
    v_min_f32 v240, 0, v240
    v_exp_f32 v241, v240
    v_add_f32 v160, v160, v240
    v_add_f32 v161, v161, v240
    v_add_f32 v162, v162, v240
    v_add_f32 v163, v163, v240
    v_add_f32 v176, v176, v240
    v_add_f32 v177, v177, v240
    v_add_f32 v178, v178, v240
    v_add_f32 v179, v179, v240
    v_add_f32 v120, v120, v240
    v_add_f32 v121, v121, v240
    v_add_f32 v122, v122, v240
    v_add_f32 v123, v123, v240
    v_add_f32 v140, v140, v240
    v_add_f32 v141, v141, v240
    v_add_f32 v142, v142, v240
    v_add_f32 v143, v143, v240
    v_add_f32 v228, v228, v240
    v_add_f32 v229, v229, v240
    v_add_f32 v230, v230, v240
    v_add_f32 v231, v231, v240
    v_accvgpr_read_b32 v242, a64
    v_accvgpr_read_b32 v243, a65
    v_accvgpr_read_b32 v244, a66
    v_accvgpr_read_b32 v245, a67
    v_mul_f32 v242, v242, v241
    v_mul_f32 v243, v243, v241
    v_mul_f32 v244, v244, v241
    v_mul_f32 v245, v245, v241
    v_accvgpr_write_b32 a64, v242
    v_accvgpr_write_b32 a65, v243
    v_accvgpr_write_b32 a66, v244
    v_accvgpr_write_b32 a67, v245
    v_accvgpr_read_b32 v242, a68
    v_accvgpr_read_b32 v243, a69
    v_accvgpr_read_b32 v244, a70
    v_accvgpr_read_b32 v245, a71
    v_mul_f32 v242, v242, v241
    v_mul_f32 v243, v243, v241
    v_mul_f32 v244, v244, v241
    v_mul_f32 v245, v245, v241
    v_accvgpr_write_b32 a68, v242
    v_accvgpr_write_b32 a69, v243
    v_accvgpr_write_b32 a70, v244
    v_accvgpr_write_b32 a71, v245
    v_accvgpr_read_b32 v242, a72
    v_accvgpr_read_b32 v243, a73
    v_accvgpr_read_b32 v244, a74
    v_accvgpr_read_b32 v245, a75
    v_mul_f32 v242, v242, v241
    v_mul_f32 v243, v243, v241
    v_mul_f32 v244, v244, v241
    v_mul_f32 v245, v245, v241
    v_accvgpr_write_b32 a72, v242
    v_accvgpr_write_b32 a73, v243
    v_accvgpr_write_b32 a74, v244
    v_accvgpr_write_b32 a75, v245
    v_accvgpr_read_b32 v242, a76
    v_accvgpr_read_b32 v243, a77
    v_accvgpr_read_b32 v244, a78
    v_accvgpr_read_b32 v245, a79
    v_mul_f32 v242, v242, v241
    v_mul_f32 v243, v243, v241
    v_mul_f32 v244, v244, v241
    v_mul_f32 v245, v245, v241
    v_accvgpr_write_b32 a76, v242
    v_accvgpr_write_b32 a77, v243
    v_accvgpr_write_b32 a78, v244
    v_accvgpr_write_b32 a79, v245
    v_accvgpr_read_b32 v242, a80
    v_accvgpr_read_b32 v243, a81
    v_accvgpr_read_b32 v244, a82
    v_accvgpr_read_b32 v245, a83
    v_mul_f32 v242, v242, v241
    v_mul_f32 v243, v243, v241
    v_mul_f32 v244, v244, v241
    v_mul_f32 v245, v245, v241
    v_accvgpr_write_b32 a80, v242
    v_accvgpr_write_b32 a81, v243
    v_accvgpr_write_b32 a82, v244
    v_accvgpr_write_b32 a83, v245
    v_accvgpr_read_b32 v242, a84
    v_accvgpr_read_b32 v243, a85
    v_accvgpr_read_b32 v244, a86
    v_accvgpr_read_b32 v245, a87
    v_mul_f32 v242, v242, v241
    v_mul_f32 v243, v243, v241
    v_mul_f32 v244, v244, v241
    v_mul_f32 v245, v245, v241
    v_accvgpr_write_b32 a84, v242
    v_accvgpr_write_b32 a85, v243
    v_accvgpr_write_b32 a86, v244
    v_accvgpr_write_b32 a87, v245
    v_accvgpr_read_b32 v242, a88
    v_accvgpr_read_b32 v243, a89
    v_accvgpr_read_b32 v244, a90
    v_accvgpr_read_b32 v245, a91
    v_mul_f32 v242, v242, v241
    v_mul_f32 v243, v243, v241
    v_mul_f32 v244, v244, v241
    v_mul_f32 v245, v245, v241
    v_accvgpr_write_b32 a88, v242
    v_accvgpr_write_b32 a89, v243
    v_accvgpr_write_b32 a90, v244
    v_accvgpr_write_b32 a91, v245
    v_accvgpr_read_b32 v242, a92
    v_accvgpr_read_b32 v243, a93
    v_accvgpr_read_b32 v244, a94
    v_accvgpr_read_b32 v245, a95
    v_mul_f32 v242, v242, v241
    v_mul_f32 v243, v243, v241
    v_mul_f32 v244, v244, v241
    v_mul_f32 v245, v245, v241
    v_accvgpr_write_b32 a92, v242
    v_accvgpr_write_b32 a93, v243
    v_accvgpr_write_b32 a94, v244
    v_accvgpr_write_b32 a95, v245
    v_accvgpr_read_b32 v242, a232
    v_accvgpr_read_b32 v243, a233
    v_accvgpr_read_b32 v244, a234
    v_accvgpr_read_b32 v245, a235
    v_mul_f32 v242, v242, v241
    v_mul_f32 v243, v243, v241
    v_mul_f32 v244, v244, v241
    v_mul_f32 v245, v245, v241
    v_accvgpr_write_b32 a232, v242
    v_accvgpr_write_b32 a233, v243
    v_accvgpr_write_b32 a234, v244
    v_accvgpr_write_b32 a235, v245
    v_max3_f32 v240, v164, v165, v166
    v_max3_f32 v241, v167, v180, v181
    v_max3_f32 v240, v182, v183, v240
    v_max_f32 v240, v240, v241
    v_mov_b32 v241, v240
    s_nop 1
    v_permlane32_swap_b32 v240, v241
    s_nop 1
    v_max_f32 v240, v240, v241
    v_mov_b32 v241, v240
    s_nop 1
    v_permlane16_swap_b32 v240, v241
    s_nop 1
    v_max_f32 v240, v240, v241
    v_sub_f32 v240, 0xc0e00000, v240
    v_min_f32 v240, 0, v240
    v_exp_f32 v241, v240
    v_add_f32 v164, v164, v240
    v_add_f32 v165, v165, v240
    v_add_f32 v166, v166, v240
    v_add_f32 v167, v167, v240
    v_add_f32 v180, v180, v240
    v_add_f32 v181, v181, v240
    v_add_f32 v182, v182, v240
    v_add_f32 v183, v183, v240
    v_add_f32 v124, v124, v240
    v_add_f32 v125, v125, v240
    v_add_f32 v126, v126, v240
    v_add_f32 v127, v127, v240
    v_add_f32 v144, v144, v240
    v_add_f32 v145, v145, v240
    v_add_f32 v146, v146, v240
    v_add_f32 v147, v147, v240
    v_add_f32 v232, v232, v240
    v_add_f32 v233, v233, v240
    v_add_f32 v234, v234, v240
    v_add_f32 v235, v235, v240
    v_accvgpr_read_b32 v242, a96
    v_accvgpr_read_b32 v243, a97
    v_accvgpr_read_b32 v244, a98
    v_accvgpr_read_b32 v245, a99
    v_mul_f32 v242, v242, v241
    v_mul_f32 v243, v243, v241
    v_mul_f32 v244, v244, v241
    v_mul_f32 v245, v245, v241
    v_accvgpr_write_b32 a96, v242
    v_accvgpr_write_b32 a97, v243
    v_accvgpr_write_b32 a98, v244
    v_accvgpr_write_b32 a99, v245
    v_accvgpr_read_b32 v242, a100
    v_accvgpr_read_b32 v243, a101
    v_accvgpr_read_b32 v244, a102
    v_accvgpr_read_b32 v245, a103
    v_mul_f32 v242, v242, v241
    v_mul_f32 v243, v243, v241
    v_mul_f32 v244, v244, v241
    v_mul_f32 v245, v245, v241
    v_accvgpr_write_b32 a100, v242
    v_accvgpr_write_b32 a101, v243
    v_accvgpr_write_b32 a102, v244
    v_accvgpr_write_b32 a103, v245
    v_accvgpr_read_b32 v242, a104
    v_accvgpr_read_b32 v243, a105
    v_accvgpr_read_b32 v244, a106
    v_accvgpr_read_b32 v245, a107
    v_mul_f32 v242, v242, v241
    v_mul_f32 v243, v243, v241
    v_mul_f32 v244, v244, v241
    v_mul_f32 v245, v245, v241
    v_accvgpr_write_b32 a104, v242
    v_accvgpr_write_b32 a105, v243
    v_accvgpr_write_b32 a106, v244
    v_accvgpr_write_b32 a107, v245
    v_accvgpr_read_b32 v242, a108
    v_accvgpr_read_b32 v243, a109
    v_accvgpr_read_b32 v244, a110
    v_accvgpr_read_b32 v245, a111
    v_mul_f32 v242, v242, v241
    v_mul_f32 v243, v243, v241
    v_mul_f32 v244, v244, v241
    v_mul_f32 v245, v245, v241
    v_accvgpr_write_b32 a108, v242
    v_accvgpr_write_b32 a109, v243
    v_accvgpr_write_b32 a110, v244
    v_accvgpr_write_b32 a111, v245
    v_accvgpr_read_b32 v242, a112
    v_accvgpr_read_b32 v243, a113
    v_accvgpr_read_b32 v244, a114
    v_accvgpr_read_b32 v245, a115
    v_mul_f32 v242, v242, v241
    v_mul_f32 v243, v243, v241
    v_mul_f32 v244, v244, v241
    v_mul_f32 v245, v245, v241
    v_accvgpr_write_b32 a112, v242
    v_accvgpr_write_b32 a113, v243
    v_accvgpr_write_b32 a114, v244
    v_accvgpr_write_b32 a115, v245
    v_accvgpr_read_b32 v242, a116
    v_accvgpr_read_b32 v243, a117
    v_accvgpr_read_b32 v244, a118
    v_accvgpr_read_b32 v245, a119
    v_mul_f32 v242, v242, v241
    v_mul_f32 v243, v243, v241
    v_mul_f32 v244, v244, v241
    v_mul_f32 v245, v245, v241
    v_accvgpr_write_b32 a116, v242
    v_accvgpr_write_b32 a117, v243
    v_accvgpr_write_b32 a118, v244
    v_accvgpr_write_b32 a119, v245
    v_accvgpr_read_b32 v242, a120
    v_accvgpr_read_b32 v243, a121
    v_accvgpr_read_b32 v244, a122
    v_accvgpr_read_b32 v245, a123
    v_mul_f32 v242, v242, v241
    v_mul_f32 v243, v243, v241
    v_mul_f32 v244, v244, v241
    v_mul_f32 v245, v245, v241
    v_accvgpr_write_b32 a120, v242
    v_accvgpr_write_b32 a121, v243
    v_accvgpr_write_b32 a122, v244
    v_accvgpr_write_b32 a123, v245
    v_accvgpr_read_b32 v242, a124
    v_accvgpr_read_b32 v243, a125
    v_accvgpr_read_b32 v244, a126
    v_accvgpr_read_b32 v245, a127
    v_mul_f32 v242, v242, v241
    v_mul_f32 v243, v243, v241
    v_mul_f32 v244, v244, v241
    v_mul_f32 v245, v245, v241
    v_accvgpr_write_b32 a124, v242
    v_accvgpr_write_b32 a125, v243
    v_accvgpr_write_b32 a126, v244
    v_accvgpr_write_b32 a127, v245
    v_accvgpr_read_b32 v242, a236
    v_accvgpr_read_b32 v243, a237
    v_accvgpr_read_b32 v244, a238
    v_accvgpr_read_b32 v245, a239
    v_mul_f32 v242, v242, v241
    v_mul_f32 v243, v243, v241
    v_mul_f32 v244, v244, v241
    v_mul_f32 v245, v245, v241
    v_accvgpr_write_b32 a236, v242
    v_accvgpr_write_b32 a237, v243
    v_accvgpr_write_b32 a238, v244
    v_accvgpr_write_b32 a239, v245
    v_exp_f32 v240, v152
    v_exp_f32 v241, v153
    v_exp_f32 v242, v154
    v_cvt_pk_bf16_f32 v204, v240, v241
    v_exp_f32 v243, v155
    v_exp_f32 v244, v168
    v_cvt_pk_bf16_f32 v205, v242, v243
    v_exp_f32 v245, v169
    v_exp_f32 v246, v170
    v_cvt_pk_bf16_f32 v206, v244, v245
    v_exp_f32 v247, v171
    v_exp_f32 v248, v156
    v_cvt_pk_bf16_f32 v207, v246, v247
    v_exp_f32 v249, v157
    v_exp_f32 v250, v158
    v_cvt_pk_bf16_f32 v208, v248, v249
    v_exp_f32 v251, v159
    v_exp_f32 v252, v172
    v_cvt_pk_bf16_f32 v209, v250, v251
    v_exp_f32 v253, v173
    v_exp_f32 v254, v174
    v_cvt_pk_bf16_f32 v210, v252, v253
    v_exp_f32 v255, v175
    v_exp_f32 v240, v160
    v_cvt_pk_bf16_f32 v211, v254, v255
    v_exp_f32 v241, v161
    v_exp_f32 v242, v162
    v_cvt_pk_bf16_f32 v212, v240, v241
    v_exp_f32 v243, v163
    v_exp_f32 v244, v176
    v_cvt_pk_bf16_f32 v213, v242, v243
    v_exp_f32 v245, v177
    v_exp_f32 v246, v178
    v_cvt_pk_bf16_f32 v214, v244, v245
    v_exp_f32 v247, v179
    v_exp_f32 v248, v164
    v_cvt_pk_bf16_f32 v215, v246, v247
    v_exp_f32 v249, v165
    v_exp_f32 v250, v166
    v_cvt_pk_bf16_f32 v216, v248, v249
    v_exp_f32 v251, v167
    v_exp_f32 v252, v180
    v_cvt_pk_bf16_f32 v217, v250, v251
    v_exp_f32 v253, v181
    v_exp_f32 v254, v182
    v_cvt_pk_bf16_f32 v218, v252, v253
    v_exp_f32 v255, v183
    s_nop 0
    v_cvt_pk_bf16_f32 v219, v254, v255
    v_exp_f32 v240, v112
    v_exp_f32 v241, v113
    v_exp_f32 v242, v114
    v_exp_f32 v243, v115
    v_exp_f32 v244, v132
    v_exp_f32 v245, v133
    s_nop 3
    s_setpc_b64 s[60:61]
.section .rodata,"a"
.p2align 6
.amdhsa_kernel concat_heads__mha_block_cached__mha_block_cached__near_ridge_kernel
  .amdhsa_next_free_vgpr 512
  .amdhsa_next_free_sgpr 102
  .amdhsa_accum_offset 256
  .amdhsa_group_segment_fixed_size 0
  .amdhsa_kernarg_size 104
  .amdhsa_user_sgpr_count 2
  .amdhsa_user_sgpr_kernarg_segment_ptr 1
  .amdhsa_system_sgpr_workgroup_id_x 1
.end_amdhsa_kernel
```
